```python
import torch

def _softmax(x, axis=-1):
    return torch.softmax(x, dim=axis)
def _gelu(x):
    return torch.nn.functional.gelu(x, approximate="tanh")
def _silu(x):
    return torch.nn.functional.silu(x)
def _sigmoid(x):
    return torch.sigmoid(x)
def _layernorm(x, axis=-1, eps=1e-5):
    m = x.mean(dim=axis, keepdim=True)
    v = x.var(dim=axis, keepdim=True, unbiased=False)
    return (x - m) / torch.sqrt(v + eps)
def _scatter_add(tgt, idx, src, axis=0):
    return tgt.clone().index_add_(axis, idx, src)
def _segment_sum(src, seg, n):
    out = torch.zeros((n,) + src.shape[1:], dtype=src.dtype)
    return out.index_add_(0, seg, src)
def _pad(x, pw):
    flat = tuple(v for pair in reversed(pw) for v in pair)
    return torch.nn.functional.pad(x, flat)

kernel_name = 'gated_mix__sliding_local_dilated__mixer_token_mlp__prompt'

def setup_inputs():

    _w = (lambda a: (lambda t: t.to(torch.bfloat16) if t.is_floating_point() else t)(torch.as_tensor(a)))
    def _A_setup():
        B, S, D = 1, 2048, 640
        return {
            "x": _w((lambda *s: torch.randn(*s, dtype=torch.bfloat16) * 0.05)(B, S, D)),
            "wqkv": _w((lambda *s: torch.randn(*s, dtype=torch.bfloat16) * 0.8)(D, 3 * D)),
            "wo": _w((lambda *s: torch.randn(*s, dtype=torch.bfloat16) * 0.05)(D, D)),
        }
    _A_in = _A_setup()

    def _B_setup():
        B, S, D, F = 1, 2048, 640, 1536
        return {
            "x": _w((lambda *s: torch.randn(*s, dtype=torch.bfloat16) * 0.05)(B, S, D)),
            "w1": _w((lambda *s: torch.randn(*s, dtype=torch.bfloat16) * 0.8)(S, F) * (S ** -0.5)),
            "b1": _w((lambda *s: torch.randn(*s, dtype=torch.bfloat16) * 0.8)(F) * 0.02),
            "w2": _w((lambda *s: torch.randn(*s, dtype=torch.bfloat16) * 0.8)(F, S) * (F ** -0.5)),
            "b2": _w((lambda *s: torch.randn(*s, dtype=torch.bfloat16) * 0.8)(S) * 0.02),
        }
    _B_in = _B_setup()

    return {
        "A_x": _A_in["x"],
        "A_wqkv": _A_in["wqkv"],
        "A_wo": _A_in["wo"],
        "B_x": _B_in["x"],
        "B_w1": _B_in["w1"],
        "B_b1": _B_in["b1"],
        "B_w2": _B_in["w2"],
        "B_b2": _B_in["b2"],
        "gate_w": _w((lambda *s: torch.randn(*s, dtype=torch.bfloat16) * 0.05)(640) * 16.0),
    }

def reference(A_x, A_wqkv, A_wo, B_x, B_w1, B_b1, B_w2, B_b2, gate_w):
    def _A_ref(x, wqkv, wo):
        B, S, D = x.shape
        H = 32; Dh = D // H
        W, dil = 8, 2
        qkv = (lambda x, *d: x.permute(*d))((x @ wqkv).reshape(B, S, 3, H, Dh), 2, 0, 3, 1, 4)
        q, k, v = qkv[0], qkv[1], qkv[2]
        scale = Dh ** -0.5
        pos = torch.arange(S)
        off = torch.arange(W) * dil
        idx = pos[:, None] - off[None, :]
        mask = idx >= 0
        idx_c = torch.where(mask, idx, 0).reshape(-1)
        kg = k[:, :, idx_c, :].reshape(B, H, S, W, Dh)
        vg = v[:, :, idx_c, :].reshape(B, H, S, W, Dh)
        logits = torch.einsum("bhsd,bhswd->bhsw", q, kg) * scale
        logits = torch.where(mask[None, None, :, :], logits, -1e9)
        attn = _softmax(logits, axis=-1)
        o = torch.einsum("bhsw,bhswd->bhsd", attn, vg)
        return (lambda x, *d: x.permute(*d))(o, 0, 2, 1, 3).reshape(B, S, D) @ wo

    def _B_ref(x, w1, b1, w2, b2):
        B, S, D = x.shape
        h = _layernorm(x, axis=-1)
        u = torch.einsum("bsd,sf->bdf", h, w1) + b1
        u = _gelu(u)
        y = torch.einsum("bdf,fs->bds", u, w2) + b2
        return (lambda x, *d: x.permute(*d))(y, 0, 2, 1)

    x = A_x
    g = _sigmoid((x * gate_w).sum(-1, keepdims=True))
    a = _A_ref(x, A_wqkv, A_wo)
    b = _B_ref(x, B_w1, B_b1, B_w2, B_b2)
    return g * a + (1 - g) * b
```

```asm
; @launch grid=(256,1,1) block=(512,1,1) lds=163840
.amdgcn_target "amdgcn-amd-amdhsa--gfx950"
.text
.globl gated_mix__sliding_local_dilated__mixer_token_mlp__prompt_kernel
.p2align 8
.type gated_mix__sliding_local_dilated__mixer_token_mlp__prompt_kernel,@function
gated_mix__sliding_local_dilated__mixer_token_mlp__prompt_kernel:
    s_cmp_ge_u32 s2, 256
    s_cbranch_scc1 L_end
    s_load_dwordx2 s[8:9], s[0:1], 0
    s_load_dwordx2 s[48:49], s[0:1], 64
    s_load_dwordx2 s[12:13], s[0:1], 8
    s_load_dwordx2 s[28:29], s[0:1], 88
    s_load_dwordx2 s[16:17], s[0:1], 16
    s_load_dwordx2 s[20:21], s[0:1], 32
    s_load_dwordx2 s[40:41], s[0:1], 40
    s_load_dwordx2 s[24:25], s[0:1], 48
    s_load_dwordx2 s[44:45], s[0:1], 56
    s_load_dwordx2 s[36:37], s[0:1], 72
    v_lshrrev_b32 v1, 6, v0
    v_and_b32 v0, 63, v0
    v_readfirstlane_b32 s52, v1
    s_mov_b32 s10, 2621440
    s_mov_b32 s11, 0x20000
    s_and_b32 s53, s2, 7
    s_lshr_b32 s54, s2, 3
    s_cmp_lt_u32 s54, 16
    s_cbranch_scc1 L_loaderA
    s_setprio 2
    s_mov_b32 s50, 1280
    s_mov_b32 s51, 0x20000
    s_lshr_b32 s79, s52, 2
    s_and_b32 s52, s52, 3
    s_lshl4_add_u32 s62, s53, s54
    s_sub_u32 s62, s62, 16
    s_lshl1_add_u32 s62, s62, s79
    v_lshrrev_b32 v124, 5, v0
    s_lshl_b32 s66, s62, 3
    s_lshl1_add_u32 s66, s52, s66
    v_add_u32 v126, s66, v124
    v_mul_u32_u24 v124, 1280, v126
    v_and_b32 v125, 31, v0
    v_lshlrev_b32 v125, 3, v125
    v_add_u32 v124, v124, v125
    s_waitcnt lgkmcnt(0)
    buffer_load_dwordx2 v[104:105], v124, s[8:11], 0 offen offset:0
    buffer_load_dwordx2 v[106:107], v124, s[8:11], 0 offen offset:256
    buffer_load_dwordx2 v[108:109], v124, s[8:11], 0 offen offset:512
    buffer_load_dwordx2 v[110:111], v124, s[8:11], 0 offen offset:768
    buffer_load_dwordx2 v[112:113], v124, s[8:11], 0 offen offset:1024
    buffer_load_dwordx2 v[114:115], v125, s[48:51], 0 offen offset:0
    buffer_load_dwordx2 v[116:117], v125, s[48:51], 0 offen offset:256
    buffer_load_dwordx2 v[118:119], v125, s[48:51], 0 offen offset:512
    buffer_load_dwordx2 v[120:121], v125, s[48:51], 0 offen offset:768
    buffer_load_dwordx2 v[122:123], v125, s[48:51], 0 offen offset:1024
    v_mov_b32 v26, 0
    v_mov_b32 v27, 0
    v_mov_b32 v28, 0
    v_mov_b32 v29, 0
    v_mov_b32 v14, 163824
    ds_write_b128 v14, v[26:29]
    s_waitcnt lgkmcnt(0)
    s_barrier
    s_branch L_compute
L_loaderA:
    s_cmp_lt_u32 s52, 4
    s_cbranch_scc1 L_computeA
    s_sub_u32 s52, s52, 4
    s_and_b32 s66, s53, 6
    s_lshr_b32 s68, s54, 3
    s_add_u32 s55, s66, s68
    s_and_b32 s67, s53, 1
    s_and_b32 s68, s54, 7
    s_lshl3_add_u32 s56, s67, s68
    s_mul_i32 s66, s52, 68
    v_lshrrev_b32 v40, 3, v0
    v_add_u32 v40, s66, v40
    v_bfe_u32 v41, v40, 1, 3
    v_and_b32 v42, 7, v0
    v_xor_b32 v41, v41, v42
    s_lshl_b32 s67, s55, 8
    s_sub_u32 s67, s67, 16
    v_add_u32 v40, s67, v40
    v_mul_i32_i24 v40, 1280, v40
    v_lshl_add_u32 v60, v41, 4, v40
    v_xor_b32 v61, 64, v60
    v_add_u32 v61, 10240, v61
    v_add_u32 v62, 20480, v60
    v_add_u32 v63, 20480, v61
    v_add_u32 v64, 20480, v62
    v_add_u32 v65, 20480, v63
    v_add_u32 v66, 20480, v64
    v_add_u32 v67, 20480, v65
    v_add_u32 v68, 20480, v66
    s_mul_i32 s74, s52, 8704
    s_movk_i32 s65, 1024
    s_lshr_b32 s66, s54, 2
    s_and_b32 s66, s66, 2
    s_add_u32 s66, s66, s54
    s_and_b32 s78, s66, 3
    s_mov_b32 s86, 0
    s_cmp_eq_u32 s78, 1
    s_cselect_b32 s86, 1, s86
    s_waitcnt lgkmcnt(0)
    s_bfe_u32 s70, s86, 0x40000
    s_mul_i32 s70, s70, 128
    s_add_u32 m0, s74, 0
    s_nop 0
    buffer_load_dwordx4 v60, s[8:11], s70 offen lds
    s_add_u32 m0, m0, s65
    s_nop 0
    buffer_load_dwordx4 v61, s[8:11], s70 offen lds
    s_add_u32 m0, m0, s65
    s_nop 0
    buffer_load_dwordx4 v62, s[8:11], s70 offen lds
    s_add_u32 m0, m0, s65
    s_nop 0
    buffer_load_dwordx4 v63, s[8:11], s70 offen lds
    s_add_u32 m0, m0, s65
    s_nop 0
    buffer_load_dwordx4 v64, s[8:11], s70 offen lds
    s_add_u32 m0, m0, s65
    s_nop 0
    buffer_load_dwordx4 v65, s[8:11], s70 offen lds
    s_add_u32 m0, m0, s65
    s_nop 0
    buffer_load_dwordx4 v66, s[8:11], s70 offen lds
    s_add_u32 m0, m0, s65
    s_nop 0
    buffer_load_dwordx4 v67, s[8:11], s70 offen lds
    s_add_u32 m0, m0, s65
    s_mov_b32 exec_hi, 0
    buffer_load_dwordx4 v68, s[8:11], s70 offen lds
    s_mov_b32 exec_hi, -1
    s_branch L_loaderA2
L_compute:
    s_mov_b32 s30, 12582912
    s_mov_b32 s31, 0x20000
    s_mov_b32 s14, 2457600
    s_mov_b32 s15, 0x20000
    s_mov_b32 s18, 819200
    s_mov_b32 s19, 0x20000
    s_mov_b32 s3, 0xffff0000
    v_and_b32 v1, 15, v0
    v_lshrrev_b32 v2, 4, v0
    s_mov_b32 s66, 8126464
    buffer_load_dword v21, v28, s[28:31], s66 offen sc1
    s_lshl2_add_u32 s68, s62, s52
    v_lshrrev_b32 v246, 2, v1
    v_and_b32 v247, 1, v2
    v_lshl_add_u32 v246, v247, 2, v246
    v_lshrrev_b32 v247, 1, v2
    v_lshl_add_u32 v247, v247, 4, v246
    v_and_b32 v248, 3, v1
    v_lshlrev_b32 v248, 3, v248
    v_lshrrev_b32 v134, 5, v0
    s_lshl_b32 s66, s52, 1
    v_add_u32 v134, s66, v134
    v_mul_u32_u24 v134, 1344, v134
    s_mul_i32 s69, s79, 10752
    s_add_u32 s69, s69, 142208
    v_add3_u32 v134, v134, v125, s69
    v_lshrrev_b32 v135, 2, v1
    v_mul_u32_u24 v135, 1344, v135
    v_lshl_add_u32 v135, v2, 5, v135
    s_lshl_b32 s66, s52, 7
    s_add_u32 s66, s66, s69
    v_add3_u32 v135, v135, v248, s66
    v_lshlrev_b32 v136, 4, v1
    v_lshl_add_u32 v136, v2, 10, v136
    s_lshr_b32 s66, s62, 2
    s_lshl_b32 s66, s66, 12
    s_and_b32 s67, s62, 3
    s_lshl_b32 s67, s67, 8
    s_add_u32 s66, s66, s67
    s_mul_i32 s67, s52, 278528
    s_add_u32 s66, s66, s67
    s_mov_b32 s70, s66
    s_add_u32 s71, s66, 1114112
    s_add_u32 s72, s66, 2228224
    v_mov_b32 v143, 0x3f803f80
    v_mov_b32 v138, 0
    v_mov_b32 v139, 0
    s_waitcnt vmcnt(6)
    v_dot2c_f32_bf16 v138, v104, v143
    v_dot2c_f32_bf16 v138, v105, v143
    v_dot2c_f32_bf16 v138, v106, v143
    v_dot2c_f32_bf16 v138, v107, v143
    v_dot2c_f32_bf16 v138, v108, v143
    v_dot2c_f32_bf16 v138, v109, v143
    v_dot2c_f32_bf16 v138, v110, v143
    v_dot2c_f32_bf16 v138, v111, v143
    v_dot2c_f32_bf16 v138, v112, v143
    v_dot2c_f32_bf16 v138, v113, v143
    v_lshlrev_b32 v144, 16, v104
    v_and_b32 v145, s3, v104
    v_lshlrev_b32 v146, 16, v105
    v_and_b32 v147, s3, v105
    v_lshlrev_b32 v148, 16, v106
    v_and_b32 v149, s3, v106
    v_lshlrev_b32 v150, 16, v107
    v_and_b32 v151, s3, v107
    v_lshlrev_b32 v152, 16, v108
    v_and_b32 v153, s3, v108
    v_lshlrev_b32 v154, 16, v109
    v_and_b32 v155, s3, v109
    v_lshlrev_b32 v156, 16, v110
    v_and_b32 v157, s3, v110
    v_lshlrev_b32 v158, 16, v111
    v_and_b32 v159, s3, v111
    v_lshlrev_b32 v160, 16, v112
    v_and_b32 v161, s3, v112
    v_lshlrev_b32 v162, 16, v113
    v_and_b32 v163, s3, v113
    v_add_f32_dpp v138, v138, v138 row_ror:8 row_mask:0xf bank_mask:0xf
    s_nop 1
    v_add_f32_dpp v138, v138, v138 row_ror:4 row_mask:0xf bank_mask:0xf
    s_nop 1
    v_add_f32_dpp v138, v138, v138 row_ror:2 row_mask:0xf bank_mask:0xf
    s_nop 1
    v_add_f32_dpp v138, v138, v138 row_ror:1 row_mask:0xf bank_mask:0xf
    v_mov_b32 v140, v138
    s_nop 1
    v_permlane16_swap_b32 v138, v140
    v_add_f32 v138, v138, v140
    v_mul_f32 v138, 0x3acccccd, v138
    v_cvt_pk_bf16_f32 v142, v138, v138
    v_and_b32 v142, s3, v142
    v_sub_f32 v143, v138, v142
    v_pk_add_f32 v[144:145], v[144:145], v[142:143] op_sel_hi:[1,0] neg_lo:[0,1] neg_hi:[0,1]
    v_pk_add_f32 v[146:147], v[146:147], v[142:143] op_sel_hi:[1,0] neg_lo:[0,1] neg_hi:[0,1]
    v_pk_add_f32 v[148:149], v[148:149], v[142:143] op_sel_hi:[1,0] neg_lo:[0,1] neg_hi:[0,1]
    v_pk_add_f32 v[150:151], v[150:151], v[142:143] op_sel_hi:[1,0] neg_lo:[0,1] neg_hi:[0,1]
    v_pk_add_f32 v[152:153], v[152:153], v[142:143] op_sel_hi:[1,0] neg_lo:[0,1] neg_hi:[0,1]
    v_pk_add_f32 v[154:155], v[154:155], v[142:143] op_sel_hi:[1,0] neg_lo:[0,1] neg_hi:[0,1]
    v_pk_add_f32 v[156:157], v[156:157], v[142:143] op_sel_hi:[1,0] neg_lo:[0,1] neg_hi:[0,1]
    v_pk_add_f32 v[158:159], v[158:159], v[142:143] op_sel_hi:[1,0] neg_lo:[0,1] neg_hi:[0,1]
    v_pk_add_f32 v[160:161], v[160:161], v[142:143] op_sel_hi:[1,0] neg_lo:[0,1] neg_hi:[0,1]
    v_pk_add_f32 v[162:163], v[162:163], v[142:143] op_sel_hi:[1,0] neg_lo:[0,1] neg_hi:[0,1]
    v_pk_mul_f32 v[140:141], v[144:145], v[144:145]
    v_pk_fma_f32 v[140:141], v[146:147], v[146:147], v[140:141]
    v_pk_fma_f32 v[140:141], v[148:149], v[148:149], v[140:141]
    v_pk_fma_f32 v[140:141], v[150:151], v[150:151], v[140:141]
    v_pk_fma_f32 v[140:141], v[152:153], v[152:153], v[140:141]
    v_pk_fma_f32 v[140:141], v[154:155], v[154:155], v[140:141]
    v_pk_fma_f32 v[140:141], v[156:157], v[156:157], v[140:141]
    v_pk_fma_f32 v[140:141], v[158:159], v[158:159], v[140:141]
    v_pk_fma_f32 v[140:141], v[160:161], v[160:161], v[140:141]
    v_pk_fma_f32 v[140:141], v[162:163], v[162:163], v[140:141]
    v_add_f32 v138, v140, v141
    s_nop 1
    v_add_f32_dpp v138, v138, v138 row_ror:8 row_mask:0xf bank_mask:0xf
    s_nop 1
    v_add_f32_dpp v138, v138, v138 row_ror:4 row_mask:0xf bank_mask:0xf
    s_nop 1
    v_add_f32_dpp v138, v138, v138 row_ror:2 row_mask:0xf bank_mask:0xf
    s_nop 1
    v_add_f32_dpp v138, v138, v138 row_ror:1 row_mask:0xf bank_mask:0xf
    v_mov_b32 v140, v138
    s_nop 1
    v_permlane16_swap_b32 v138, v140
    v_add_f32 v138, v138, v140
    v_cvt_pk_bf16_f32 v164, v144, v145
    v_cvt_pk_bf16_f32 v165, v146, v147
    v_cvt_pk_bf16_f32 v166, v148, v149
    v_cvt_pk_bf16_f32 v167, v150, v151
    v_cvt_pk_bf16_f32 v168, v152, v153
    v_cvt_pk_bf16_f32 v169, v154, v155
    v_cvt_pk_bf16_f32 v170, v156, v157
    v_cvt_pk_bf16_f32 v171, v158, v159
    v_cvt_pk_bf16_f32 v172, v160, v161
    v_cvt_pk_bf16_f32 v173, v162, v163
    v_mul_f32 v138, 0x3acccccd, v138
    v_fma_f32 v138, -v143, v143, v138
    v_cvt_pk_bf16_f32 v138, v138, v138
    v_and_b32 v138, s3, v138
    v_add_f32 v138, 0x3727c5ac, v138
    v_cvt_pk_bf16_f32 v138, v138, v138
    v_and_b32 v138, s3, v138
    v_sqrt_f32 v138, v138
    s_nop 0
    v_cvt_pk_bf16_f32 v138, v138, v138
    v_and_b32 v138, s3, v138
    v_rcp_f32 v142, v138
    v_lshlrev_b32 v144, 16, v164
    v_and_b32 v145, s3, v164
    v_lshlrev_b32 v146, 16, v165
    v_and_b32 v147, s3, v165
    v_lshlrev_b32 v148, 16, v166
    v_and_b32 v149, s3, v166
    v_lshlrev_b32 v150, 16, v167
    v_and_b32 v151, s3, v167
    v_lshlrev_b32 v152, 16, v168
    v_and_b32 v153, s3, v168
    v_lshlrev_b32 v154, 16, v169
    v_and_b32 v155, s3, v169
    v_lshlrev_b32 v156, 16, v170
    v_and_b32 v157, s3, v170
    v_lshlrev_b32 v158, 16, v171
    v_and_b32 v159, s3, v171
    v_lshlrev_b32 v160, 16, v172
    v_and_b32 v161, s3, v172
    v_lshlrev_b32 v162, 16, v173
    v_and_b32 v163, s3, v173
    v_pk_mul_f32 v[144:145], v[144:145], v[142:143] op_sel_hi:[1,0]
    v_pk_mul_f32 v[146:147], v[146:147], v[142:143] op_sel_hi:[1,0]
    v_pk_mul_f32 v[148:149], v[148:149], v[142:143] op_sel_hi:[1,0]
    v_pk_mul_f32 v[150:151], v[150:151], v[142:143] op_sel_hi:[1,0]
    v_pk_mul_f32 v[152:153], v[152:153], v[142:143] op_sel_hi:[1,0]
    v_pk_mul_f32 v[154:155], v[154:155], v[142:143] op_sel_hi:[1,0]
    v_pk_mul_f32 v[156:157], v[156:157], v[142:143] op_sel_hi:[1,0]
    v_pk_mul_f32 v[158:159], v[158:159], v[142:143] op_sel_hi:[1,0]
    v_pk_mul_f32 v[160:161], v[160:161], v[142:143] op_sel_hi:[1,0]
    v_pk_mul_f32 v[162:163], v[162:163], v[142:143] op_sel_hi:[1,0]
    v_cvt_pk_bf16_f32 v164, v144, v145
    v_cvt_pk_bf16_f32 v165, v146, v147
    v_cvt_pk_bf16_f32 v166, v148, v149
    v_cvt_pk_bf16_f32 v167, v150, v151
    v_cvt_pk_bf16_f32 v168, v152, v153
    v_cvt_pk_bf16_f32 v169, v154, v155
    v_cvt_pk_bf16_f32 v170, v156, v157
    v_cvt_pk_bf16_f32 v171, v158, v159
    v_cvt_pk_bf16_f32 v172, v160, v161
    v_cvt_pk_bf16_f32 v173, v162, v163
    ds_write_b64 v134, v[164:165] offset:0
    ds_write_b64 v134, v[166:167] offset:256
    ds_write_b64 v134, v[168:169] offset:512
    ds_write_b64 v134, v[170:171] offset:768
    ds_write_b64 v134, v[172:173] offset:1024
    s_waitcnt vmcnt(1)
    s_lshl2_add_u32 s66, s79, 163824
    v_mov_b32 v14, s66
    v_mov_b32 v15, 1
    s_waitcnt lgkmcnt(0)
    s_mov_b64 exec, 1
    ds_add_u32 v14, v15
    s_mov_b64 exec, -1
L_ln_meet:
    ds_read_b32 v15, v14
    s_waitcnt lgkmcnt(0)
    v_readfirstlane_b32 s69, v15
    s_nop 1
    s_cmp_lt_u32 s69, 4
    s_cbranch_scc1 L_ln_meet
    ds_read_b64_tr_b16 v[204:205], v135 offset:0
    ds_read_b64_tr_b16 v[206:207], v135 offset:5376
    s_waitcnt lgkmcnt(0)
    buffer_store_dwordx4 v[204:207], v136, s[28:31], s70 offen sc1
    ds_read_b64_tr_b16 v[208:209], v135 offset:512
    ds_read_b64_tr_b16 v[210:211], v135 offset:5888
    s_waitcnt lgkmcnt(0)
    buffer_store_dwordx4 v[208:211], v136, s[28:31], s71 offen sc1
    s_cmp_ge_u32 s52, 2
    s_cbranch_scc1 L_ln_done
    ds_read_b64_tr_b16 v[212:213], v135 offset:1024
    ds_read_b64_tr_b16 v[214:215], v135 offset:6400
    s_waitcnt lgkmcnt(0)
    buffer_store_dwordx4 v[212:215], v136, s[28:31], s72 offen sc1
L_ln_done:
    s_setprio 0
    s_lshl_b32 s66, s52, 6
    v_add_u32 v186, s66, v0
    v_mul_u32_u24 v187, 205, v186
    v_lshrrev_b32 v187, 11, v187
    v_mad_i32_i24 v188, v187, -10, v186
    s_and_b32 s66, s62, 31
    s_mul_i32 s66, s66, 20
    v_add_u32 v187, s66, v187
    v_bfe_u32 v189, v187, 2, 1
    v_bfe_u32 v190, v187, 3, 1
    v_xor_b32 v189, v189, v190
    v_mul_u32_u24 v189, 12, v189
    v_xor_b32 v187, v187, v189
    v_mul_u32_u24 v187, 1280, v187
    v_lshl_add_u32 v187, v188, 4, v187
    v_lshlrev_b32 v188, 4, v186
    v_mov_b32 v189, 12582912
    v_cmp_gt_u32 vcc, 200, v186
    s_nop 1
    v_cndmask_b32 v186, v189, v187, vcc
    v_cndmask_b32 v187, v189, v188, vcc
    s_lshr_b32 s78, s62, 5
    s_mul_i32 s78, s78, 160
    s_mul_i32 s73, s62, 3200
    s_add_u32 s73, s73, 11534336
    buffer_load_dwordx4 v[200:203], v186, s[16:19], s78 offen
    v_lshlrev_b32 v144, 16, v104
    v_and_b32 v145, s3, v104
    v_lshlrev_b32 v146, 16, v105
    v_and_b32 v147, s3, v105
    v_lshlrev_b32 v148, 16, v106
    v_and_b32 v149, s3, v106
    v_lshlrev_b32 v150, 16, v107
    v_and_b32 v151, s3, v107
    v_lshlrev_b32 v152, 16, v108
    v_and_b32 v153, s3, v108
    v_lshlrev_b32 v154, 16, v109
    v_and_b32 v155, s3, v109
    v_lshlrev_b32 v156, 16, v110
    v_and_b32 v157, s3, v110
    v_lshlrev_b32 v158, 16, v111
    v_and_b32 v159, s3, v111
    v_lshlrev_b32 v160, 16, v112
    v_and_b32 v161, s3, v112
    v_lshlrev_b32 v162, 16, v113
    v_and_b32 v163, s3, v113
    v_lshlrev_b32 v164, 16, v114
    v_and_b32 v165, s3, v114
    v_lshlrev_b32 v166, 16, v115
    v_and_b32 v167, s3, v115
    v_lshlrev_b32 v168, 16, v116
    v_and_b32 v169, s3, v116
    v_lshlrev_b32 v170, 16, v117
    v_and_b32 v171, s3, v117
    v_lshlrev_b32 v172, 16, v118
    v_and_b32 v173, s3, v118
    v_lshlrev_b32 v174, 16, v119
    v_and_b32 v175, s3, v119
    v_lshlrev_b32 v176, 16, v120
    v_and_b32 v177, s3, v120
    v_lshlrev_b32 v178, 16, v121
    v_and_b32 v179, s3, v121
    v_lshlrev_b32 v180, 16, v122
    v_and_b32 v181, s3, v122
    v_lshlrev_b32 v182, 16, v123
    v_and_b32 v183, s3, v123
    v_mov_b32 v143, 0x3f803f80
    v_pk_mul_f32 v[164:165], v[164:165], v[144:145]
    v_pk_mul_f32 v[166:167], v[166:167], v[146:147]
    v_pk_mul_f32 v[168:169], v[168:169], v[148:149]
    v_pk_mul_f32 v[170:171], v[170:171], v[150:151]
    v_pk_mul_f32 v[172:173], v[172:173], v[152:153]
    v_pk_mul_f32 v[174:175], v[174:175], v[154:155]
    v_pk_mul_f32 v[176:177], v[176:177], v[156:157]
    v_pk_mul_f32 v[178:179], v[178:179], v[158:159]
    v_pk_mul_f32 v[180:181], v[180:181], v[160:161]
    v_pk_mul_f32 v[182:183], v[182:183], v[162:163]
    v_cvt_pk_bf16_f32 v114, v164, v165
    v_cvt_pk_bf16_f32 v115, v166, v167
    v_cvt_pk_bf16_f32 v116, v168, v169
    v_cvt_pk_bf16_f32 v117, v170, v171
    v_cvt_pk_bf16_f32 v118, v172, v173
    v_cvt_pk_bf16_f32 v119, v174, v175
    v_cvt_pk_bf16_f32 v120, v176, v177
    v_cvt_pk_bf16_f32 v121, v178, v179
    v_cvt_pk_bf16_f32 v122, v180, v181
    v_cvt_pk_bf16_f32 v123, v182, v183
    v_dot2c_f32_bf16 v139, v114, v143
    v_dot2c_f32_bf16 v139, v115, v143
    v_dot2c_f32_bf16 v139, v116, v143
    v_dot2c_f32_bf16 v139, v117, v143
    v_dot2c_f32_bf16 v139, v118, v143
    v_dot2c_f32_bf16 v139, v119, v143
    v_dot2c_f32_bf16 v139, v120, v143
    v_dot2c_f32_bf16 v139, v121, v143
    v_dot2c_f32_bf16 v139, v122, v143
    v_dot2c_f32_bf16 v139, v123, v143
    s_nop 2
    v_add_f32_dpp v139, v139, v139 row_ror:8 row_mask:0xf bank_mask:0xf
    s_nop 1
    v_add_f32_dpp v139, v139, v139 row_ror:4 row_mask:0xf bank_mask:0xf
    s_nop 1
    v_add_f32_dpp v139, v139, v139 row_ror:2 row_mask:0xf bank_mask:0xf
    s_nop 1
    v_add_f32_dpp v139, v139, v139 row_ror:1 row_mask:0xf bank_mask:0xf
    v_mov_b32 v140, v139
    s_nop 1
    v_permlane16_swap_b32 v139, v140
    v_add_f32 v139, v139, v140
    v_cvt_pk_bf16_f32 v139, v139, v139
    v_and_b32 v139, s3, v139
    v_mul_f32 v139, 0xbfb8aa3b, v139
    v_exp_f32 v139, v139
    v_lshlrev_b32 v126, 2, v126
    v_add_f32 v139, 1.0, v139
    v_rcp_f32 v139, v139
    s_nop 0
    v_cvt_pk_bf16_f32 v139, v139, v139
    v_and_b32 v139, s3, v139
    s_waitcnt vmcnt(1)
    s_mov_b32 s66, 0x9e3779b1
    v_mul_lo_u32 v29, v21, s66
    v_add_u32 v29, 0x7f4a7c15, v29
    s_lshr_b32 s68, s62, 1
    s_lshl_b32 s68, s68, 7
    s_add_u32 s68, s68, 8060928
    s_mov_b64 exec, 1
    v_mov_b32 v9, 1
    v_mov_b32 v14, 163836
    ds_add_rtn_u32 v9, v14, v9
    s_waitcnt lgkmcnt(0)
    v_readfirstlane_b32 s67, v9
    s_nop 1
    s_cmp_eq_u32 s67, 7
    s_cselect_b32 s66, s68, 12582912
    s_mov_b32 exec_lo, -1
    s_mov_b32 exec_hi, 0
    v_lshlrev_b32 v9, 2, v0
    buffer_store_dword v29, v9, s[28:31], s66 offen sc1
    s_mov_b64 exec, -1
    s_setprio 2
    s_cmp_eq_u32 s79, 1
    s_cbranch_scc1 L_loaderB
L_computeB:
    s_lshl_b32 s66, s52, 12
    s_add_u32 s66, s66, 8060928
    v_and_b32 v14, 31, v0
    v_lshl_add_u32 v14, v14, 7, s66
    v_not_b32 v15, v29
    s_mov_b32 s42, 3072
    s_mov_b32 s43, 0x20000
    s_sub_u32 s69, s54, 16
    s_mul_i32 s68, s69, 205
    s_lshr_b32 s68, s68, 10
    s_lshr_b32 s66, s53, 1
    s_mul_i32 s58, s66, 3
    s_add_u32 s58, s58, s68
    s_mul_i32 s68, s68, 5
    s_sub_u32 s68, s69, s68
    s_and_b32 s67, s53, 1
    s_mul_i32 s57, s67, 5
    s_add_u32 s57, s57, s68
    s_cmp_lt_u32 s54, 31
    s_cselect_b32 s59, 1, 0
    s_mul_i32 s66, s57, 12
    s_add_u32 s66, s66, s58
    s_lshl_b32 s66, s66, 7
    s_add_u32 s66, s66, 7995392
    s_cmp_eq_u32 s59, 1
    s_cselect_b32 s64, s66, 12582912
    v_lshrrev_b32 v249, 1, v246
    v_lshl_add_u32 v249, v249, 5, v248
    v_lshl_add_u32 v249, v247, 7, v249
    s_and_b32 s66, s52, 1
    s_lshl_b32 s66, s66, 14
    v_add_u32 v3, s66, v249
    v_xor_b32 v4, 32, v3
    v_xor_b32 v5, 64, v3
    v_xor_b32 v6, 96, v3
    s_mov_b32 s46, 4096
    s_mov_b32 s47, 0x20000
    s_mov_b32 s38, 2621440
    s_mov_b32 s39, 0x20000
    s_lshr_b32 s66, s53, 1
    s_and_b32 s67, s53, 1
    s_lshr_b32 s68, s54, 2
    s_lshl3_add_u32 s60, s66, s68
    s_and_b32 s68, s54, 3
    s_lshl2_add_u32 s61, s67, s68
    v_lshrrev_b32 v246, 1, v246
    v_mul_u32_u24 v249, 160, v247
    v_add_u32 v12, v249, v248
    v_xor_b32 v249, s52, v246
    v_lshl_add_u32 v249, v249, 5, v248
    v_lshrrev_b32 v247, 2, v0
    v_lshl_add_u32 v10, v247, 7, v249
    v_lshlrev_b32 v11, 4, v0
    s_lshl_b32 s66, s52, 10
    s_add_u32 s66, s66, 20480
    v_add_u32 v13, s66, v11
    s_lshl_b32 s66, s60, 2
    s_add_u32 s66, s66, s52
    s_lshl_b32 s66, s66, 4
    v_add_u32 v20, s66, v1
    s_lshr_b32 s66, s52, 1
    s_lshl_b32 s66, s66, 11
    v_add_u32 v7, s66, v11
    s_and_b32 s66, s52, 1
    s_lshl1_add_u32 s66, s58, s66
    s_mul_i32 s67, s66, 10240
    s_add_u32 s67, s67, 3145728
    v_add_u32 v250, s67, v11
    s_lshl_b32 s66, s66, 7
    v_lshl_add_u32 v249, v2, 3, s66
    s_and_b32 s66, s52, 2
    s_lshl2_add_u32 s66, s57, s66
    s_add_u32 s66, s66, 0
    s_mul_i32 s67, s66, 205
    s_lshr_b32 s67, s67, 10
    s_mul_i32 s67, s67, 240640
    s_lshl_b32 s66, s66, 10
    s_add_u32 s66, s66, s67
    s_cmp_eq_u32 s59, 1
    s_cselect_b32 s86, s66, 12582912
    s_add_u32 s87, s86, 5120
    s_and_b32 s66, s52, 2
    s_lshl2_add_u32 s66, s57, s66
    s_add_u32 s66, s66, 1
    s_mul_i32 s67, s66, 205
    s_lshr_b32 s67, s67, 10
    s_mul_i32 s67, s67, 240640
    s_lshl_b32 s66, s66, 10
    s_add_u32 s66, s66, s67
    s_cmp_eq_u32 s59, 1
    s_cselect_b32 s88, s66, 12582912
    s_add_u32 s89, s88, 5120
    s_mov_b32 s67, 0x40000
    s_barrier
L_h_watch:
    v_cmp_eq_u32 vcc, v15, v29
    s_nop 1
    s_cmp_eq_u64 vcc, -1
    s_cbranch_scc1 L_h_there
    buffer_load_dword v15, v14, s[28:31], 0 offen sc1
    s_sub_u32 s67, s67, 1
    s_waitcnt vmcnt(0)
    s_cbranch_scc0 L_h_watch
L_h_there:
    s_barrier
    s_mov_b32 s67, 7864320
    s_mov_b32 exec_lo, 1
    s_mov_b32 exec_hi, 1
    buffer_store_dword v139, v126, s[28:31], s67 offen sc1
    s_mov_b64 exec, -1
    s_waitcnt vmcnt(1)
    buffer_store_dwordx4 v[200:203], v187, s[28:31], s73 offen sc1
    buffer_load_dwordx2 v[240:241], v249, s[40:43], 0 offen offset:0
    buffer_load_dwordx2 v[242:243], v249, s[40:43], 0 offen offset:32
    buffer_load_dwordx2 v[244:245], v249, s[40:43], 0 offen offset:64
    buffer_load_dwordx2 v[246:247], v249, s[40:43], 0 offen offset:96
    v_add_u32 v14, 0, v3
    v_add_u32 v15, 0, v4
    v_add_u32 v16, 0, v5
    v_add_u32 v17, 0, v6
    v_add_u32 v18, 32768, v7
    s_barrier
    ds_read_b128 v[80:83], v18 offset:0
    ds_read_b128 v[84:87], v18 offset:1024
    ds_read_b64_tr_b16 v[64:65], v14 offset:0
    ds_read_b64_tr_b16 v[66:67], v14 offset:1024
    ds_read_b64_tr_b16 v[68:69], v15 offset:0
    ds_read_b64_tr_b16 v[70:71], v15 offset:1024
    ds_read_b64_tr_b16 v[72:73], v16 offset:0
    ds_read_b64_tr_b16 v[74:75], v16 offset:1024
    ds_read_b64_tr_b16 v[76:77], v17 offset:0
    ds_read_b64_tr_b16 v[78:79], v17 offset:1024
    ds_read_b128 v[104:107], v18 offset:4096
    ds_read_b128 v[108:111], v18 offset:5120
    ds_read_b64_tr_b16 v[88:89], v14 offset:4096
    ds_read_b64_tr_b16 v[90:91], v14 offset:5120
    ds_read_b64_tr_b16 v[92:93], v15 offset:4096
    ds_read_b64_tr_b16 v[94:95], v15 offset:5120
    ds_read_b64_tr_b16 v[96:97], v16 offset:4096
    ds_read_b64_tr_b16 v[98:99], v16 offset:5120
    ds_read_b64_tr_b16 v[100:101], v17 offset:4096
    ds_read_b64_tr_b16 v[102:103], v17 offset:5120
    s_waitcnt lgkmcnt(15)
    v_mfma_f32_16x16x32_bf16 v[32:35], v[64:67], v[80:83], 0
    ds_read_b64_tr_b16 v[112:113], v14 offset:8192
    ds_read_b64_tr_b16 v[114:115], v14 offset:9216
    ds_read_b64_tr_b16 v[116:117], v15 offset:8192
    ds_read_b64_tr_b16 v[118:119], v15 offset:9216
    ds_read_b64_tr_b16 v[120:121], v16 offset:8192
    v_mfma_f32_16x16x32_bf16 v[48:51], v[64:67], v[84:87], 0
    ds_read_b64_tr_b16 v[122:123], v16 offset:9216
    ds_read_b64_tr_b16 v[124:125], v17 offset:8192
    s_waitcnt lgkmcnt(15)
    v_mfma_f32_16x16x32_bf16 v[36:39], v[68:71], v[80:83], 0
    ds_read_b64_tr_b16 v[126:127], v17 offset:9216
    ds_read_b128 v[128:131], v18 offset:8192
    v_mfma_f32_16x16x32_bf16 v[52:55], v[68:71], v[84:87], 0
    ds_read_b128 v[132:135], v18 offset:9216
    v_mfma_f32_16x16x32_bf16 v[40:43], v[72:75], v[80:83], 0
    ds_read_b64_tr_b16 v[136:137], v14 offset:12288
    ds_read_b64_tr_b16 v[138:139], v14 offset:13312
    v_mfma_f32_16x16x32_bf16 v[56:59], v[72:75], v[84:87], 0
    ds_read_b64_tr_b16 v[140:141], v15 offset:12288
    ds_read_b64_tr_b16 v[142:143], v15 offset:13312
    v_mfma_f32_16x16x32_bf16 v[44:47], v[76:79], v[80:83], 0
    ds_read_b64_tr_b16 v[144:145], v16 offset:12288
    ds_read_b64_tr_b16 v[146:147], v16 offset:13312
    v_mfma_f32_16x16x32_bf16 v[60:63], v[76:79], v[84:87], 0
    ds_read_b64_tr_b16 v[148:149], v17 offset:12288
    ds_read_b64_tr_b16 v[150:151], v17 offset:13312
    s_waitcnt lgkmcnt(15)
    v_mfma_f32_16x16x32_bf16 v[32:35], v[88:91], v[104:107], v[32:35]
    ds_read_b128 v[152:155], v18 offset:12288
    v_mfma_f32_16x16x32_bf16 v[48:51], v[88:91], v[108:111], v[48:51]
    ds_read_b128 v[156:159], v18 offset:13312
    v_mfma_f32_16x16x32_bf16 v[36:39], v[92:95], v[104:107], v[36:39]
    v_mfma_f32_16x16x32_bf16 v[52:55], v[92:95], v[108:111], v[52:55]
    v_mfma_f32_16x16x32_bf16 v[40:43], v[96:99], v[104:107], v[40:43]
    v_mfma_f32_16x16x32_bf16 v[56:59], v[96:99], v[108:111], v[56:59]
    v_mfma_f32_16x16x32_bf16 v[44:47], v[100:103], v[104:107], v[44:47]
    v_mfma_f32_16x16x32_bf16 v[60:63], v[100:103], v[108:111], v[60:63]
    s_waitcnt lgkmcnt(0)
    v_add_u32 v14, 49152, v3
    v_add_u32 v15, 49152, v4
    v_add_u32 v16, 49152, v5
    v_add_u32 v17, 49152, v6
    v_add_u32 v18, 81920, v7
    s_barrier
    ds_read_b128 v[80:83], v18 offset:0
    v_mfma_f32_16x16x32_bf16 v[32:35], v[112:115], v[128:131], v[32:35]
    ds_read_b128 v[84:87], v18 offset:1024
    v_mfma_f32_16x16x32_bf16 v[48:51], v[112:115], v[132:135], v[48:51]
    ds_read_b64_tr_b16 v[64:65], v14 offset:0
    ds_read_b64_tr_b16 v[66:67], v14 offset:1024
    v_mfma_f32_16x16x32_bf16 v[36:39], v[116:119], v[128:131], v[36:39]
    ds_read_b64_tr_b16 v[68:69], v15 offset:0
    ds_read_b64_tr_b16 v[70:71], v15 offset:1024
    v_mfma_f32_16x16x32_bf16 v[52:55], v[116:119], v[132:135], v[52:55]
    ds_read_b64_tr_b16 v[72:73], v16 offset:0
    v_mfma_f32_16x16x32_bf16 v[40:43], v[120:123], v[128:131], v[40:43]
    ds_read_b64_tr_b16 v[74:75], v16 offset:1024
    ds_read_b64_tr_b16 v[76:77], v17 offset:0
    v_mfma_f32_16x16x32_bf16 v[56:59], v[120:123], v[132:135], v[56:59]
    ds_read_b64_tr_b16 v[78:79], v17 offset:1024
    ds_read_b128 v[104:107], v18 offset:4096
    v_mfma_f32_16x16x32_bf16 v[44:47], v[124:127], v[128:131], v[44:47]
    ds_read_b128 v[108:111], v18 offset:5120
    v_mfma_f32_16x16x32_bf16 v[60:63], v[124:127], v[132:135], v[60:63]
    v_mfma_f32_16x16x32_bf16 v[32:35], v[136:139], v[152:155], v[32:35]
    ds_read_b64_tr_b16 v[88:89], v14 offset:4096
    ds_read_b64_tr_b16 v[90:91], v14 offset:5120
    v_mfma_f32_16x16x32_bf16 v[48:51], v[136:139], v[156:159], v[48:51]
    ds_read_b64_tr_b16 v[92:93], v15 offset:4096
    ds_read_b64_tr_b16 v[94:95], v15 offset:5120
    v_mfma_f32_16x16x32_bf16 v[36:39], v[140:143], v[152:155], v[36:39]
    ds_read_b64_tr_b16 v[96:97], v16 offset:4096
    ds_read_b64_tr_b16 v[98:99], v16 offset:5120
    v_mfma_f32_16x16x32_bf16 v[52:55], v[140:143], v[156:159], v[52:55]
    ds_read_b64_tr_b16 v[100:101], v17 offset:4096
    ds_read_b64_tr_b16 v[102:103], v17 offset:5120
    v_mfma_f32_16x16x32_bf16 v[40:43], v[144:147], v[152:155], v[40:43]
    ds_read_b64_tr_b16 v[112:113], v14 offset:8192
    v_mfma_f32_16x16x32_bf16 v[56:59], v[144:147], v[156:159], v[56:59]
    ds_read_b64_tr_b16 v[114:115], v14 offset:9216
    ds_read_b64_tr_b16 v[116:117], v15 offset:8192
    v_mfma_f32_16x16x32_bf16 v[44:47], v[148:151], v[152:155], v[44:47]
    ds_read_b64_tr_b16 v[118:119], v15 offset:9216
    ds_read_b64_tr_b16 v[120:121], v16 offset:8192
    v_mfma_f32_16x16x32_bf16 v[60:63], v[148:151], v[156:159], v[60:63]
    ds_read_b64_tr_b16 v[122:123], v16 offset:9216
    ds_read_b64_tr_b16 v[124:125], v17 offset:8192
    s_waitcnt lgkmcnt(15)
    v_mfma_f32_16x16x32_bf16 v[32:35], v[64:67], v[80:83], v[32:35]
    ds_read_b64_tr_b16 v[126:127], v17 offset:9216
    v_mfma_f32_16x16x32_bf16 v[48:51], v[64:67], v[84:87], v[48:51]
    ds_read_b128 v[128:131], v18 offset:8192
    v_mfma_f32_16x16x32_bf16 v[36:39], v[68:71], v[80:83], v[36:39]
    ds_read_b128 v[132:135], v18 offset:9216
    v_mfma_f32_16x16x32_bf16 v[52:55], v[68:71], v[84:87], v[52:55]
    ds_read_b64_tr_b16 v[136:137], v14 offset:12288
    ds_read_b64_tr_b16 v[138:139], v14 offset:13312
    v_mfma_f32_16x16x32_bf16 v[40:43], v[72:75], v[80:83], v[40:43]
    ds_read_b64_tr_b16 v[140:141], v15 offset:12288
    ds_read_b64_tr_b16 v[142:143], v15 offset:13312
    v_mfma_f32_16x16x32_bf16 v[56:59], v[72:75], v[84:87], v[56:59]
    ds_read_b64_tr_b16 v[144:145], v16 offset:12288
    v_mfma_f32_16x16x32_bf16 v[44:47], v[76:79], v[80:83], v[44:47]
    ds_read_b64_tr_b16 v[146:147], v16 offset:13312
    ds_read_b64_tr_b16 v[148:149], v17 offset:12288
    v_mfma_f32_16x16x32_bf16 v[60:63], v[76:79], v[84:87], v[60:63]
    ds_read_b64_tr_b16 v[150:151], v17 offset:13312
    ds_read_b128 v[152:155], v18 offset:12288
    s_waitcnt lgkmcnt(15)
    v_mfma_f32_16x16x32_bf16 v[32:35], v[88:91], v[104:107], v[32:35]
    ds_read_b128 v[156:159], v18 offset:13312
    v_mfma_f32_16x16x32_bf16 v[48:51], v[88:91], v[108:111], v[48:51]
    v_mfma_f32_16x16x32_bf16 v[36:39], v[92:95], v[104:107], v[36:39]
    v_mfma_f32_16x16x32_bf16 v[52:55], v[92:95], v[108:111], v[52:55]
    v_mfma_f32_16x16x32_bf16 v[40:43], v[96:99], v[104:107], v[40:43]
    v_mfma_f32_16x16x32_bf16 v[56:59], v[96:99], v[108:111], v[56:59]
    v_mfma_f32_16x16x32_bf16 v[44:47], v[100:103], v[104:107], v[44:47]
    v_mfma_f32_16x16x32_bf16 v[60:63], v[100:103], v[108:111], v[60:63]
    s_waitcnt lgkmcnt(0)
    v_add_u32 v14, 98304, v3
    v_add_u32 v15, 98304, v4
    v_add_u32 v16, 98304, v5
    v_add_u32 v17, 98304, v6
    v_add_u32 v18, 131072, v7
    s_barrier
    ds_read_b128 v[80:83], v18 offset:0
    v_mfma_f32_16x16x32_bf16 v[32:35], v[112:115], v[128:131], v[32:35]
    ds_read_b128 v[84:87], v18 offset:1024
    v_mfma_f32_16x16x32_bf16 v[48:51], v[112:115], v[132:135], v[48:51]
    ds_read_b64_tr_b16 v[64:65], v14 offset:0
    ds_read_b64_tr_b16 v[66:67], v14 offset:1024
    v_mfma_f32_16x16x32_bf16 v[36:39], v[116:119], v[128:131], v[36:39]
    ds_read_b64_tr_b16 v[68:69], v15 offset:0
    ds_read_b64_tr_b16 v[70:71], v15 offset:1024
    v_mfma_f32_16x16x32_bf16 v[52:55], v[116:119], v[132:135], v[52:55]
    ds_read_b64_tr_b16 v[72:73], v16 offset:0
    v_mfma_f32_16x16x32_bf16 v[40:43], v[120:123], v[128:131], v[40:43]
    ds_read_b64_tr_b16 v[74:75], v16 offset:1024
    ds_read_b64_tr_b16 v[76:77], v17 offset:0
    v_mfma_f32_16x16x32_bf16 v[56:59], v[120:123], v[132:135], v[56:59]
    ds_read_b64_tr_b16 v[78:79], v17 offset:1024
    ds_read_b128 v[104:107], v18 offset:4096
    v_mfma_f32_16x16x32_bf16 v[44:47], v[124:127], v[128:131], v[44:47]
    ds_read_b128 v[108:111], v18 offset:5120
    v_mfma_f32_16x16x32_bf16 v[60:63], v[124:127], v[132:135], v[60:63]
    v_mfma_f32_16x16x32_bf16 v[32:35], v[136:139], v[152:155], v[32:35]
    ds_read_b64_tr_b16 v[88:89], v14 offset:4096
    ds_read_b64_tr_b16 v[90:91], v14 offset:5120
    v_mfma_f32_16x16x32_bf16 v[48:51], v[136:139], v[156:159], v[48:51]
    ds_read_b64_tr_b16 v[92:93], v15 offset:4096
    ds_read_b64_tr_b16 v[94:95], v15 offset:5120
    v_mfma_f32_16x16x32_bf16 v[36:39], v[140:143], v[152:155], v[36:39]
    ds_read_b64_tr_b16 v[96:97], v16 offset:4096
    ds_read_b64_tr_b16 v[98:99], v16 offset:5120
    v_mfma_f32_16x16x32_bf16 v[52:55], v[140:143], v[156:159], v[52:55]
    ds_read_b64_tr_b16 v[100:101], v17 offset:4096
    ds_read_b64_tr_b16 v[102:103], v17 offset:5120
    v_mfma_f32_16x16x32_bf16 v[40:43], v[144:147], v[152:155], v[40:43]
    ds_read_b64_tr_b16 v[112:113], v14 offset:8192
    v_mfma_f32_16x16x32_bf16 v[56:59], v[144:147], v[156:159], v[56:59]
    ds_read_b64_tr_b16 v[114:115], v14 offset:9216
    ds_read_b64_tr_b16 v[116:117], v15 offset:8192
    v_mfma_f32_16x16x32_bf16 v[44:47], v[148:151], v[152:155], v[44:47]
    ds_read_b64_tr_b16 v[118:119], v15 offset:9216
    ds_read_b64_tr_b16 v[120:121], v16 offset:8192
    v_mfma_f32_16x16x32_bf16 v[60:63], v[148:151], v[156:159], v[60:63]
    ds_read_b64_tr_b16 v[122:123], v16 offset:9216
    ds_read_b64_tr_b16 v[124:125], v17 offset:8192
    s_waitcnt lgkmcnt(15)
    v_mfma_f32_16x16x32_bf16 v[32:35], v[64:67], v[80:83], v[32:35]
    ds_read_b64_tr_b16 v[126:127], v17 offset:9216
    v_mfma_f32_16x16x32_bf16 v[48:51], v[64:67], v[84:87], v[48:51]
    ds_read_b128 v[128:131], v18 offset:8192
    v_mfma_f32_16x16x32_bf16 v[36:39], v[68:71], v[80:83], v[36:39]
    ds_read_b128 v[132:135], v18 offset:9216
    v_mfma_f32_16x16x32_bf16 v[52:55], v[68:71], v[84:87], v[52:55]
    ds_read_b64_tr_b16 v[136:137], v14 offset:12288
    ds_read_b64_tr_b16 v[138:139], v14 offset:13312
    v_mfma_f32_16x16x32_bf16 v[40:43], v[72:75], v[80:83], v[40:43]
    ds_read_b64_tr_b16 v[140:141], v15 offset:12288
    ds_read_b64_tr_b16 v[142:143], v15 offset:13312
    v_mfma_f32_16x16x32_bf16 v[56:59], v[72:75], v[84:87], v[56:59]
    ds_read_b64_tr_b16 v[144:145], v16 offset:12288
    v_mfma_f32_16x16x32_bf16 v[44:47], v[76:79], v[80:83], v[44:47]
    ds_read_b64_tr_b16 v[146:147], v16 offset:13312
    ds_read_b64_tr_b16 v[148:149], v17 offset:12288
    v_mfma_f32_16x16x32_bf16 v[60:63], v[76:79], v[84:87], v[60:63]
    ds_read_b64_tr_b16 v[150:151], v17 offset:13312
    ds_read_b128 v[152:155], v18 offset:12288
    s_waitcnt lgkmcnt(15)
    v_mfma_f32_16x16x32_bf16 v[32:35], v[88:91], v[104:107], v[32:35]
    ds_read_b128 v[156:159], v18 offset:13312
    v_mfma_f32_16x16x32_bf16 v[48:51], v[88:91], v[108:111], v[48:51]
    v_mfma_f32_16x16x32_bf16 v[36:39], v[92:95], v[104:107], v[36:39]
    v_mfma_f32_16x16x32_bf16 v[52:55], v[92:95], v[108:111], v[52:55]
    v_mfma_f32_16x16x32_bf16 v[40:43], v[96:99], v[104:107], v[40:43]
    v_mfma_f32_16x16x32_bf16 v[56:59], v[96:99], v[108:111], v[56:59]
    v_mfma_f32_16x16x32_bf16 v[44:47], v[100:103], v[104:107], v[44:47]
    v_mfma_f32_16x16x32_bf16 v[60:63], v[100:103], v[108:111], v[60:63]
    s_waitcnt lgkmcnt(0)
    s_waitcnt vmcnt(0)
    v_add_u32 v14, 0, v3
    v_add_u32 v15, 0, v4
    v_add_u32 v16, 0, v5
    v_add_u32 v17, 0, v6
    v_add_u32 v18, 32768, v7
    s_barrier
    ds_read_b128 v[80:83], v18 offset:0
    s_lshr_b32 s68, s62, 1
    s_lshl_b32 s68, s68, 7
    s_add_u32 s68, s68, 8093696
    s_cmp_eq_u32 s52, 3
    s_cselect_b32 s68, s68, 12582912
    s_mov_b32 exec_lo, -1
    s_mov_b32 exec_hi, 0
    v_lshlrev_b32 v9, 2, v0
    buffer_store_dword v29, v9, s[28:31], s68 offen sc1
    s_mov_b64 exec, -1
    v_mfma_f32_16x16x32_bf16 v[32:35], v[112:115], v[128:131], v[32:35]
    ds_read_b128 v[84:87], v18 offset:1024
    v_mfma_f32_16x16x32_bf16 v[48:51], v[112:115], v[132:135], v[48:51]
    ds_read_b64_tr_b16 v[64:65], v14 offset:0
    ds_read_b64_tr_b16 v[66:67], v14 offset:1024
    v_mfma_f32_16x16x32_bf16 v[36:39], v[116:119], v[128:131], v[36:39]
    ds_read_b64_tr_b16 v[68:69], v15 offset:0
    ds_read_b64_tr_b16 v[70:71], v15 offset:1024
    v_mfma_f32_16x16x32_bf16 v[52:55], v[116:119], v[132:135], v[52:55]
    ds_read_b64_tr_b16 v[72:73], v16 offset:0
    v_mfma_f32_16x16x32_bf16 v[40:43], v[120:123], v[128:131], v[40:43]
    ds_read_b64_tr_b16 v[74:75], v16 offset:1024
    ds_read_b64_tr_b16 v[76:77], v17 offset:0
    v_mfma_f32_16x16x32_bf16 v[56:59], v[120:123], v[132:135], v[56:59]
    ds_read_b64_tr_b16 v[78:79], v17 offset:1024
    ds_read_b128 v[104:107], v18 offset:4096
    v_mfma_f32_16x16x32_bf16 v[44:47], v[124:127], v[128:131], v[44:47]
    ds_read_b128 v[108:111], v18 offset:5120
    v_mfma_f32_16x16x32_bf16 v[60:63], v[124:127], v[132:135], v[60:63]
    v_mfma_f32_16x16x32_bf16 v[32:35], v[136:139], v[152:155], v[32:35]
    ds_read_b64_tr_b16 v[88:89], v14 offset:4096
    ds_read_b64_tr_b16 v[90:91], v14 offset:5120
    v_mfma_f32_16x16x32_bf16 v[48:51], v[136:139], v[156:159], v[48:51]
    ds_read_b64_tr_b16 v[92:93], v15 offset:4096
    ds_read_b64_tr_b16 v[94:95], v15 offset:5120
    v_mfma_f32_16x16x32_bf16 v[36:39], v[140:143], v[152:155], v[36:39]
    ds_read_b64_tr_b16 v[96:97], v16 offset:4096
    ds_read_b64_tr_b16 v[98:99], v16 offset:5120
    v_mfma_f32_16x16x32_bf16 v[52:55], v[140:143], v[156:159], v[52:55]
    ds_read_b64_tr_b16 v[100:101], v17 offset:4096
    ds_read_b64_tr_b16 v[102:103], v17 offset:5120
    v_mfma_f32_16x16x32_bf16 v[40:43], v[144:147], v[152:155], v[40:43]
    ds_read_b64_tr_b16 v[112:113], v14 offset:8192
    v_mfma_f32_16x16x32_bf16 v[56:59], v[144:147], v[156:159], v[56:59]
    ds_read_b64_tr_b16 v[114:115], v14 offset:9216
    ds_read_b64_tr_b16 v[116:117], v15 offset:8192
    v_mfma_f32_16x16x32_bf16 v[44:47], v[148:151], v[152:155], v[44:47]
    ds_read_b64_tr_b16 v[118:119], v15 offset:9216
    ds_read_b64_tr_b16 v[120:121], v16 offset:8192
    v_mfma_f32_16x16x32_bf16 v[60:63], v[148:151], v[156:159], v[60:63]
    ds_read_b64_tr_b16 v[122:123], v16 offset:9216
    ds_read_b64_tr_b16 v[124:125], v17 offset:8192
    s_waitcnt lgkmcnt(15)
    v_mfma_f32_16x16x32_bf16 v[32:35], v[64:67], v[80:83], v[32:35]
    ds_read_b64_tr_b16 v[126:127], v17 offset:9216
    v_mfma_f32_16x16x32_bf16 v[48:51], v[64:67], v[84:87], v[48:51]
    ds_read_b128 v[128:131], v18 offset:8192
    v_mfma_f32_16x16x32_bf16 v[36:39], v[68:71], v[80:83], v[36:39]
    ds_read_b128 v[132:135], v18 offset:9216
    v_mfma_f32_16x16x32_bf16 v[52:55], v[68:71], v[84:87], v[52:55]
    ds_read_b64_tr_b16 v[136:137], v14 offset:12288
    ds_read_b64_tr_b16 v[138:139], v14 offset:13312
    v_mfma_f32_16x16x32_bf16 v[40:43], v[72:75], v[80:83], v[40:43]
    ds_read_b64_tr_b16 v[140:141], v15 offset:12288
    ds_read_b64_tr_b16 v[142:143], v15 offset:13312
    v_mfma_f32_16x16x32_bf16 v[56:59], v[72:75], v[84:87], v[56:59]
    ds_read_b64_tr_b16 v[144:145], v16 offset:12288
    v_mfma_f32_16x16x32_bf16 v[44:47], v[76:79], v[80:83], v[44:47]
    ds_read_b64_tr_b16 v[146:147], v16 offset:13312
    ds_read_b64_tr_b16 v[148:149], v17 offset:12288
    v_mfma_f32_16x16x32_bf16 v[60:63], v[76:79], v[84:87], v[60:63]
    ds_read_b64_tr_b16 v[150:151], v17 offset:13312
    ds_read_b128 v[152:155], v18 offset:12288
    s_waitcnt lgkmcnt(15)
    v_mfma_f32_16x16x32_bf16 v[32:35], v[88:91], v[104:107], v[32:35]
    ds_read_b128 v[156:159], v18 offset:13312
    v_mfma_f32_16x16x32_bf16 v[48:51], v[88:91], v[108:111], v[48:51]
    v_mfma_f32_16x16x32_bf16 v[36:39], v[92:95], v[104:107], v[36:39]
    v_mfma_f32_16x16x32_bf16 v[52:55], v[92:95], v[108:111], v[52:55]
    v_mfma_f32_16x16x32_bf16 v[40:43], v[96:99], v[104:107], v[40:43]
    v_mfma_f32_16x16x32_bf16 v[56:59], v[96:99], v[108:111], v[56:59]
    v_mfma_f32_16x16x32_bf16 v[44:47], v[100:103], v[104:107], v[44:47]
    v_mfma_f32_16x16x32_bf16 v[60:63], v[100:103], v[108:111], v[60:63]
    s_waitcnt lgkmcnt(0)
    v_add_u32 v14, 49152, v3
    v_add_u32 v15, 49152, v4
    v_add_u32 v16, 49152, v5
    v_add_u32 v17, 49152, v6
    v_add_u32 v18, 81920, v7
    s_barrier
    ds_read_b128 v[80:83], v18 offset:0
    v_mfma_f32_16x16x32_bf16 v[32:35], v[112:115], v[128:131], v[32:35]
    ds_read_b128 v[84:87], v18 offset:1024
    v_mfma_f32_16x16x32_bf16 v[48:51], v[112:115], v[132:135], v[48:51]
    ds_read_b64_tr_b16 v[64:65], v14 offset:0
    ds_read_b64_tr_b16 v[66:67], v14 offset:1024
    v_mfma_f32_16x16x32_bf16 v[36:39], v[116:119], v[128:131], v[36:39]
    ds_read_b64_tr_b16 v[68:69], v15 offset:0
    ds_read_b64_tr_b16 v[70:71], v15 offset:1024
    v_mfma_f32_16x16x32_bf16 v[52:55], v[116:119], v[132:135], v[52:55]
    ds_read_b64_tr_b16 v[72:73], v16 offset:0
    v_mfma_f32_16x16x32_bf16 v[40:43], v[120:123], v[128:131], v[40:43]
    ds_read_b64_tr_b16 v[74:75], v16 offset:1024
    ds_read_b64_tr_b16 v[76:77], v17 offset:0
    v_mfma_f32_16x16x32_bf16 v[56:59], v[120:123], v[132:135], v[56:59]
    ds_read_b64_tr_b16 v[78:79], v17 offset:1024
    ds_read_b128 v[104:107], v18 offset:4096
    v_mfma_f32_16x16x32_bf16 v[44:47], v[124:127], v[128:131], v[44:47]
    ds_read_b128 v[108:111], v18 offset:5120
    v_mfma_f32_16x16x32_bf16 v[60:63], v[124:127], v[132:135], v[60:63]
    v_mfma_f32_16x16x32_bf16 v[32:35], v[136:139], v[152:155], v[32:35]
    ds_read_b64_tr_b16 v[88:89], v14 offset:4096
    ds_read_b64_tr_b16 v[90:91], v14 offset:5120
    v_mfma_f32_16x16x32_bf16 v[48:51], v[136:139], v[156:159], v[48:51]
    ds_read_b64_tr_b16 v[92:93], v15 offset:4096
    ds_read_b64_tr_b16 v[94:95], v15 offset:5120
    v_mfma_f32_16x16x32_bf16 v[36:39], v[140:143], v[152:155], v[36:39]
    ds_read_b64_tr_b16 v[96:97], v16 offset:4096
    ds_read_b64_tr_b16 v[98:99], v16 offset:5120
    v_mfma_f32_16x16x32_bf16 v[52:55], v[140:143], v[156:159], v[52:55]
    ds_read_b64_tr_b16 v[100:101], v17 offset:4096
    ds_read_b64_tr_b16 v[102:103], v17 offset:5120
    v_mfma_f32_16x16x32_bf16 v[40:43], v[144:147], v[152:155], v[40:43]
    ds_read_b64_tr_b16 v[112:113], v14 offset:8192
    v_mfma_f32_16x16x32_bf16 v[56:59], v[144:147], v[156:159], v[56:59]
    ds_read_b64_tr_b16 v[114:115], v14 offset:9216
    ds_read_b64_tr_b16 v[116:117], v15 offset:8192
    v_mfma_f32_16x16x32_bf16 v[44:47], v[148:151], v[152:155], v[44:47]
    ds_read_b64_tr_b16 v[118:119], v15 offset:9216
    ds_read_b64_tr_b16 v[120:121], v16 offset:8192
    v_mfma_f32_16x16x32_bf16 v[60:63], v[148:151], v[156:159], v[60:63]
    ds_read_b64_tr_b16 v[122:123], v16 offset:9216
    ds_read_b64_tr_b16 v[124:125], v17 offset:8192
    s_waitcnt lgkmcnt(15)
    v_mfma_f32_16x16x32_bf16 v[32:35], v[64:67], v[80:83], v[32:35]
    ds_read_b64_tr_b16 v[126:127], v17 offset:9216
    v_mfma_f32_16x16x32_bf16 v[48:51], v[64:67], v[84:87], v[48:51]
    ds_read_b128 v[128:131], v18 offset:8192
    v_mfma_f32_16x16x32_bf16 v[36:39], v[68:71], v[80:83], v[36:39]
    ds_read_b128 v[132:135], v18 offset:9216
    v_mfma_f32_16x16x32_bf16 v[52:55], v[68:71], v[84:87], v[52:55]
    ds_read_b64_tr_b16 v[136:137], v14 offset:12288
    ds_read_b64_tr_b16 v[138:139], v14 offset:13312
    v_mfma_f32_16x16x32_bf16 v[40:43], v[72:75], v[80:83], v[40:43]
    ds_read_b64_tr_b16 v[140:141], v15 offset:12288
    ds_read_b64_tr_b16 v[142:143], v15 offset:13312
    v_mfma_f32_16x16x32_bf16 v[56:59], v[72:75], v[84:87], v[56:59]
    ds_read_b64_tr_b16 v[144:145], v16 offset:12288
    v_mfma_f32_16x16x32_bf16 v[44:47], v[76:79], v[80:83], v[44:47]
    ds_read_b64_tr_b16 v[146:147], v16 offset:13312
    ds_read_b64_tr_b16 v[148:149], v17 offset:12288
    v_mfma_f32_16x16x32_bf16 v[60:63], v[76:79], v[84:87], v[60:63]
    ds_read_b64_tr_b16 v[150:151], v17 offset:13312
    ds_read_b128 v[152:155], v18 offset:12288
    s_waitcnt lgkmcnt(15)
    v_mfma_f32_16x16x32_bf16 v[32:35], v[88:91], v[104:107], v[32:35]
    ds_read_b128 v[156:159], v18 offset:13312
    v_mfma_f32_16x16x32_bf16 v[48:51], v[88:91], v[108:111], v[48:51]
    v_mfma_f32_16x16x32_bf16 v[36:39], v[92:95], v[104:107], v[36:39]
    v_mfma_f32_16x16x32_bf16 v[52:55], v[92:95], v[108:111], v[52:55]
    v_mfma_f32_16x16x32_bf16 v[40:43], v[96:99], v[104:107], v[40:43]
    v_mfma_f32_16x16x32_bf16 v[56:59], v[96:99], v[108:111], v[56:59]
    v_mfma_f32_16x16x32_bf16 v[44:47], v[100:103], v[104:107], v[44:47]
    v_mfma_f32_16x16x32_bf16 v[60:63], v[100:103], v[108:111], v[60:63]
    s_waitcnt lgkmcnt(0)
    v_add_u32 v14, 98304, v3
    v_add_u32 v15, 98304, v4
    v_add_u32 v16, 98304, v5
    v_add_u32 v17, 98304, v6
    v_add_u32 v18, 131072, v7
    s_barrier
    ds_read_b128 v[80:83], v18 offset:0
    v_mfma_f32_16x16x32_bf16 v[32:35], v[112:115], v[128:131], v[32:35]
    ds_read_b128 v[84:87], v18 offset:1024
    v_mfma_f32_16x16x32_bf16 v[48:51], v[112:115], v[132:135], v[48:51]
    ds_read_b64_tr_b16 v[64:65], v14 offset:0
    ds_read_b64_tr_b16 v[66:67], v14 offset:1024
    v_mfma_f32_16x16x32_bf16 v[36:39], v[116:119], v[128:131], v[36:39]
    ds_read_b64_tr_b16 v[68:69], v15 offset:0
    ds_read_b64_tr_b16 v[70:71], v15 offset:1024
    v_mfma_f32_16x16x32_bf16 v[52:55], v[116:119], v[132:135], v[52:55]
    ds_read_b64_tr_b16 v[72:73], v16 offset:0
    v_mfma_f32_16x16x32_bf16 v[40:43], v[120:123], v[128:131], v[40:43]
    ds_read_b64_tr_b16 v[74:75], v16 offset:1024
    ds_read_b64_tr_b16 v[76:77], v17 offset:0
    v_mfma_f32_16x16x32_bf16 v[56:59], v[120:123], v[132:135], v[56:59]
    ds_read_b64_tr_b16 v[78:79], v17 offset:1024
    ds_read_b128 v[104:107], v18 offset:4096
    v_mfma_f32_16x16x32_bf16 v[44:47], v[124:127], v[128:131], v[44:47]
    ds_read_b128 v[108:111], v18 offset:5120
    v_mfma_f32_16x16x32_bf16 v[60:63], v[124:127], v[132:135], v[60:63]
    v_mfma_f32_16x16x32_bf16 v[32:35], v[136:139], v[152:155], v[32:35]
    ds_read_b64_tr_b16 v[88:89], v14 offset:4096
    ds_read_b64_tr_b16 v[90:91], v14 offset:5120
    v_mfma_f32_16x16x32_bf16 v[48:51], v[136:139], v[156:159], v[48:51]
    ds_read_b64_tr_b16 v[92:93], v15 offset:4096
    ds_read_b64_tr_b16 v[94:95], v15 offset:5120
    v_mfma_f32_16x16x32_bf16 v[36:39], v[140:143], v[152:155], v[36:39]
    ds_read_b64_tr_b16 v[96:97], v16 offset:4096
    ds_read_b64_tr_b16 v[98:99], v16 offset:5120
    v_mfma_f32_16x16x32_bf16 v[52:55], v[140:143], v[156:159], v[52:55]
    ds_read_b64_tr_b16 v[100:101], v17 offset:4096
    ds_read_b64_tr_b16 v[102:103], v17 offset:5120
    v_mfma_f32_16x16x32_bf16 v[40:43], v[144:147], v[152:155], v[40:43]
    ds_read_b64_tr_b16 v[112:113], v14 offset:8192
    v_mfma_f32_16x16x32_bf16 v[56:59], v[144:147], v[156:159], v[56:59]
    ds_read_b64_tr_b16 v[114:115], v14 offset:9216
    ds_read_b64_tr_b16 v[116:117], v15 offset:8192
    v_mfma_f32_16x16x32_bf16 v[44:47], v[148:151], v[152:155], v[44:47]
    ds_read_b64_tr_b16 v[118:119], v15 offset:9216
    ds_read_b64_tr_b16 v[120:121], v16 offset:8192
    v_mfma_f32_16x16x32_bf16 v[60:63], v[148:151], v[156:159], v[60:63]
    ds_read_b64_tr_b16 v[122:123], v16 offset:9216
    ds_read_b64_tr_b16 v[124:125], v17 offset:8192
    s_waitcnt lgkmcnt(15)
    v_mfma_f32_16x16x32_bf16 v[32:35], v[64:67], v[80:83], v[32:35]
    ds_read_b64_tr_b16 v[126:127], v17 offset:9216
    v_mfma_f32_16x16x32_bf16 v[48:51], v[64:67], v[84:87], v[48:51]
    ds_read_b128 v[128:131], v18 offset:8192
    v_mfma_f32_16x16x32_bf16 v[36:39], v[68:71], v[80:83], v[36:39]
    ds_read_b128 v[132:135], v18 offset:9216
    v_mfma_f32_16x16x32_bf16 v[52:55], v[68:71], v[84:87], v[52:55]
    ds_read_b64_tr_b16 v[136:137], v14 offset:12288
    ds_read_b64_tr_b16 v[138:139], v14 offset:13312
    v_mfma_f32_16x16x32_bf16 v[40:43], v[72:75], v[80:83], v[40:43]
    ds_read_b64_tr_b16 v[140:141], v15 offset:12288
    ds_read_b64_tr_b16 v[142:143], v15 offset:13312
    v_mfma_f32_16x16x32_bf16 v[56:59], v[72:75], v[84:87], v[56:59]
    ds_read_b64_tr_b16 v[144:145], v16 offset:12288
    v_mfma_f32_16x16x32_bf16 v[44:47], v[76:79], v[80:83], v[44:47]
    ds_read_b64_tr_b16 v[146:147], v16 offset:13312
    ds_read_b64_tr_b16 v[148:149], v17 offset:12288
    v_mfma_f32_16x16x32_bf16 v[60:63], v[76:79], v[84:87], v[60:63]
    ds_read_b64_tr_b16 v[150:151], v17 offset:13312
    ds_read_b128 v[152:155], v18 offset:12288
    s_waitcnt lgkmcnt(15)
    v_mfma_f32_16x16x32_bf16 v[32:35], v[88:91], v[104:107], v[32:35]
    ds_read_b128 v[156:159], v18 offset:13312
    v_mfma_f32_16x16x32_bf16 v[48:51], v[88:91], v[108:111], v[48:51]
    v_mfma_f32_16x16x32_bf16 v[36:39], v[92:95], v[104:107], v[36:39]
    v_mfma_f32_16x16x32_bf16 v[52:55], v[92:95], v[108:111], v[52:55]
    v_mfma_f32_16x16x32_bf16 v[40:43], v[96:99], v[104:107], v[40:43]
    v_mfma_f32_16x16x32_bf16 v[56:59], v[96:99], v[108:111], v[56:59]
    v_mfma_f32_16x16x32_bf16 v[44:47], v[100:103], v[104:107], v[44:47]
    v_mfma_f32_16x16x32_bf16 v[60:63], v[100:103], v[108:111], v[60:63]
    s_waitcnt lgkmcnt(0)
    v_add_u32 v14, 0, v3
    v_add_u32 v15, 0, v4
    v_add_u32 v16, 0, v5
    v_add_u32 v17, 0, v6
    v_add_u32 v18, 32768, v7
    s_barrier
    ds_read_b128 v[80:83], v18 offset:0
    v_mfma_f32_16x16x32_bf16 v[32:35], v[112:115], v[128:131], v[32:35]
    ds_read_b128 v[84:87], v18 offset:1024
    v_mfma_f32_16x16x32_bf16 v[48:51], v[112:115], v[132:135], v[48:51]
    ds_read_b64_tr_b16 v[64:65], v14 offset:0
    ds_read_b64_tr_b16 v[66:67], v14 offset:1024
    v_mfma_f32_16x16x32_bf16 v[36:39], v[116:119], v[128:131], v[36:39]
    ds_read_b64_tr_b16 v[68:69], v15 offset:0
    ds_read_b64_tr_b16 v[70:71], v15 offset:1024
    v_mfma_f32_16x16x32_bf16 v[52:55], v[116:119], v[132:135], v[52:55]
    ds_read_b64_tr_b16 v[72:73], v16 offset:0
    v_mfma_f32_16x16x32_bf16 v[40:43], v[120:123], v[128:131], v[40:43]
    ds_read_b64_tr_b16 v[74:75], v16 offset:1024
    ds_read_b64_tr_b16 v[76:77], v17 offset:0
    v_mfma_f32_16x16x32_bf16 v[56:59], v[120:123], v[132:135], v[56:59]
    ds_read_b64_tr_b16 v[78:79], v17 offset:1024
    ds_read_b128 v[104:107], v18 offset:4096
    v_mfma_f32_16x16x32_bf16 v[44:47], v[124:127], v[128:131], v[44:47]
    ds_read_b128 v[108:111], v18 offset:5120
    v_mfma_f32_16x16x32_bf16 v[60:63], v[124:127], v[132:135], v[60:63]
    v_mfma_f32_16x16x32_bf16 v[32:35], v[136:139], v[152:155], v[32:35]
    ds_read_b64_tr_b16 v[88:89], v14 offset:4096
    ds_read_b64_tr_b16 v[90:91], v14 offset:5120
    v_mfma_f32_16x16x32_bf16 v[48:51], v[136:139], v[156:159], v[48:51]
    ds_read_b64_tr_b16 v[92:93], v15 offset:4096
    ds_read_b64_tr_b16 v[94:95], v15 offset:5120
    v_mfma_f32_16x16x32_bf16 v[36:39], v[140:143], v[152:155], v[36:39]
    ds_read_b64_tr_b16 v[96:97], v16 offset:4096
    ds_read_b64_tr_b16 v[98:99], v16 offset:5120
    v_mfma_f32_16x16x32_bf16 v[52:55], v[140:143], v[156:159], v[52:55]
    ds_read_b64_tr_b16 v[100:101], v17 offset:4096
    ds_read_b64_tr_b16 v[102:103], v17 offset:5120
    v_mfma_f32_16x16x32_bf16 v[40:43], v[144:147], v[152:155], v[40:43]
    ds_read_b64_tr_b16 v[112:113], v14 offset:8192
    v_mfma_f32_16x16x32_bf16 v[56:59], v[144:147], v[156:159], v[56:59]
    ds_read_b64_tr_b16 v[114:115], v14 offset:9216
    ds_read_b64_tr_b16 v[116:117], v15 offset:8192
    v_mfma_f32_16x16x32_bf16 v[44:47], v[148:151], v[152:155], v[44:47]
    ds_read_b64_tr_b16 v[118:119], v15 offset:9216
    ds_read_b64_tr_b16 v[120:121], v16 offset:8192
    v_mfma_f32_16x16x32_bf16 v[60:63], v[148:151], v[156:159], v[60:63]
    ds_read_b64_tr_b16 v[122:123], v16 offset:9216
    ds_read_b64_tr_b16 v[124:125], v17 offset:8192
    s_waitcnt lgkmcnt(15)
    v_mfma_f32_16x16x32_bf16 v[32:35], v[64:67], v[80:83], v[32:35]
    ds_read_b64_tr_b16 v[126:127], v17 offset:9216
    v_mfma_f32_16x16x32_bf16 v[48:51], v[64:67], v[84:87], v[48:51]
    ds_read_b128 v[128:131], v18 offset:8192
    v_mfma_f32_16x16x32_bf16 v[36:39], v[68:71], v[80:83], v[36:39]
    ds_read_b128 v[132:135], v18 offset:9216
    v_mfma_f32_16x16x32_bf16 v[52:55], v[68:71], v[84:87], v[52:55]
    ds_read_b64_tr_b16 v[136:137], v14 offset:12288
    ds_read_b64_tr_b16 v[138:139], v14 offset:13312
    v_mfma_f32_16x16x32_bf16 v[40:43], v[72:75], v[80:83], v[40:43]
    ds_read_b64_tr_b16 v[140:141], v15 offset:12288
    ds_read_b64_tr_b16 v[142:143], v15 offset:13312
    v_mfma_f32_16x16x32_bf16 v[56:59], v[72:75], v[84:87], v[56:59]
    ds_read_b64_tr_b16 v[144:145], v16 offset:12288
    v_mfma_f32_16x16x32_bf16 v[44:47], v[76:79], v[80:83], v[44:47]
    ds_read_b64_tr_b16 v[146:147], v16 offset:13312
    ds_read_b64_tr_b16 v[148:149], v17 offset:12288
    v_mfma_f32_16x16x32_bf16 v[60:63], v[76:79], v[84:87], v[60:63]
    ds_read_b64_tr_b16 v[150:151], v17 offset:13312
    ds_read_b128 v[152:155], v18 offset:12288
    s_waitcnt lgkmcnt(15)
    v_mfma_f32_16x16x32_bf16 v[32:35], v[88:91], v[104:107], v[32:35]
    ds_read_b128 v[156:159], v18 offset:13312
    v_mfma_f32_16x16x32_bf16 v[48:51], v[88:91], v[108:111], v[48:51]
    v_mfma_f32_16x16x32_bf16 v[36:39], v[92:95], v[104:107], v[36:39]
    v_mfma_f32_16x16x32_bf16 v[52:55], v[92:95], v[108:111], v[52:55]
    v_mfma_f32_16x16x32_bf16 v[40:43], v[96:99], v[104:107], v[40:43]
    v_mfma_f32_16x16x32_bf16 v[56:59], v[96:99], v[108:111], v[56:59]
    v_mfma_f32_16x16x32_bf16 v[44:47], v[100:103], v[104:107], v[44:47]
    v_mfma_f32_16x16x32_bf16 v[60:63], v[100:103], v[108:111], v[60:63]
    s_waitcnt lgkmcnt(0)
    v_add_u32 v14, 49152, v3
    v_add_u32 v15, 49152, v4
    v_add_u32 v16, 49152, v5
    v_add_u32 v17, 49152, v6
    v_add_u32 v18, 81920, v7
    s_barrier
    ds_read_b128 v[80:83], v18 offset:0
    v_mfma_f32_16x16x32_bf16 v[32:35], v[112:115], v[128:131], v[32:35]
    ds_read_b128 v[84:87], v18 offset:1024
    v_mfma_f32_16x16x32_bf16 v[48:51], v[112:115], v[132:135], v[48:51]
    ds_read_b64_tr_b16 v[64:65], v14 offset:0
    ds_read_b64_tr_b16 v[66:67], v14 offset:1024
    v_mfma_f32_16x16x32_bf16 v[36:39], v[116:119], v[128:131], v[36:39]
    ds_read_b64_tr_b16 v[68:69], v15 offset:0
    ds_read_b64_tr_b16 v[70:71], v15 offset:1024
    v_mfma_f32_16x16x32_bf16 v[52:55], v[116:119], v[132:135], v[52:55]
    ds_read_b64_tr_b16 v[72:73], v16 offset:0
    v_mfma_f32_16x16x32_bf16 v[40:43], v[120:123], v[128:131], v[40:43]
    ds_read_b64_tr_b16 v[74:75], v16 offset:1024
    ds_read_b64_tr_b16 v[76:77], v17 offset:0
    v_mfma_f32_16x16x32_bf16 v[56:59], v[120:123], v[132:135], v[56:59]
    ds_read_b64_tr_b16 v[78:79], v17 offset:1024
    ds_read_b128 v[104:107], v18 offset:4096
    v_mfma_f32_16x16x32_bf16 v[44:47], v[124:127], v[128:131], v[44:47]
    ds_read_b128 v[108:111], v18 offset:5120
    v_mfma_f32_16x16x32_bf16 v[60:63], v[124:127], v[132:135], v[60:63]
    v_mfma_f32_16x16x32_bf16 v[32:35], v[136:139], v[152:155], v[32:35]
    ds_read_b64_tr_b16 v[88:89], v14 offset:4096
    ds_read_b64_tr_b16 v[90:91], v14 offset:5120
    v_mfma_f32_16x16x32_bf16 v[48:51], v[136:139], v[156:159], v[48:51]
    ds_read_b64_tr_b16 v[92:93], v15 offset:4096
    ds_read_b64_tr_b16 v[94:95], v15 offset:5120
    v_mfma_f32_16x16x32_bf16 v[36:39], v[140:143], v[152:155], v[36:39]
    ds_read_b64_tr_b16 v[96:97], v16 offset:4096
    ds_read_b64_tr_b16 v[98:99], v16 offset:5120
    v_mfma_f32_16x16x32_bf16 v[52:55], v[140:143], v[156:159], v[52:55]
    ds_read_b64_tr_b16 v[100:101], v17 offset:4096
    ds_read_b64_tr_b16 v[102:103], v17 offset:5120
    v_mfma_f32_16x16x32_bf16 v[40:43], v[144:147], v[152:155], v[40:43]
    ds_read_b64_tr_b16 v[112:113], v14 offset:8192
    v_mfma_f32_16x16x32_bf16 v[56:59], v[144:147], v[156:159], v[56:59]
    ds_read_b64_tr_b16 v[114:115], v14 offset:9216
    ds_read_b64_tr_b16 v[116:117], v15 offset:8192
    v_mfma_f32_16x16x32_bf16 v[44:47], v[148:151], v[152:155], v[44:47]
    ds_read_b64_tr_b16 v[118:119], v15 offset:9216
    ds_read_b64_tr_b16 v[120:121], v16 offset:8192
    v_mfma_f32_16x16x32_bf16 v[60:63], v[148:151], v[156:159], v[60:63]
    ds_read_b64_tr_b16 v[122:123], v16 offset:9216
    ds_read_b64_tr_b16 v[124:125], v17 offset:8192
    s_waitcnt lgkmcnt(15)
    v_mfma_f32_16x16x32_bf16 v[32:35], v[64:67], v[80:83], v[32:35]
    ds_read_b64_tr_b16 v[126:127], v17 offset:9216
    v_mfma_f32_16x16x32_bf16 v[48:51], v[64:67], v[84:87], v[48:51]
    ds_read_b128 v[128:131], v18 offset:8192
    v_mfma_f32_16x16x32_bf16 v[36:39], v[68:71], v[80:83], v[36:39]
    ds_read_b128 v[132:135], v18 offset:9216
    v_mfma_f32_16x16x32_bf16 v[52:55], v[68:71], v[84:87], v[52:55]
    ds_read_b64_tr_b16 v[136:137], v14 offset:12288
    ds_read_b64_tr_b16 v[138:139], v14 offset:13312
    v_mfma_f32_16x16x32_bf16 v[40:43], v[72:75], v[80:83], v[40:43]
    ds_read_b64_tr_b16 v[140:141], v15 offset:12288
    ds_read_b64_tr_b16 v[142:143], v15 offset:13312
    v_mfma_f32_16x16x32_bf16 v[56:59], v[72:75], v[84:87], v[56:59]
    ds_read_b64_tr_b16 v[144:145], v16 offset:12288
    v_mfma_f32_16x16x32_bf16 v[44:47], v[76:79], v[80:83], v[44:47]
    ds_read_b64_tr_b16 v[146:147], v16 offset:13312
    ds_read_b64_tr_b16 v[148:149], v17 offset:12288
    v_mfma_f32_16x16x32_bf16 v[60:63], v[76:79], v[84:87], v[60:63]
    ds_read_b64_tr_b16 v[150:151], v17 offset:13312
    ds_read_b128 v[152:155], v18 offset:12288
    s_waitcnt lgkmcnt(15)
    v_mfma_f32_16x16x32_bf16 v[32:35], v[88:91], v[104:107], v[32:35]
    ds_read_b128 v[156:159], v18 offset:13312
    v_mfma_f32_16x16x32_bf16 v[48:51], v[88:91], v[108:111], v[48:51]
    v_mfma_f32_16x16x32_bf16 v[36:39], v[92:95], v[104:107], v[36:39]
    v_mfma_f32_16x16x32_bf16 v[52:55], v[92:95], v[108:111], v[52:55]
    v_mfma_f32_16x16x32_bf16 v[40:43], v[96:99], v[104:107], v[40:43]
    v_mfma_f32_16x16x32_bf16 v[56:59], v[96:99], v[108:111], v[56:59]
    v_mfma_f32_16x16x32_bf16 v[44:47], v[100:103], v[104:107], v[44:47]
    v_mfma_f32_16x16x32_bf16 v[60:63], v[100:103], v[108:111], v[60:63]
    s_waitcnt lgkmcnt(0)
    v_add_u32 v14, 98304, v3
    v_add_u32 v15, 98304, v4
    v_add_u32 v16, 98304, v5
    v_add_u32 v17, 98304, v6
    v_add_u32 v18, 131072, v7
    s_barrier
    ds_read_b128 v[80:83], v18 offset:0
    v_mfma_f32_16x16x32_bf16 v[32:35], v[112:115], v[128:131], v[32:35]
    ds_read_b128 v[84:87], v18 offset:1024
    v_mfma_f32_16x16x32_bf16 v[48:51], v[112:115], v[132:135], v[48:51]
    ds_read_b64_tr_b16 v[64:65], v14 offset:0
    ds_read_b64_tr_b16 v[66:67], v14 offset:1024
    v_mfma_f32_16x16x32_bf16 v[36:39], v[116:119], v[128:131], v[36:39]
    ds_read_b64_tr_b16 v[68:69], v15 offset:0
    ds_read_b64_tr_b16 v[70:71], v15 offset:1024
    v_mfma_f32_16x16x32_bf16 v[52:55], v[116:119], v[132:135], v[52:55]
    ds_read_b64_tr_b16 v[72:73], v16 offset:0
    v_mfma_f32_16x16x32_bf16 v[40:43], v[120:123], v[128:131], v[40:43]
    ds_read_b64_tr_b16 v[74:75], v16 offset:1024
    ds_read_b64_tr_b16 v[76:77], v17 offset:0
    v_mfma_f32_16x16x32_bf16 v[56:59], v[120:123], v[132:135], v[56:59]
    ds_read_b64_tr_b16 v[78:79], v17 offset:1024
    ds_read_b128 v[104:107], v18 offset:4096
    v_mfma_f32_16x16x32_bf16 v[44:47], v[124:127], v[128:131], v[44:47]
    ds_read_b128 v[108:111], v18 offset:5120
    v_mfma_f32_16x16x32_bf16 v[60:63], v[124:127], v[132:135], v[60:63]
    v_mfma_f32_16x16x32_bf16 v[32:35], v[136:139], v[152:155], v[32:35]
    ds_read_b64_tr_b16 v[88:89], v14 offset:4096
    ds_read_b64_tr_b16 v[90:91], v14 offset:5120
    v_mfma_f32_16x16x32_bf16 v[48:51], v[136:139], v[156:159], v[48:51]
    ds_read_b64_tr_b16 v[92:93], v15 offset:4096
    ds_read_b64_tr_b16 v[94:95], v15 offset:5120
    v_mfma_f32_16x16x32_bf16 v[36:39], v[140:143], v[152:155], v[36:39]
    ds_read_b64_tr_b16 v[96:97], v16 offset:4096
    ds_read_b64_tr_b16 v[98:99], v16 offset:5120
    v_mfma_f32_16x16x32_bf16 v[52:55], v[140:143], v[156:159], v[52:55]
    ds_read_b64_tr_b16 v[100:101], v17 offset:4096
    ds_read_b64_tr_b16 v[102:103], v17 offset:5120
    v_mfma_f32_16x16x32_bf16 v[40:43], v[144:147], v[152:155], v[40:43]
    ds_read_b64_tr_b16 v[112:113], v14 offset:8192
    v_mfma_f32_16x16x32_bf16 v[56:59], v[144:147], v[156:159], v[56:59]
    ds_read_b64_tr_b16 v[114:115], v14 offset:9216
    ds_read_b64_tr_b16 v[116:117], v15 offset:8192
    v_mfma_f32_16x16x32_bf16 v[44:47], v[148:151], v[152:155], v[44:47]
    ds_read_b64_tr_b16 v[118:119], v15 offset:9216
    ds_read_b64_tr_b16 v[120:121], v16 offset:8192
    v_mfma_f32_16x16x32_bf16 v[60:63], v[148:151], v[156:159], v[60:63]
    ds_read_b64_tr_b16 v[122:123], v16 offset:9216
    ds_read_b64_tr_b16 v[124:125], v17 offset:8192
    s_waitcnt lgkmcnt(15)
    v_mfma_f32_16x16x32_bf16 v[32:35], v[64:67], v[80:83], v[32:35]
    ds_read_b64_tr_b16 v[126:127], v17 offset:9216
    v_mfma_f32_16x16x32_bf16 v[48:51], v[64:67], v[84:87], v[48:51]
    ds_read_b128 v[128:131], v18 offset:8192
    v_mfma_f32_16x16x32_bf16 v[36:39], v[68:71], v[80:83], v[36:39]
    ds_read_b128 v[132:135], v18 offset:9216
    v_mfma_f32_16x16x32_bf16 v[52:55], v[68:71], v[84:87], v[52:55]
    ds_read_b64_tr_b16 v[136:137], v14 offset:12288
    ds_read_b64_tr_b16 v[138:139], v14 offset:13312
    v_mfma_f32_16x16x32_bf16 v[40:43], v[72:75], v[80:83], v[40:43]
    ds_read_b64_tr_b16 v[140:141], v15 offset:12288
    ds_read_b64_tr_b16 v[142:143], v15 offset:13312
    v_mfma_f32_16x16x32_bf16 v[56:59], v[72:75], v[84:87], v[56:59]
    ds_read_b64_tr_b16 v[144:145], v16 offset:12288
    v_mfma_f32_16x16x32_bf16 v[44:47], v[76:79], v[80:83], v[44:47]
    ds_read_b64_tr_b16 v[146:147], v16 offset:13312
    ds_read_b64_tr_b16 v[148:149], v17 offset:12288
    v_mfma_f32_16x16x32_bf16 v[60:63], v[76:79], v[84:87], v[60:63]
    ds_read_b64_tr_b16 v[150:151], v17 offset:13312
    ds_read_b128 v[152:155], v18 offset:12288
    s_waitcnt lgkmcnt(15)
    v_mfma_f32_16x16x32_bf16 v[32:35], v[88:91], v[104:107], v[32:35]
    ds_read_b128 v[156:159], v18 offset:13312
    v_mfma_f32_16x16x32_bf16 v[48:51], v[88:91], v[108:111], v[48:51]
    v_mfma_f32_16x16x32_bf16 v[36:39], v[92:95], v[104:107], v[36:39]
    v_mfma_f32_16x16x32_bf16 v[52:55], v[92:95], v[108:111], v[52:55]
    v_mfma_f32_16x16x32_bf16 v[40:43], v[96:99], v[104:107], v[40:43]
    v_mfma_f32_16x16x32_bf16 v[56:59], v[96:99], v[108:111], v[56:59]
    v_mfma_f32_16x16x32_bf16 v[44:47], v[100:103], v[104:107], v[44:47]
    v_mfma_f32_16x16x32_bf16 v[60:63], v[100:103], v[108:111], v[60:63]
    s_waitcnt lgkmcnt(0)
    v_add_u32 v14, 0, v3
    v_add_u32 v15, 0, v4
    v_add_u32 v16, 0, v5
    v_add_u32 v17, 0, v6
    v_add_u32 v18, 32768, v7
    s_barrier
    ds_read_b128 v[80:83], v18 offset:0
    v_mfma_f32_16x16x32_bf16 v[32:35], v[112:115], v[128:131], v[32:35]
    ds_read_b128 v[84:87], v18 offset:1024
    v_mfma_f32_16x16x32_bf16 v[48:51], v[112:115], v[132:135], v[48:51]
    ds_read_b64_tr_b16 v[64:65], v14 offset:0
    ds_read_b64_tr_b16 v[66:67], v14 offset:1024
    v_mfma_f32_16x16x32_bf16 v[36:39], v[116:119], v[128:131], v[36:39]
    ds_read_b64_tr_b16 v[68:69], v15 offset:0
    ds_read_b64_tr_b16 v[70:71], v15 offset:1024
    v_mfma_f32_16x16x32_bf16 v[52:55], v[116:119], v[132:135], v[52:55]
    ds_read_b64_tr_b16 v[72:73], v16 offset:0
    v_mfma_f32_16x16x32_bf16 v[40:43], v[120:123], v[128:131], v[40:43]
    ds_read_b64_tr_b16 v[74:75], v16 offset:1024
    ds_read_b64_tr_b16 v[76:77], v17 offset:0
    v_mfma_f32_16x16x32_bf16 v[56:59], v[120:123], v[132:135], v[56:59]
    ds_read_b64_tr_b16 v[78:79], v17 offset:1024
    ds_read_b128 v[104:107], v18 offset:4096
    v_mfma_f32_16x16x32_bf16 v[44:47], v[124:127], v[128:131], v[44:47]
    ds_read_b128 v[108:111], v18 offset:5120
    v_mfma_f32_16x16x32_bf16 v[60:63], v[124:127], v[132:135], v[60:63]
    v_mfma_f32_16x16x32_bf16 v[32:35], v[136:139], v[152:155], v[32:35]
    ds_read_b64_tr_b16 v[88:89], v14 offset:4096
    ds_read_b64_tr_b16 v[90:91], v14 offset:5120
    v_mfma_f32_16x16x32_bf16 v[48:51], v[136:139], v[156:159], v[48:51]
    ds_read_b64_tr_b16 v[92:93], v15 offset:4096
    ds_read_b64_tr_b16 v[94:95], v15 offset:5120
    v_mfma_f32_16x16x32_bf16 v[36:39], v[140:143], v[152:155], v[36:39]
    ds_read_b64_tr_b16 v[96:97], v16 offset:4096
    ds_read_b64_tr_b16 v[98:99], v16 offset:5120
    v_mfma_f32_16x16x32_bf16 v[52:55], v[140:143], v[156:159], v[52:55]
    ds_read_b64_tr_b16 v[100:101], v17 offset:4096
    ds_read_b64_tr_b16 v[102:103], v17 offset:5120
    v_mfma_f32_16x16x32_bf16 v[40:43], v[144:147], v[152:155], v[40:43]
    ds_read_b64_tr_b16 v[112:113], v14 offset:8192
    v_mfma_f32_16x16x32_bf16 v[56:59], v[144:147], v[156:159], v[56:59]
    ds_read_b64_tr_b16 v[114:115], v14 offset:9216
    ds_read_b64_tr_b16 v[116:117], v15 offset:8192
    v_mfma_f32_16x16x32_bf16 v[44:47], v[148:151], v[152:155], v[44:47]
    ds_read_b64_tr_b16 v[118:119], v15 offset:9216
    ds_read_b64_tr_b16 v[120:121], v16 offset:8192
    v_mfma_f32_16x16x32_bf16 v[60:63], v[148:151], v[156:159], v[60:63]
    ds_read_b64_tr_b16 v[122:123], v16 offset:9216
    ds_read_b64_tr_b16 v[124:125], v17 offset:8192
    s_waitcnt lgkmcnt(15)
    v_mfma_f32_16x16x32_bf16 v[32:35], v[64:67], v[80:83], v[32:35]
    ds_read_b64_tr_b16 v[126:127], v17 offset:9216
    v_mfma_f32_16x16x32_bf16 v[48:51], v[64:67], v[84:87], v[48:51]
    ds_read_b128 v[128:131], v18 offset:8192
    v_mfma_f32_16x16x32_bf16 v[36:39], v[68:71], v[80:83], v[36:39]
    ds_read_b128 v[132:135], v18 offset:9216
    v_mfma_f32_16x16x32_bf16 v[52:55], v[68:71], v[84:87], v[52:55]
    ds_read_b64_tr_b16 v[136:137], v14 offset:12288
    ds_read_b64_tr_b16 v[138:139], v14 offset:13312
    v_mfma_f32_16x16x32_bf16 v[40:43], v[72:75], v[80:83], v[40:43]
    ds_read_b64_tr_b16 v[140:141], v15 offset:12288
    ds_read_b64_tr_b16 v[142:143], v15 offset:13312
    v_mfma_f32_16x16x32_bf16 v[56:59], v[72:75], v[84:87], v[56:59]
    ds_read_b64_tr_b16 v[144:145], v16 offset:12288
    v_mfma_f32_16x16x32_bf16 v[44:47], v[76:79], v[80:83], v[44:47]
    ds_read_b64_tr_b16 v[146:147], v16 offset:13312
    ds_read_b64_tr_b16 v[148:149], v17 offset:12288
    v_mfma_f32_16x16x32_bf16 v[60:63], v[76:79], v[84:87], v[60:63]
    ds_read_b64_tr_b16 v[150:151], v17 offset:13312
    ds_read_b128 v[152:155], v18 offset:12288
    s_waitcnt lgkmcnt(15)
    v_mfma_f32_16x16x32_bf16 v[32:35], v[88:91], v[104:107], v[32:35]
    ds_read_b128 v[156:159], v18 offset:13312
    v_mfma_f32_16x16x32_bf16 v[48:51], v[88:91], v[108:111], v[48:51]
    v_mfma_f32_16x16x32_bf16 v[36:39], v[92:95], v[104:107], v[36:39]
    v_mfma_f32_16x16x32_bf16 v[52:55], v[92:95], v[108:111], v[52:55]
    v_mfma_f32_16x16x32_bf16 v[40:43], v[96:99], v[104:107], v[40:43]
    v_mfma_f32_16x16x32_bf16 v[56:59], v[96:99], v[108:111], v[56:59]
    v_mfma_f32_16x16x32_bf16 v[44:47], v[100:103], v[104:107], v[44:47]
    v_mfma_f32_16x16x32_bf16 v[60:63], v[100:103], v[108:111], v[60:63]
    s_waitcnt lgkmcnt(0)
    v_add_u32 v14, 49152, v3
    v_add_u32 v15, 49152, v4
    v_add_u32 v16, 49152, v5
    v_add_u32 v17, 49152, v6
    v_add_u32 v18, 81920, v7
    s_barrier
    ds_read_b128 v[80:83], v18 offset:0
    v_mfma_f32_16x16x32_bf16 v[32:35], v[112:115], v[128:131], v[32:35]
    ds_read_b128 v[84:87], v18 offset:1024
    v_mfma_f32_16x16x32_bf16 v[48:51], v[112:115], v[132:135], v[48:51]
    ds_read_b64_tr_b16 v[64:65], v14 offset:0
    ds_read_b64_tr_b16 v[66:67], v14 offset:1024
    v_mfma_f32_16x16x32_bf16 v[36:39], v[116:119], v[128:131], v[36:39]
    ds_read_b64_tr_b16 v[68:69], v15 offset:0
    ds_read_b64_tr_b16 v[70:71], v15 offset:1024
    v_mfma_f32_16x16x32_bf16 v[52:55], v[116:119], v[132:135], v[52:55]
    ds_read_b64_tr_b16 v[72:73], v16 offset:0
    v_mfma_f32_16x16x32_bf16 v[40:43], v[120:123], v[128:131], v[40:43]
    ds_read_b64_tr_b16 v[74:75], v16 offset:1024
    ds_read_b64_tr_b16 v[76:77], v17 offset:0
    v_mfma_f32_16x16x32_bf16 v[56:59], v[120:123], v[132:135], v[56:59]
    ds_read_b64_tr_b16 v[78:79], v17 offset:1024
    ds_read_b128 v[104:107], v18 offset:4096
    v_mfma_f32_16x16x32_bf16 v[44:47], v[124:127], v[128:131], v[44:47]
    ds_read_b128 v[108:111], v18 offset:5120
    v_mfma_f32_16x16x32_bf16 v[60:63], v[124:127], v[132:135], v[60:63]
    v_mfma_f32_16x16x32_bf16 v[32:35], v[136:139], v[152:155], v[32:35]
    ds_read_b64_tr_b16 v[88:89], v14 offset:4096
    ds_read_b64_tr_b16 v[90:91], v14 offset:5120
    v_mfma_f32_16x16x32_bf16 v[48:51], v[136:139], v[156:159], v[48:51]
    ds_read_b64_tr_b16 v[92:93], v15 offset:4096
    ds_read_b64_tr_b16 v[94:95], v15 offset:5120
    v_mfma_f32_16x16x32_bf16 v[36:39], v[140:143], v[152:155], v[36:39]
    ds_read_b64_tr_b16 v[96:97], v16 offset:4096
    ds_read_b64_tr_b16 v[98:99], v16 offset:5120
    v_mfma_f32_16x16x32_bf16 v[52:55], v[140:143], v[156:159], v[52:55]
    ds_read_b64_tr_b16 v[100:101], v17 offset:4096
    ds_read_b64_tr_b16 v[102:103], v17 offset:5120
    v_mfma_f32_16x16x32_bf16 v[40:43], v[144:147], v[152:155], v[40:43]
    ds_read_b64_tr_b16 v[112:113], v14 offset:8192
    v_mfma_f32_16x16x32_bf16 v[56:59], v[144:147], v[156:159], v[56:59]
    ds_read_b64_tr_b16 v[114:115], v14 offset:9216
    ds_read_b64_tr_b16 v[116:117], v15 offset:8192
    v_mfma_f32_16x16x32_bf16 v[44:47], v[148:151], v[152:155], v[44:47]
    ds_read_b64_tr_b16 v[118:119], v15 offset:9216
    ds_read_b64_tr_b16 v[120:121], v16 offset:8192
    v_mfma_f32_16x16x32_bf16 v[60:63], v[148:151], v[156:159], v[60:63]
    ds_read_b64_tr_b16 v[122:123], v16 offset:9216
    ds_read_b64_tr_b16 v[124:125], v17 offset:8192
    s_waitcnt lgkmcnt(15)
    v_mfma_f32_16x16x32_bf16 v[32:35], v[64:67], v[80:83], v[32:35]
    ds_read_b64_tr_b16 v[126:127], v17 offset:9216
    v_mfma_f32_16x16x32_bf16 v[48:51], v[64:67], v[84:87], v[48:51]
    ds_read_b128 v[128:131], v18 offset:8192
    v_mfma_f32_16x16x32_bf16 v[36:39], v[68:71], v[80:83], v[36:39]
    ds_read_b128 v[132:135], v18 offset:9216
    v_mfma_f32_16x16x32_bf16 v[52:55], v[68:71], v[84:87], v[52:55]
    ds_read_b64_tr_b16 v[136:137], v14 offset:12288
    ds_read_b64_tr_b16 v[138:139], v14 offset:13312
    v_mfma_f32_16x16x32_bf16 v[40:43], v[72:75], v[80:83], v[40:43]
    ds_read_b64_tr_b16 v[140:141], v15 offset:12288
    ds_read_b64_tr_b16 v[142:143], v15 offset:13312
    v_mfma_f32_16x16x32_bf16 v[56:59], v[72:75], v[84:87], v[56:59]
    ds_read_b64_tr_b16 v[144:145], v16 offset:12288
    v_mfma_f32_16x16x32_bf16 v[44:47], v[76:79], v[80:83], v[44:47]
    ds_read_b64_tr_b16 v[146:147], v16 offset:13312
    ds_read_b64_tr_b16 v[148:149], v17 offset:12288
    v_mfma_f32_16x16x32_bf16 v[60:63], v[76:79], v[84:87], v[60:63]
    ds_read_b64_tr_b16 v[150:151], v17 offset:13312
    ds_read_b128 v[152:155], v18 offset:12288
    s_waitcnt lgkmcnt(15)
    v_mfma_f32_16x16x32_bf16 v[32:35], v[88:91], v[104:107], v[32:35]
    ds_read_b128 v[156:159], v18 offset:13312
    v_mfma_f32_16x16x32_bf16 v[48:51], v[88:91], v[108:111], v[48:51]
    v_mfma_f32_16x16x32_bf16 v[36:39], v[92:95], v[104:107], v[36:39]
    v_mfma_f32_16x16x32_bf16 v[52:55], v[92:95], v[108:111], v[52:55]
    v_mfma_f32_16x16x32_bf16 v[40:43], v[96:99], v[104:107], v[40:43]
    v_mfma_f32_16x16x32_bf16 v[56:59], v[96:99], v[108:111], v[56:59]
    v_mfma_f32_16x16x32_bf16 v[44:47], v[100:103], v[104:107], v[44:47]
    v_mfma_f32_16x16x32_bf16 v[60:63], v[100:103], v[108:111], v[60:63]
    s_waitcnt lgkmcnt(0)
    v_add_u32 v14, 98304, v3
    v_add_u32 v15, 98304, v4
    v_add_u32 v16, 98304, v5
    v_add_u32 v17, 98304, v6
    v_add_u32 v18, 131072, v7
    s_barrier
    ds_read_b128 v[80:83], v18 offset:0
    v_mfma_f32_16x16x32_bf16 v[32:35], v[112:115], v[128:131], v[32:35]
    ds_read_b128 v[84:87], v18 offset:1024
    v_mfma_f32_16x16x32_bf16 v[48:51], v[112:115], v[132:135], v[48:51]
    ds_read_b64_tr_b16 v[64:65], v14 offset:0
    ds_read_b64_tr_b16 v[66:67], v14 offset:1024
    v_mfma_f32_16x16x32_bf16 v[36:39], v[116:119], v[128:131], v[36:39]
    ds_read_b64_tr_b16 v[68:69], v15 offset:0
    ds_read_b64_tr_b16 v[70:71], v15 offset:1024
    v_mfma_f32_16x16x32_bf16 v[52:55], v[116:119], v[132:135], v[52:55]
    ds_read_b64_tr_b16 v[72:73], v16 offset:0
    v_mfma_f32_16x16x32_bf16 v[40:43], v[120:123], v[128:131], v[40:43]
    ds_read_b64_tr_b16 v[74:75], v16 offset:1024
    ds_read_b64_tr_b16 v[76:77], v17 offset:0
    v_mfma_f32_16x16x32_bf16 v[56:59], v[120:123], v[132:135], v[56:59]
    ds_read_b64_tr_b16 v[78:79], v17 offset:1024
    ds_read_b128 v[104:107], v18 offset:4096
    v_mfma_f32_16x16x32_bf16 v[44:47], v[124:127], v[128:131], v[44:47]
    ds_read_b128 v[108:111], v18 offset:5120
    v_mfma_f32_16x16x32_bf16 v[60:63], v[124:127], v[132:135], v[60:63]
    v_mfma_f32_16x16x32_bf16 v[32:35], v[136:139], v[152:155], v[32:35]
    ds_read_b64_tr_b16 v[88:89], v14 offset:4096
    ds_read_b64_tr_b16 v[90:91], v14 offset:5120
    v_mfma_f32_16x16x32_bf16 v[48:51], v[136:139], v[156:159], v[48:51]
    ds_read_b64_tr_b16 v[92:93], v15 offset:4096
    ds_read_b64_tr_b16 v[94:95], v15 offset:5120
    v_mfma_f32_16x16x32_bf16 v[36:39], v[140:143], v[152:155], v[36:39]
    ds_read_b64_tr_b16 v[96:97], v16 offset:4096
    ds_read_b64_tr_b16 v[98:99], v16 offset:5120
    v_mfma_f32_16x16x32_bf16 v[52:55], v[140:143], v[156:159], v[52:55]
    ds_read_b64_tr_b16 v[100:101], v17 offset:4096
    ds_read_b64_tr_b16 v[102:103], v17 offset:5120
    v_mfma_f32_16x16x32_bf16 v[40:43], v[144:147], v[152:155], v[40:43]
    ds_read_b64_tr_b16 v[112:113], v14 offset:8192
    v_mfma_f32_16x16x32_bf16 v[56:59], v[144:147], v[156:159], v[56:59]
    ds_read_b64_tr_b16 v[114:115], v14 offset:9216
    ds_read_b64_tr_b16 v[116:117], v15 offset:8192
    v_mfma_f32_16x16x32_bf16 v[44:47], v[148:151], v[152:155], v[44:47]
    ds_read_b64_tr_b16 v[118:119], v15 offset:9216
    ds_read_b64_tr_b16 v[120:121], v16 offset:8192
    v_mfma_f32_16x16x32_bf16 v[60:63], v[148:151], v[156:159], v[60:63]
    ds_read_b64_tr_b16 v[122:123], v16 offset:9216
    ds_read_b64_tr_b16 v[124:125], v17 offset:8192
    s_waitcnt lgkmcnt(15)
    v_mfma_f32_16x16x32_bf16 v[32:35], v[64:67], v[80:83], v[32:35]
    ds_read_b64_tr_b16 v[126:127], v17 offset:9216
    v_mfma_f32_16x16x32_bf16 v[48:51], v[64:67], v[84:87], v[48:51]
    ds_read_b128 v[128:131], v18 offset:8192
    v_mfma_f32_16x16x32_bf16 v[36:39], v[68:71], v[80:83], v[36:39]
    ds_read_b128 v[132:135], v18 offset:9216
    v_mfma_f32_16x16x32_bf16 v[52:55], v[68:71], v[84:87], v[52:55]
    ds_read_b64_tr_b16 v[136:137], v14 offset:12288
    ds_read_b64_tr_b16 v[138:139], v14 offset:13312
    v_mfma_f32_16x16x32_bf16 v[40:43], v[72:75], v[80:83], v[40:43]
    ds_read_b64_tr_b16 v[140:141], v15 offset:12288
    ds_read_b64_tr_b16 v[142:143], v15 offset:13312
    v_mfma_f32_16x16x32_bf16 v[56:59], v[72:75], v[84:87], v[56:59]
    ds_read_b64_tr_b16 v[144:145], v16 offset:12288
    v_mfma_f32_16x16x32_bf16 v[44:47], v[76:79], v[80:83], v[44:47]
    ds_read_b64_tr_b16 v[146:147], v16 offset:13312
    ds_read_b64_tr_b16 v[148:149], v17 offset:12288
    v_mfma_f32_16x16x32_bf16 v[60:63], v[76:79], v[84:87], v[60:63]
    ds_read_b64_tr_b16 v[150:151], v17 offset:13312
    ds_read_b128 v[152:155], v18 offset:12288
    s_waitcnt lgkmcnt(15)
    v_mfma_f32_16x16x32_bf16 v[32:35], v[88:91], v[104:107], v[32:35]
    ds_read_b128 v[156:159], v18 offset:13312
    v_mfma_f32_16x16x32_bf16 v[48:51], v[88:91], v[108:111], v[48:51]
    v_mfma_f32_16x16x32_bf16 v[36:39], v[92:95], v[104:107], v[36:39]
    v_mfma_f32_16x16x32_bf16 v[52:55], v[92:95], v[108:111], v[52:55]
    v_mfma_f32_16x16x32_bf16 v[40:43], v[96:99], v[104:107], v[40:43]
    v_mfma_f32_16x16x32_bf16 v[56:59], v[96:99], v[108:111], v[56:59]
    v_mfma_f32_16x16x32_bf16 v[44:47], v[100:103], v[104:107], v[44:47]
    v_mfma_f32_16x16x32_bf16 v[60:63], v[100:103], v[108:111], v[60:63]
    s_waitcnt lgkmcnt(0)
    v_add_u32 v14, 0, v3
    v_add_u32 v15, 0, v4
    v_add_u32 v16, 0, v5
    v_add_u32 v17, 0, v6
    v_add_u32 v18, 32768, v7
    s_barrier
    ds_read_b128 v[80:83], v18 offset:0
    v_lshlrev_b32 v26, 1, v20
    v_lshlrev_b32 v27, 2, v20
    s_mov_b32 s67, 7864320
    buffer_load_ushort v26, v26, s[44:47], 0 offen
    buffer_load_dword v27, v27, s[28:31], s67 offen sc1
    v_mfma_f32_16x16x32_bf16 v[32:35], v[112:115], v[128:131], v[32:35]
    ds_read_b128 v[84:87], v18 offset:1024
    v_mfma_f32_16x16x32_bf16 v[48:51], v[112:115], v[132:135], v[48:51]
    ds_read_b64_tr_b16 v[64:65], v14 offset:0
    ds_read_b64_tr_b16 v[66:67], v14 offset:1024
    v_mfma_f32_16x16x32_bf16 v[36:39], v[116:119], v[128:131], v[36:39]
    ds_read_b64_tr_b16 v[68:69], v15 offset:0
    ds_read_b64_tr_b16 v[70:71], v15 offset:1024
    v_mfma_f32_16x16x32_bf16 v[52:55], v[116:119], v[132:135], v[52:55]
    ds_read_b64_tr_b16 v[72:73], v16 offset:0
    v_mfma_f32_16x16x32_bf16 v[40:43], v[120:123], v[128:131], v[40:43]
    ds_read_b64_tr_b16 v[74:75], v16 offset:1024
    ds_read_b64_tr_b16 v[76:77], v17 offset:0
    v_mfma_f32_16x16x32_bf16 v[56:59], v[120:123], v[132:135], v[56:59]
    ds_read_b64_tr_b16 v[78:79], v17 offset:1024
    ds_read_b128 v[104:107], v18 offset:4096
    v_mfma_f32_16x16x32_bf16 v[44:47], v[124:127], v[128:131], v[44:47]
    ds_read_b128 v[108:111], v18 offset:5120
    v_mfma_f32_16x16x32_bf16 v[60:63], v[124:127], v[132:135], v[60:63]
    v_mfma_f32_16x16x32_bf16 v[32:35], v[136:139], v[152:155], v[32:35]
    ds_read_b64_tr_b16 v[88:89], v14 offset:4096
    ds_read_b64_tr_b16 v[90:91], v14 offset:5120
    v_mfma_f32_16x16x32_bf16 v[48:51], v[136:139], v[156:159], v[48:51]
    ds_read_b64_tr_b16 v[92:93], v15 offset:4096
    ds_read_b64_tr_b16 v[94:95], v15 offset:5120
    v_mfma_f32_16x16x32_bf16 v[36:39], v[140:143], v[152:155], v[36:39]
    ds_read_b64_tr_b16 v[96:97], v16 offset:4096
    ds_read_b64_tr_b16 v[98:99], v16 offset:5120
    v_mfma_f32_16x16x32_bf16 v[52:55], v[140:143], v[156:159], v[52:55]
    ds_read_b64_tr_b16 v[100:101], v17 offset:4096
    ds_read_b64_tr_b16 v[102:103], v17 offset:5120
    v_mfma_f32_16x16x32_bf16 v[40:43], v[144:147], v[152:155], v[40:43]
    ds_read_b64_tr_b16 v[112:113], v14 offset:8192
    v_mfma_f32_16x16x32_bf16 v[56:59], v[144:147], v[156:159], v[56:59]
    ds_read_b64_tr_b16 v[114:115], v14 offset:9216
    ds_read_b64_tr_b16 v[116:117], v15 offset:8192
    v_mfma_f32_16x16x32_bf16 v[44:47], v[148:151], v[152:155], v[44:47]
    ds_read_b64_tr_b16 v[118:119], v15 offset:9216
    ds_read_b64_tr_b16 v[120:121], v16 offset:8192
    v_mfma_f32_16x16x32_bf16 v[60:63], v[148:151], v[156:159], v[60:63]
    ds_read_b64_tr_b16 v[122:123], v16 offset:9216
    ds_read_b64_tr_b16 v[124:125], v17 offset:8192
    s_waitcnt lgkmcnt(15)
    v_mfma_f32_16x16x32_bf16 v[32:35], v[64:67], v[80:83], v[32:35]
    ds_read_b64_tr_b16 v[126:127], v17 offset:9216
    v_mfma_f32_16x16x32_bf16 v[48:51], v[64:67], v[84:87], v[48:51]
    ds_read_b128 v[128:131], v18 offset:8192
    v_mfma_f32_16x16x32_bf16 v[36:39], v[68:71], v[80:83], v[36:39]
    ds_read_b128 v[132:135], v18 offset:9216
    v_mfma_f32_16x16x32_bf16 v[52:55], v[68:71], v[84:87], v[52:55]
    ds_read_b64_tr_b16 v[136:137], v14 offset:12288
    ds_read_b64_tr_b16 v[138:139], v14 offset:13312
    v_mfma_f32_16x16x32_bf16 v[40:43], v[72:75], v[80:83], v[40:43]
    ds_read_b64_tr_b16 v[140:141], v15 offset:12288
    ds_read_b64_tr_b16 v[142:143], v15 offset:13312
    v_mfma_f32_16x16x32_bf16 v[56:59], v[72:75], v[84:87], v[56:59]
    ds_read_b64_tr_b16 v[144:145], v16 offset:12288
    v_mfma_f32_16x16x32_bf16 v[44:47], v[76:79], v[80:83], v[44:47]
    ds_read_b64_tr_b16 v[146:147], v16 offset:13312
    ds_read_b64_tr_b16 v[148:149], v17 offset:12288
    v_mfma_f32_16x16x32_bf16 v[60:63], v[76:79], v[84:87], v[60:63]
    ds_read_b64_tr_b16 v[150:151], v17 offset:13312
    ds_read_b128 v[152:155], v18 offset:12288
    s_waitcnt lgkmcnt(15)
    v_mfma_f32_16x16x32_bf16 v[32:35], v[88:91], v[104:107], v[32:35]
    ds_read_b128 v[156:159], v18 offset:13312
    v_mfma_f32_16x16x32_bf16 v[48:51], v[88:91], v[108:111], v[48:51]
    v_mfma_f32_16x16x32_bf16 v[36:39], v[92:95], v[104:107], v[36:39]
    v_mfma_f32_16x16x32_bf16 v[52:55], v[92:95], v[108:111], v[52:55]
    v_mfma_f32_16x16x32_bf16 v[40:43], v[96:99], v[104:107], v[40:43]
    v_mfma_f32_16x16x32_bf16 v[56:59], v[96:99], v[108:111], v[56:59]
    v_mfma_f32_16x16x32_bf16 v[44:47], v[100:103], v[104:107], v[44:47]
    v_mfma_f32_16x16x32_bf16 v[60:63], v[100:103], v[108:111], v[60:63]
    s_waitcnt lgkmcnt(0)
    v_add_u32 v14, 49152, v3
    v_add_u32 v15, 49152, v4
    v_add_u32 v16, 49152, v5
    v_add_u32 v17, 49152, v6
    v_add_u32 v18, 81920, v7
    s_barrier
    ds_read_b128 v[80:83], v18 offset:0
    v_mfma_f32_16x16x32_bf16 v[32:35], v[112:115], v[128:131], v[32:35]
    ds_read_b128 v[84:87], v18 offset:1024
    v_mfma_f32_16x16x32_bf16 v[48:51], v[112:115], v[132:135], v[48:51]
    ds_read_b64_tr_b16 v[64:65], v14 offset:0
    ds_read_b64_tr_b16 v[66:67], v14 offset:1024
    v_mfma_f32_16x16x32_bf16 v[36:39], v[116:119], v[128:131], v[36:39]
    ds_read_b64_tr_b16 v[68:69], v15 offset:0
    ds_read_b64_tr_b16 v[70:71], v15 offset:1024
    v_mfma_f32_16x16x32_bf16 v[52:55], v[116:119], v[132:135], v[52:55]
    ds_read_b64_tr_b16 v[72:73], v16 offset:0
    v_mfma_f32_16x16x32_bf16 v[40:43], v[120:123], v[128:131], v[40:43]
    ds_read_b64_tr_b16 v[74:75], v16 offset:1024
    ds_read_b64_tr_b16 v[76:77], v17 offset:0
    v_mfma_f32_16x16x32_bf16 v[56:59], v[120:123], v[132:135], v[56:59]
    ds_read_b64_tr_b16 v[78:79], v17 offset:1024
    ds_read_b128 v[104:107], v18 offset:4096
    v_mfma_f32_16x16x32_bf16 v[44:47], v[124:127], v[128:131], v[44:47]
    ds_read_b128 v[108:111], v18 offset:5120
    v_mfma_f32_16x16x32_bf16 v[60:63], v[124:127], v[132:135], v[60:63]
    v_mfma_f32_16x16x32_bf16 v[32:35], v[136:139], v[152:155], v[32:35]
    ds_read_b64_tr_b16 v[88:89], v14 offset:4096
    ds_read_b64_tr_b16 v[90:91], v14 offset:5120
    v_mfma_f32_16x16x32_bf16 v[48:51], v[136:139], v[156:159], v[48:51]
    ds_read_b64_tr_b16 v[92:93], v15 offset:4096
    ds_read_b64_tr_b16 v[94:95], v15 offset:5120
    v_mfma_f32_16x16x32_bf16 v[36:39], v[140:143], v[152:155], v[36:39]
    ds_read_b64_tr_b16 v[96:97], v16 offset:4096
    ds_read_b64_tr_b16 v[98:99], v16 offset:5120
    v_mfma_f32_16x16x32_bf16 v[52:55], v[140:143], v[156:159], v[52:55]
    ds_read_b64_tr_b16 v[100:101], v17 offset:4096
    ds_read_b64_tr_b16 v[102:103], v17 offset:5120
    v_mfma_f32_16x16x32_bf16 v[40:43], v[144:147], v[152:155], v[40:43]
    ds_read_b64_tr_b16 v[112:113], v14 offset:8192
    v_mfma_f32_16x16x32_bf16 v[56:59], v[144:147], v[156:159], v[56:59]
    ds_read_b64_tr_b16 v[114:115], v14 offset:9216
    ds_read_b64_tr_b16 v[116:117], v15 offset:8192
    v_mfma_f32_16x16x32_bf16 v[44:47], v[148:151], v[152:155], v[44:47]
    ds_read_b64_tr_b16 v[118:119], v15 offset:9216
    ds_read_b64_tr_b16 v[120:121], v16 offset:8192
    v_mfma_f32_16x16x32_bf16 v[60:63], v[148:151], v[156:159], v[60:63]
    ds_read_b64_tr_b16 v[122:123], v16 offset:9216
    ds_read_b64_tr_b16 v[124:125], v17 offset:8192
    s_waitcnt lgkmcnt(15)
    v_mfma_f32_16x16x32_bf16 v[32:35], v[64:67], v[80:83], v[32:35]
    ds_read_b64_tr_b16 v[126:127], v17 offset:9216
    v_mfma_f32_16x16x32_bf16 v[48:51], v[64:67], v[84:87], v[48:51]
    ds_read_b128 v[128:131], v18 offset:8192
    v_mfma_f32_16x16x32_bf16 v[36:39], v[68:71], v[80:83], v[36:39]
    ds_read_b128 v[132:135], v18 offset:9216
    v_mfma_f32_16x16x32_bf16 v[52:55], v[68:71], v[84:87], v[52:55]
    ds_read_b64_tr_b16 v[136:137], v14 offset:12288
    ds_read_b64_tr_b16 v[138:139], v14 offset:13312
    v_mfma_f32_16x16x32_bf16 v[40:43], v[72:75], v[80:83], v[40:43]
    ds_read_b64_tr_b16 v[140:141], v15 offset:12288
    ds_read_b64_tr_b16 v[142:143], v15 offset:13312
    v_mfma_f32_16x16x32_bf16 v[56:59], v[72:75], v[84:87], v[56:59]
    ds_read_b64_tr_b16 v[144:145], v16 offset:12288
    v_mfma_f32_16x16x32_bf16 v[44:47], v[76:79], v[80:83], v[44:47]
    ds_read_b64_tr_b16 v[146:147], v16 offset:13312
    ds_read_b64_tr_b16 v[148:149], v17 offset:12288
    v_mfma_f32_16x16x32_bf16 v[60:63], v[76:79], v[84:87], v[60:63]
    ds_read_b64_tr_b16 v[150:151], v17 offset:13312
    ds_read_b128 v[152:155], v18 offset:12288
    s_waitcnt lgkmcnt(15)
    v_mfma_f32_16x16x32_bf16 v[32:35], v[88:91], v[104:107], v[32:35]
    ds_read_b128 v[156:159], v18 offset:13312
    v_mfma_f32_16x16x32_bf16 v[48:51], v[88:91], v[108:111], v[48:51]
    v_mfma_f32_16x16x32_bf16 v[36:39], v[92:95], v[104:107], v[36:39]
    v_mfma_f32_16x16x32_bf16 v[52:55], v[92:95], v[108:111], v[52:55]
    v_mfma_f32_16x16x32_bf16 v[40:43], v[96:99], v[104:107], v[40:43]
    v_mfma_f32_16x16x32_bf16 v[56:59], v[96:99], v[108:111], v[56:59]
    v_mfma_f32_16x16x32_bf16 v[44:47], v[100:103], v[104:107], v[44:47]
    v_mfma_f32_16x16x32_bf16 v[60:63], v[100:103], v[108:111], v[60:63]
    s_waitcnt lgkmcnt(0)
    v_add_u32 v14, 98304, v3
    v_add_u32 v15, 98304, v4
    v_add_u32 v16, 98304, v5
    v_add_u32 v17, 98304, v6
    v_add_u32 v18, 131072, v7
    s_barrier
    ds_read_b128 v[80:83], v18 offset:0
    v_mfma_f32_16x16x32_bf16 v[32:35], v[112:115], v[128:131], v[32:35]
    ds_read_b128 v[84:87], v18 offset:1024
    v_mfma_f32_16x16x32_bf16 v[48:51], v[112:115], v[132:135], v[48:51]
    ds_read_b64_tr_b16 v[64:65], v14 offset:0
    ds_read_b64_tr_b16 v[66:67], v14 offset:1024
    v_mfma_f32_16x16x32_bf16 v[36:39], v[116:119], v[128:131], v[36:39]
    ds_read_b64_tr_b16 v[68:69], v15 offset:0
    ds_read_b64_tr_b16 v[70:71], v15 offset:1024
    v_mfma_f32_16x16x32_bf16 v[52:55], v[116:119], v[132:135], v[52:55]
    ds_read_b64_tr_b16 v[72:73], v16 offset:0
    v_mfma_f32_16x16x32_bf16 v[40:43], v[120:123], v[128:131], v[40:43]
    ds_read_b64_tr_b16 v[74:75], v16 offset:1024
    ds_read_b64_tr_b16 v[76:77], v17 offset:0
    v_mfma_f32_16x16x32_bf16 v[56:59], v[120:123], v[132:135], v[56:59]
    ds_read_b64_tr_b16 v[78:79], v17 offset:1024
    ds_read_b128 v[104:107], v18 offset:4096
    v_mfma_f32_16x16x32_bf16 v[44:47], v[124:127], v[128:131], v[44:47]
    ds_read_b128 v[108:111], v18 offset:5120
    v_mfma_f32_16x16x32_bf16 v[60:63], v[124:127], v[132:135], v[60:63]
    v_mfma_f32_16x16x32_bf16 v[32:35], v[136:139], v[152:155], v[32:35]
    ds_read_b64_tr_b16 v[88:89], v14 offset:4096
    ds_read_b64_tr_b16 v[90:91], v14 offset:5120
    v_mfma_f32_16x16x32_bf16 v[48:51], v[136:139], v[156:159], v[48:51]
    ds_read_b64_tr_b16 v[92:93], v15 offset:4096
    ds_read_b64_tr_b16 v[94:95], v15 offset:5120
    v_mfma_f32_16x16x32_bf16 v[36:39], v[140:143], v[152:155], v[36:39]
    ds_read_b64_tr_b16 v[96:97], v16 offset:4096
    ds_read_b64_tr_b16 v[98:99], v16 offset:5120
    v_mfma_f32_16x16x32_bf16 v[52:55], v[140:143], v[156:159], v[52:55]
    ds_read_b64_tr_b16 v[100:101], v17 offset:4096
    ds_read_b64_tr_b16 v[102:103], v17 offset:5120
    v_mfma_f32_16x16x32_bf16 v[40:43], v[144:147], v[152:155], v[40:43]
    ds_read_b64_tr_b16 v[112:113], v14 offset:8192
    v_mfma_f32_16x16x32_bf16 v[56:59], v[144:147], v[156:159], v[56:59]
    ds_read_b64_tr_b16 v[114:115], v14 offset:9216
    ds_read_b64_tr_b16 v[116:117], v15 offset:8192
    v_mfma_f32_16x16x32_bf16 v[44:47], v[148:151], v[152:155], v[44:47]
    ds_read_b64_tr_b16 v[118:119], v15 offset:9216
    ds_read_b64_tr_b16 v[120:121], v16 offset:8192
    v_mfma_f32_16x16x32_bf16 v[60:63], v[148:151], v[156:159], v[60:63]
    ds_read_b64_tr_b16 v[122:123], v16 offset:9216
    ds_read_b64_tr_b16 v[124:125], v17 offset:8192
    s_waitcnt lgkmcnt(15)
    v_mfma_f32_16x16x32_bf16 v[32:35], v[64:67], v[80:83], v[32:35]
    ds_read_b64_tr_b16 v[126:127], v17 offset:9216
    v_mfma_f32_16x16x32_bf16 v[48:51], v[64:67], v[84:87], v[48:51]
    ds_read_b128 v[128:131], v18 offset:8192
    v_mfma_f32_16x16x32_bf16 v[36:39], v[68:71], v[80:83], v[36:39]
    ds_read_b128 v[132:135], v18 offset:9216
    v_mfma_f32_16x16x32_bf16 v[52:55], v[68:71], v[84:87], v[52:55]
    ds_read_b64_tr_b16 v[136:137], v14 offset:12288
    ds_read_b64_tr_b16 v[138:139], v14 offset:13312
    v_mfma_f32_16x16x32_bf16 v[40:43], v[72:75], v[80:83], v[40:43]
    ds_read_b64_tr_b16 v[140:141], v15 offset:12288
    ds_read_b64_tr_b16 v[142:143], v15 offset:13312
    v_mfma_f32_16x16x32_bf16 v[56:59], v[72:75], v[84:87], v[56:59]
    ds_read_b64_tr_b16 v[144:145], v16 offset:12288
    v_mfma_f32_16x16x32_bf16 v[44:47], v[76:79], v[80:83], v[44:47]
    ds_read_b64_tr_b16 v[146:147], v16 offset:13312
    ds_read_b64_tr_b16 v[148:149], v17 offset:12288
    v_mfma_f32_16x16x32_bf16 v[60:63], v[76:79], v[84:87], v[60:63]
    ds_read_b64_tr_b16 v[150:151], v17 offset:13312
    ds_read_b128 v[152:155], v18 offset:12288
    s_waitcnt lgkmcnt(15)
    v_mfma_f32_16x16x32_bf16 v[32:35], v[88:91], v[104:107], v[32:35]
    ds_read_b128 v[156:159], v18 offset:13312
    v_mfma_f32_16x16x32_bf16 v[48:51], v[88:91], v[108:111], v[48:51]
    v_mfma_f32_16x16x32_bf16 v[36:39], v[92:95], v[104:107], v[36:39]
    v_mfma_f32_16x16x32_bf16 v[52:55], v[92:95], v[108:111], v[52:55]
    v_mfma_f32_16x16x32_bf16 v[40:43], v[96:99], v[104:107], v[40:43]
    v_mfma_f32_16x16x32_bf16 v[56:59], v[96:99], v[108:111], v[56:59]
    v_mfma_f32_16x16x32_bf16 v[44:47], v[100:103], v[104:107], v[44:47]
    v_mfma_f32_16x16x32_bf16 v[60:63], v[100:103], v[108:111], v[60:63]
    s_waitcnt lgkmcnt(0)
    v_add_u32 v14, 0, v3
    v_add_u32 v15, 0, v4
    v_add_u32 v16, 0, v5
    v_add_u32 v17, 0, v6
    v_add_u32 v18, 32768, v7
    s_barrier
    ds_read_b128 v[80:83], v18 offset:0
    v_mfma_f32_16x16x32_bf16 v[32:35], v[112:115], v[128:131], v[32:35]
    ds_read_b128 v[84:87], v18 offset:1024
    v_mfma_f32_16x16x32_bf16 v[48:51], v[112:115], v[132:135], v[48:51]
    ds_read_b64_tr_b16 v[64:65], v14 offset:0
    ds_read_b64_tr_b16 v[66:67], v14 offset:1024
    v_mfma_f32_16x16x32_bf16 v[36:39], v[116:119], v[128:131], v[36:39]
    ds_read_b64_tr_b16 v[68:69], v15 offset:0
    ds_read_b64_tr_b16 v[70:71], v15 offset:1024
    v_mfma_f32_16x16x32_bf16 v[52:55], v[116:119], v[132:135], v[52:55]
    ds_read_b64_tr_b16 v[72:73], v16 offset:0
    v_mfma_f32_16x16x32_bf16 v[40:43], v[120:123], v[128:131], v[40:43]
    ds_read_b64_tr_b16 v[74:75], v16 offset:1024
    ds_read_b64_tr_b16 v[76:77], v17 offset:0
    v_mfma_f32_16x16x32_bf16 v[56:59], v[120:123], v[132:135], v[56:59]
    ds_read_b64_tr_b16 v[78:79], v17 offset:1024
    ds_read_b128 v[104:107], v18 offset:4096
    v_mfma_f32_16x16x32_bf16 v[44:47], v[124:127], v[128:131], v[44:47]
    ds_read_b128 v[108:111], v18 offset:5120
    v_mfma_f32_16x16x32_bf16 v[60:63], v[124:127], v[132:135], v[60:63]
    v_mfma_f32_16x16x32_bf16 v[32:35], v[136:139], v[152:155], v[32:35]
    ds_read_b64_tr_b16 v[88:89], v14 offset:4096
    ds_read_b64_tr_b16 v[90:91], v14 offset:5120
    v_mfma_f32_16x16x32_bf16 v[48:51], v[136:139], v[156:159], v[48:51]
    ds_read_b64_tr_b16 v[92:93], v15 offset:4096
    ds_read_b64_tr_b16 v[94:95], v15 offset:5120
    v_mfma_f32_16x16x32_bf16 v[36:39], v[140:143], v[152:155], v[36:39]
    ds_read_b64_tr_b16 v[96:97], v16 offset:4096
    ds_read_b64_tr_b16 v[98:99], v16 offset:5120
    v_mfma_f32_16x16x32_bf16 v[52:55], v[140:143], v[156:159], v[52:55]
    ds_read_b64_tr_b16 v[100:101], v17 offset:4096
    ds_read_b64_tr_b16 v[102:103], v17 offset:5120
    v_mfma_f32_16x16x32_bf16 v[40:43], v[144:147], v[152:155], v[40:43]
    ds_read_b64_tr_b16 v[112:113], v14 offset:8192
    v_mfma_f32_16x16x32_bf16 v[56:59], v[144:147], v[156:159], v[56:59]
    ds_read_b64_tr_b16 v[114:115], v14 offset:9216
    ds_read_b64_tr_b16 v[116:117], v15 offset:8192
    v_mfma_f32_16x16x32_bf16 v[44:47], v[148:151], v[152:155], v[44:47]
    ds_read_b64_tr_b16 v[118:119], v15 offset:9216
    ds_read_b64_tr_b16 v[120:121], v16 offset:8192
    v_mfma_f32_16x16x32_bf16 v[60:63], v[148:151], v[156:159], v[60:63]
    ds_read_b64_tr_b16 v[122:123], v16 offset:9216
    ds_read_b64_tr_b16 v[124:125], v17 offset:8192
    s_waitcnt lgkmcnt(15)
    v_mfma_f32_16x16x32_bf16 v[32:35], v[64:67], v[80:83], v[32:35]
    ds_read_b64_tr_b16 v[126:127], v17 offset:9216
    v_mfma_f32_16x16x32_bf16 v[48:51], v[64:67], v[84:87], v[48:51]
    ds_read_b128 v[128:131], v18 offset:8192
    v_mfma_f32_16x16x32_bf16 v[36:39], v[68:71], v[80:83], v[36:39]
    ds_read_b128 v[132:135], v18 offset:9216
    v_mfma_f32_16x16x32_bf16 v[52:55], v[68:71], v[84:87], v[52:55]
    ds_read_b64_tr_b16 v[136:137], v14 offset:12288
    ds_read_b64_tr_b16 v[138:139], v14 offset:13312
    v_mfma_f32_16x16x32_bf16 v[40:43], v[72:75], v[80:83], v[40:43]
    ds_read_b64_tr_b16 v[140:141], v15 offset:12288
    ds_read_b64_tr_b16 v[142:143], v15 offset:13312
    v_mfma_f32_16x16x32_bf16 v[56:59], v[72:75], v[84:87], v[56:59]
    ds_read_b64_tr_b16 v[144:145], v16 offset:12288
    v_mfma_f32_16x16x32_bf16 v[44:47], v[76:79], v[80:83], v[44:47]
    ds_read_b64_tr_b16 v[146:147], v16 offset:13312
    ds_read_b64_tr_b16 v[148:149], v17 offset:12288
    v_mfma_f32_16x16x32_bf16 v[60:63], v[76:79], v[84:87], v[60:63]
    ds_read_b64_tr_b16 v[150:151], v17 offset:13312
    ds_read_b128 v[152:155], v18 offset:12288
    s_waitcnt lgkmcnt(15)
    v_mfma_f32_16x16x32_bf16 v[32:35], v[88:91], v[104:107], v[32:35]
    ds_read_b128 v[156:159], v18 offset:13312
    v_mfma_f32_16x16x32_bf16 v[48:51], v[88:91], v[108:111], v[48:51]
    v_mfma_f32_16x16x32_bf16 v[36:39], v[92:95], v[104:107], v[36:39]
    v_mfma_f32_16x16x32_bf16 v[52:55], v[92:95], v[108:111], v[52:55]
    v_mfma_f32_16x16x32_bf16 v[40:43], v[96:99], v[104:107], v[40:43]
    v_mfma_f32_16x16x32_bf16 v[56:59], v[96:99], v[108:111], v[56:59]
    v_mfma_f32_16x16x32_bf16 v[44:47], v[100:103], v[104:107], v[44:47]
    v_mfma_f32_16x16x32_bf16 v[60:63], v[100:103], v[108:111], v[60:63]
    s_waitcnt lgkmcnt(0)
    v_mfma_f32_16x16x32_bf16 v[32:35], v[112:115], v[128:131], v[32:35]
    v_mfma_f32_16x16x32_bf16 v[48:51], v[112:115], v[132:135], v[48:51]
    v_mfma_f32_16x16x32_bf16 v[36:39], v[116:119], v[128:131], v[36:39]
    v_mfma_f32_16x16x32_bf16 v[52:55], v[116:119], v[132:135], v[52:55]
    v_mfma_f32_16x16x32_bf16 v[40:43], v[120:123], v[128:131], v[40:43]
    v_mfma_f32_16x16x32_bf16 v[56:59], v[120:123], v[132:135], v[56:59]
    v_mfma_f32_16x16x32_bf16 v[44:47], v[124:127], v[128:131], v[44:47]
    v_mfma_f32_16x16x32_bf16 v[60:63], v[124:127], v[132:135], v[60:63]
    v_mfma_f32_16x16x32_bf16 v[32:35], v[136:139], v[152:155], v[32:35]
    v_mfma_f32_16x16x32_bf16 v[48:51], v[136:139], v[156:159], v[48:51]
    v_mfma_f32_16x16x32_bf16 v[36:39], v[140:143], v[152:155], v[36:39]
    v_mfma_f32_16x16x32_bf16 v[52:55], v[140:143], v[156:159], v[52:55]
    v_mfma_f32_16x16x32_bf16 v[40:43], v[144:147], v[152:155], v[40:43]
    v_mfma_f32_16x16x32_bf16 v[56:59], v[144:147], v[156:159], v[56:59]
    v_mfma_f32_16x16x32_bf16 v[44:47], v[148:151], v[152:155], v[44:47]
    v_mfma_f32_16x16x32_bf16 v[60:63], v[148:151], v[156:159], v[60:63]
    s_waitcnt vmcnt(0)
    v_lshlrev_b32 v64, 16, v240
    v_and_b32 v65, s3, v240
    v_lshlrev_b32 v66, 16, v241
    v_and_b32 v67, s3, v241
    v_lshlrev_b32 v68, 16, v242
    v_and_b32 v69, s3, v242
    v_lshlrev_b32 v70, 16, v243
    v_and_b32 v71, s3, v243
    v_lshlrev_b32 v72, 16, v244
    v_and_b32 v73, s3, v244
    v_lshlrev_b32 v74, 16, v245
    v_and_b32 v75, s3, v245
    v_lshlrev_b32 v76, 16, v246
    v_and_b32 v77, s3, v246
    v_lshlrev_b32 v78, 16, v247
    v_and_b32 v79, s3, v247
    v_mov_b32 v88, 0xc0135761
    v_mov_b32 v90, 0xbdd2d3e8
    v_pk_add_f32 v[32:33], v[32:33], v[64:65]
    v_pk_add_f32 v[34:35], v[34:35], v[66:67]
    v_pk_add_f32 v[36:37], v[36:37], v[68:69]
    v_pk_add_f32 v[38:39], v[38:39], v[70:71]
    v_pk_mul_f32 v[80:81], v[32:33], v[32:33]
    v_pk_mul_f32 v[82:83], v[34:35], v[34:35]
    v_pk_mul_f32 v[84:85], v[36:37], v[36:37]
    v_pk_mul_f32 v[86:87], v[38:39], v[38:39]
    v_pk_fma_f32 v[80:81], v[80:81], v[90:91], v[88:89] op_sel_hi:[1,0,0]
    v_pk_fma_f32 v[82:83], v[82:83], v[90:91], v[88:89] op_sel_hi:[1,0,0]
    v_pk_fma_f32 v[84:85], v[84:85], v[90:91], v[88:89] op_sel_hi:[1,0,0]
    v_pk_fma_f32 v[86:87], v[86:87], v[90:91], v[88:89] op_sel_hi:[1,0,0]
    v_pk_mul_f32 v[80:81], v[80:81], v[32:33]
    v_pk_mul_f32 v[82:83], v[82:83], v[34:35]
    v_pk_mul_f32 v[84:85], v[84:85], v[36:37]
    v_pk_mul_f32 v[86:87], v[86:87], v[38:39]
    v_exp_f32 v80, v80
    v_exp_f32 v81, v81
    v_exp_f32 v82, v82
    v_exp_f32 v83, v83
    v_exp_f32 v84, v84
    v_exp_f32 v85, v85
    v_exp_f32 v86, v86
    v_exp_f32 v87, v87
    v_add_f32 v80, 1.0, v80
    v_add_f32 v81, 1.0, v81
    v_add_f32 v82, 1.0, v82
    v_add_f32 v83, 1.0, v83
    v_add_f32 v84, 1.0, v84
    v_add_f32 v85, 1.0, v85
    v_add_f32 v86, 1.0, v86
    v_add_f32 v87, 1.0, v87
    v_rcp_f32 v80, v80
    v_rcp_f32 v81, v81
    v_rcp_f32 v82, v82
    v_rcp_f32 v83, v83
    v_rcp_f32 v84, v84
    v_rcp_f32 v85, v85
    v_rcp_f32 v86, v86
    v_rcp_f32 v87, v87
    v_pk_mul_f32 v[80:81], v[80:81], v[32:33]
    v_pk_mul_f32 v[82:83], v[82:83], v[34:35]
    v_pk_mul_f32 v[84:85], v[84:85], v[36:37]
    v_pk_mul_f32 v[86:87], v[86:87], v[38:39]
    v_cvt_pk_bf16_f32 v224, v80, v81
    v_cvt_pk_bf16_f32 v225, v82, v83
    v_cvt_pk_bf16_f32 v226, v84, v85
    v_cvt_pk_bf16_f32 v227, v86, v87
    buffer_store_dwordx4 v[224:227], v250, s[28:31], s86 offen sc1
    v_pk_add_f32 v[40:41], v[40:41], v[72:73]
    v_pk_add_f32 v[42:43], v[42:43], v[74:75]
    v_pk_add_f32 v[44:45], v[44:45], v[76:77]
    v_pk_add_f32 v[46:47], v[46:47], v[78:79]
    v_pk_mul_f32 v[80:81], v[40:41], v[40:41]
    v_pk_mul_f32 v[82:83], v[42:43], v[42:43]
    v_pk_mul_f32 v[84:85], v[44:45], v[44:45]
    v_pk_mul_f32 v[86:87], v[46:47], v[46:47]
    v_pk_fma_f32 v[80:81], v[80:81], v[90:91], v[88:89] op_sel_hi:[1,0,0]
    v_pk_fma_f32 v[82:83], v[82:83], v[90:91], v[88:89] op_sel_hi:[1,0,0]
    v_pk_fma_f32 v[84:85], v[84:85], v[90:91], v[88:89] op_sel_hi:[1,0,0]
    v_pk_fma_f32 v[86:87], v[86:87], v[90:91], v[88:89] op_sel_hi:[1,0,0]
    v_pk_mul_f32 v[80:81], v[80:81], v[40:41]
    v_pk_mul_f32 v[82:83], v[82:83], v[42:43]
    v_pk_mul_f32 v[84:85], v[84:85], v[44:45]
    v_pk_mul_f32 v[86:87], v[86:87], v[46:47]
    v_exp_f32 v80, v80
    v_exp_f32 v81, v81
    v_exp_f32 v82, v82
    v_exp_f32 v83, v83
    v_exp_f32 v84, v84
    v_exp_f32 v85, v85
    v_exp_f32 v86, v86
    v_exp_f32 v87, v87
    v_add_f32 v80, 1.0, v80
    v_add_f32 v81, 1.0, v81
    v_add_f32 v82, 1.0, v82
    v_add_f32 v83, 1.0, v83
    v_add_f32 v84, 1.0, v84
    v_add_f32 v85, 1.0, v85
    v_add_f32 v86, 1.0, v86
    v_add_f32 v87, 1.0, v87
    v_rcp_f32 v80, v80
    v_rcp_f32 v81, v81
    v_rcp_f32 v82, v82
    v_rcp_f32 v83, v83
    v_rcp_f32 v84, v84
    v_rcp_f32 v85, v85
    v_rcp_f32 v86, v86
    v_rcp_f32 v87, v87
    v_pk_mul_f32 v[80:81], v[80:81], v[40:41]
    v_pk_mul_f32 v[82:83], v[82:83], v[42:43]
    v_pk_mul_f32 v[84:85], v[84:85], v[44:45]
    v_pk_mul_f32 v[86:87], v[86:87], v[46:47]
    v_cvt_pk_bf16_f32 v228, v80, v81
    v_cvt_pk_bf16_f32 v229, v82, v83
    v_cvt_pk_bf16_f32 v230, v84, v85
    v_cvt_pk_bf16_f32 v231, v86, v87
    buffer_store_dwordx4 v[228:231], v250, s[28:31], s87 offen sc1
    v_pk_add_f32 v[48:49], v[48:49], v[64:65]
    v_pk_add_f32 v[50:51], v[50:51], v[66:67]
    v_pk_add_f32 v[52:53], v[52:53], v[68:69]
    v_pk_add_f32 v[54:55], v[54:55], v[70:71]
    v_pk_mul_f32 v[80:81], v[48:49], v[48:49]
    v_pk_mul_f32 v[82:83], v[50:51], v[50:51]
    v_pk_mul_f32 v[84:85], v[52:53], v[52:53]
    v_pk_mul_f32 v[86:87], v[54:55], v[54:55]
    v_pk_fma_f32 v[80:81], v[80:81], v[90:91], v[88:89] op_sel_hi:[1,0,0]
    v_pk_fma_f32 v[82:83], v[82:83], v[90:91], v[88:89] op_sel_hi:[1,0,0]
    v_pk_fma_f32 v[84:85], v[84:85], v[90:91], v[88:89] op_sel_hi:[1,0,0]
    v_pk_fma_f32 v[86:87], v[86:87], v[90:91], v[88:89] op_sel_hi:[1,0,0]
    v_pk_mul_f32 v[80:81], v[80:81], v[48:49]
    v_pk_mul_f32 v[82:83], v[82:83], v[50:51]
    v_pk_mul_f32 v[84:85], v[84:85], v[52:53]
    v_pk_mul_f32 v[86:87], v[86:87], v[54:55]
    v_exp_f32 v80, v80
    v_exp_f32 v81, v81
    v_exp_f32 v82, v82
    v_exp_f32 v83, v83
    v_exp_f32 v84, v84
    v_exp_f32 v85, v85
    v_exp_f32 v86, v86
    v_exp_f32 v87, v87
    v_add_f32 v80, 1.0, v80
    v_add_f32 v81, 1.0, v81
    v_add_f32 v82, 1.0, v82
    v_add_f32 v83, 1.0, v83
    v_add_f32 v84, 1.0, v84
    v_add_f32 v85, 1.0, v85
    v_add_f32 v86, 1.0, v86
    v_add_f32 v87, 1.0, v87
    v_rcp_f32 v80, v80
    v_rcp_f32 v81, v81
    v_rcp_f32 v82, v82
    v_rcp_f32 v83, v83
    v_rcp_f32 v84, v84
    v_rcp_f32 v85, v85
    v_rcp_f32 v86, v86
    v_rcp_f32 v87, v87
    v_pk_mul_f32 v[80:81], v[80:81], v[48:49]
    v_pk_mul_f32 v[82:83], v[82:83], v[50:51]
    v_pk_mul_f32 v[84:85], v[84:85], v[52:53]
    v_pk_mul_f32 v[86:87], v[86:87], v[54:55]
    v_cvt_pk_bf16_f32 v232, v80, v81
    v_cvt_pk_bf16_f32 v233, v82, v83
    v_cvt_pk_bf16_f32 v234, v84, v85
    v_cvt_pk_bf16_f32 v235, v86, v87
    buffer_store_dwordx4 v[232:235], v250, s[28:31], s88 offen sc1
    v_pk_add_f32 v[56:57], v[56:57], v[72:73]
    v_pk_add_f32 v[58:59], v[58:59], v[74:75]
    v_pk_add_f32 v[60:61], v[60:61], v[76:77]
    v_pk_add_f32 v[62:63], v[62:63], v[78:79]
    v_pk_mul_f32 v[80:81], v[56:57], v[56:57]
    v_pk_mul_f32 v[82:83], v[58:59], v[58:59]
    v_pk_mul_f32 v[84:85], v[60:61], v[60:61]
    v_pk_mul_f32 v[86:87], v[62:63], v[62:63]
    v_pk_fma_f32 v[80:81], v[80:81], v[90:91], v[88:89] op_sel_hi:[1,0,0]
    v_pk_fma_f32 v[82:83], v[82:83], v[90:91], v[88:89] op_sel_hi:[1,0,0]
    v_pk_fma_f32 v[84:85], v[84:85], v[90:91], v[88:89] op_sel_hi:[1,0,0]
    v_pk_fma_f32 v[86:87], v[86:87], v[90:91], v[88:89] op_sel_hi:[1,0,0]
    v_pk_mul_f32 v[80:81], v[80:81], v[56:57]
    v_pk_mul_f32 v[82:83], v[82:83], v[58:59]
    v_pk_mul_f32 v[84:85], v[84:85], v[60:61]
    v_pk_mul_f32 v[86:87], v[86:87], v[62:63]
    v_exp_f32 v80, v80
    v_exp_f32 v81, v81
    v_exp_f32 v82, v82
    v_exp_f32 v83, v83
    v_exp_f32 v84, v84
    v_exp_f32 v85, v85
    v_exp_f32 v86, v86
    v_exp_f32 v87, v87
    v_add_f32 v80, 1.0, v80
    v_add_f32 v81, 1.0, v81
    v_add_f32 v82, 1.0, v82
    v_add_f32 v83, 1.0, v83
    v_add_f32 v84, 1.0, v84
    v_add_f32 v85, 1.0, v85
    v_add_f32 v86, 1.0, v86
    v_add_f32 v87, 1.0, v87
    v_rcp_f32 v80, v80
    v_rcp_f32 v81, v81
    v_rcp_f32 v82, v82
    v_rcp_f32 v83, v83
    v_rcp_f32 v84, v84
    v_rcp_f32 v85, v85
    v_rcp_f32 v86, v86
    v_rcp_f32 v87, v87
    v_pk_mul_f32 v[80:81], v[80:81], v[56:57]
    v_pk_mul_f32 v[82:83], v[82:83], v[58:59]
    v_pk_mul_f32 v[84:85], v[84:85], v[60:61]
    v_pk_mul_f32 v[86:87], v[86:87], v[62:63]
    v_cvt_pk_bf16_f32 v236, v80, v81
    v_cvt_pk_bf16_f32 v237, v82, v83
    v_cvt_pk_bf16_f32 v238, v84, v85
    v_cvt_pk_bf16_f32 v239, v86, v87
    buffer_store_dwordx4 v[236:239], v250, s[28:31], s89 offen sc1
    s_waitcnt vmcnt(0)
    s_mov_b64 exec, 1
    v_mov_b32 v9, 1
    v_mov_b32 v14, 163832
    ds_add_rtn_u32 v9, v14, v9
    s_waitcnt lgkmcnt(0)
    v_readfirstlane_b32 s67, v9
    s_nop 1
    s_cmp_eq_u32 s67, 3
    s_cselect_b32 s66, s64, 12582912
    s_mov_b32 exec_lo, -1
    s_mov_b32 exec_hi, 0
    v_lshlrev_b32 v9, 2, v0
    buffer_store_dword v29, v9, s[28:31], s66 offen sc1
    s_mov_b64 exec, -1
    v_add_u32 v14, 49152, v12
    v_add_u32 v15, 102400, v13
    s_barrier
    ds_read_b128 v[128:131], v15 offset:0
    ds_read_b64_tr_b16 v[132:133], v14 offset:0
    ds_read_b64_tr_b16 v[134:135], v14 offset:1280
    ds_read_b64_tr_b16 v[136:137], v14 offset:32
    ds_read_b64_tr_b16 v[138:139], v14 offset:1312
    ds_read_b64_tr_b16 v[140:141], v14 offset:64
    ds_read_b64_tr_b16 v[142:143], v14 offset:1344
    ds_read_b64_tr_b16 v[144:145], v14 offset:96
    ds_read_b64_tr_b16 v[146:147], v14 offset:1376
    ds_read_b64_tr_b16 v[148:149], v14 offset:128
    ds_read_b64_tr_b16 v[150:151], v14 offset:1408
    ds_read_b128 v[152:155], v15 offset:4096
    ds_read_b64_tr_b16 v[156:157], v14 offset:5120
    ds_read_b64_tr_b16 v[158:159], v14 offset:6400
    ds_read_b64_tr_b16 v[160:161], v14 offset:5152
    ds_read_b64_tr_b16 v[162:163], v14 offset:6432
    ds_read_b64_tr_b16 v[164:165], v14 offset:5184
    ds_read_b64_tr_b16 v[166:167], v14 offset:6464
    ds_read_b64_tr_b16 v[168:169], v14 offset:5216
    ds_read_b64_tr_b16 v[170:171], v14 offset:6496
    ds_read_b64_tr_b16 v[172:173], v14 offset:5248
    ds_read_b64_tr_b16 v[174:175], v14 offset:6528
    s_waitcnt lgkmcnt(15)
    v_mfma_f32_16x16x32_bf16 v[32:35], v[132:135], v[128:131], 0
    ds_read_b64_tr_b16 v[180:181], v14 offset:10240
    ds_read_b64_tr_b16 v[182:183], v14 offset:11520
    ds_read_b64_tr_b16 v[184:185], v14 offset:10272
    ds_read_b64_tr_b16 v[186:187], v14 offset:11552
    ds_read_b64_tr_b16 v[188:189], v14 offset:10304
    ds_read_b64_tr_b16 v[190:191], v14 offset:11584
    ds_read_b64_tr_b16 v[192:193], v14 offset:10336
    v_mfma_f32_16x16x32_bf16 v[36:39], v[136:139], v[128:131], 0
    ds_read_b64_tr_b16 v[194:195], v14 offset:11616
    ds_read_b64_tr_b16 v[196:197], v14 offset:10368
    ds_read_b64_tr_b16 v[198:199], v14 offset:11648
    ds_read_b128 v[176:179], v15 offset:8192
    v_mfma_f32_16x16x32_bf16 v[40:43], v[140:143], v[128:131], 0
    ds_read_b64_tr_b16 v[204:205], v14 offset:15360
    ds_read_b64_tr_b16 v[206:207], v14 offset:16640
    s_waitcnt lgkmcnt(15)
    v_mfma_f32_16x16x32_bf16 v[44:47], v[144:147], v[128:131], 0
    ds_read_b64_tr_b16 v[208:209], v14 offset:15392
    ds_read_b64_tr_b16 v[210:211], v14 offset:16672
    ds_read_b64_tr_b16 v[212:213], v14 offset:15424
    ds_read_b64_tr_b16 v[214:215], v14 offset:16704
    v_mfma_f32_16x16x32_bf16 v[48:51], v[148:151], v[128:131], 0
    ds_read_b64_tr_b16 v[216:217], v14 offset:15456
    ds_read_b64_tr_b16 v[218:219], v14 offset:16736
    ds_read_b64_tr_b16 v[220:221], v14 offset:15488
    v_mfma_f32_16x16x32_bf16 v[32:35], v[156:159], v[152:155], v[32:35]
    ds_read_b64_tr_b16 v[222:223], v14 offset:16768
    ds_read_b128 v[200:203], v15 offset:12288
    v_mfma_f32_16x16x32_bf16 v[36:39], v[160:163], v[152:155], v[36:39]
    v_mfma_f32_16x16x32_bf16 v[40:43], v[164:167], v[152:155], v[40:43]
    v_mfma_f32_16x16x32_bf16 v[44:47], v[168:171], v[152:155], v[44:47]
    s_waitcnt lgkmcnt(15)
    v_mfma_f32_16x16x32_bf16 v[48:51], v[172:175], v[152:155], v[48:51]
    s_waitcnt lgkmcnt(0)
    v_add_u32 v14, 69632, v12
    v_add_u32 v15, 118784, v13
    s_barrier
    ds_read_b128 v[128:131], v15 offset:0
    ds_read_b64_tr_b16 v[132:133], v14 offset:0
    v_mfma_f32_16x16x32_bf16 v[32:35], v[180:183], v[176:179], v[32:35]
    ds_read_b64_tr_b16 v[134:135], v14 offset:1280
    ds_read_b64_tr_b16 v[136:137], v14 offset:32
    ds_read_b64_tr_b16 v[138:139], v14 offset:1312
    v_mfma_f32_16x16x32_bf16 v[36:39], v[184:187], v[176:179], v[36:39]
    ds_read_b64_tr_b16 v[140:141], v14 offset:64
    ds_read_b64_tr_b16 v[142:143], v14 offset:1344
    ds_read_b64_tr_b16 v[144:145], v14 offset:96
    v_mfma_f32_16x16x32_bf16 v[40:43], v[188:191], v[176:179], v[40:43]
    ds_read_b64_tr_b16 v[146:147], v14 offset:1376
    ds_read_b64_tr_b16 v[148:149], v14 offset:128
    ds_read_b64_tr_b16 v[150:151], v14 offset:1408
    v_mfma_f32_16x16x32_bf16 v[44:47], v[192:195], v[176:179], v[44:47]
    ds_read_b128 v[152:155], v15 offset:4096
    ds_read_b64_tr_b16 v[156:157], v14 offset:5120
    v_mfma_f32_16x16x32_bf16 v[48:51], v[196:199], v[176:179], v[48:51]
    ds_read_b64_tr_b16 v[158:159], v14 offset:6400
    ds_read_b64_tr_b16 v[160:161], v14 offset:5152
    v_mfma_f32_16x16x32_bf16 v[32:35], v[204:207], v[200:203], v[32:35]
    ds_read_b64_tr_b16 v[162:163], v14 offset:6432
    ds_read_b64_tr_b16 v[164:165], v14 offset:5184
    ds_read_b64_tr_b16 v[166:167], v14 offset:6464
    v_mfma_f32_16x16x32_bf16 v[36:39], v[208:211], v[200:203], v[36:39]
    ds_read_b64_tr_b16 v[168:169], v14 offset:5216
    ds_read_b64_tr_b16 v[170:171], v14 offset:6496
    ds_read_b64_tr_b16 v[172:173], v14 offset:5248
    v_mfma_f32_16x16x32_bf16 v[40:43], v[212:215], v[200:203], v[40:43]
    ds_read_b64_tr_b16 v[174:175], v14 offset:6528
    ds_read_b64_tr_b16 v[180:181], v14 offset:10240
    ds_read_b64_tr_b16 v[182:183], v14 offset:11520
    v_mfma_f32_16x16x32_bf16 v[44:47], v[216:219], v[200:203], v[44:47]
    ds_read_b64_tr_b16 v[184:185], v14 offset:10272
    ds_read_b64_tr_b16 v[186:187], v14 offset:11552
    ds_read_b64_tr_b16 v[188:189], v14 offset:10304
    v_mfma_f32_16x16x32_bf16 v[48:51], v[220:223], v[200:203], v[48:51]
    ds_read_b64_tr_b16 v[190:191], v14 offset:11584
    ds_read_b64_tr_b16 v[192:193], v14 offset:10336
    ds_read_b64_tr_b16 v[194:195], v14 offset:11616
    s_waitcnt lgkmcnt(15)
    v_mfma_f32_16x16x32_bf16 v[32:35], v[132:135], v[128:131], v[32:35]
    ds_read_b64_tr_b16 v[196:197], v14 offset:10368
    ds_read_b64_tr_b16 v[198:199], v14 offset:11648
    v_mfma_f32_16x16x32_bf16 v[36:39], v[136:139], v[128:131], v[36:39]
    ds_read_b128 v[176:179], v15 offset:8192
    ds_read_b64_tr_b16 v[204:205], v14 offset:15360
    v_mfma_f32_16x16x32_bf16 v[40:43], v[140:143], v[128:131], v[40:43]
    ds_read_b64_tr_b16 v[206:207], v14 offset:16640
    ds_read_b64_tr_b16 v[208:209], v14 offset:15392
    ds_read_b64_tr_b16 v[210:211], v14 offset:16672
    v_mfma_f32_16x16x32_bf16 v[44:47], v[144:147], v[128:131], v[44:47]
    ds_read_b64_tr_b16 v[212:213], v14 offset:15424
    ds_read_b64_tr_b16 v[214:215], v14 offset:16704
    ds_read_b64_tr_b16 v[216:217], v14 offset:15456
    v_mfma_f32_16x16x32_bf16 v[48:51], v[148:151], v[128:131], v[48:51]
    ds_read_b64_tr_b16 v[218:219], v14 offset:16736
    ds_read_b64_tr_b16 v[220:221], v14 offset:15488
    ds_read_b64_tr_b16 v[222:223], v14 offset:16768
    v_mfma_f32_16x16x32_bf16 v[32:35], v[156:159], v[152:155], v[32:35]
    ds_read_b128 v[200:203], v15 offset:12288
    s_waitcnt lgkmcnt(15)
    v_mfma_f32_16x16x32_bf16 v[36:39], v[160:163], v[152:155], v[36:39]
    v_mfma_f32_16x16x32_bf16 v[40:43], v[164:167], v[152:155], v[40:43]
    v_mfma_f32_16x16x32_bf16 v[44:47], v[168:171], v[152:155], v[44:47]
    v_mfma_f32_16x16x32_bf16 v[48:51], v[172:175], v[152:155], v[48:51]
    s_waitcnt lgkmcnt(0)
    v_add_u32 v14, 0, v12
    v_add_u32 v15, 0, v13
    s_barrier
    ds_read_b128 v[128:131], v15 offset:0
    ds_read_b64_tr_b16 v[132:133], v14 offset:0
    v_mfma_f32_16x16x32_bf16 v[32:35], v[180:183], v[176:179], v[32:35]
    ds_read_b64_tr_b16 v[134:135], v14 offset:1280
    ds_read_b64_tr_b16 v[136:137], v14 offset:32
    ds_read_b64_tr_b16 v[138:139], v14 offset:1312
    v_mfma_f32_16x16x32_bf16 v[36:39], v[184:187], v[176:179], v[36:39]
    ds_read_b64_tr_b16 v[140:141], v14 offset:64
    ds_read_b64_tr_b16 v[142:143], v14 offset:1344
    ds_read_b64_tr_b16 v[144:145], v14 offset:96
    v_mfma_f32_16x16x32_bf16 v[40:43], v[188:191], v[176:179], v[40:43]
    ds_read_b64_tr_b16 v[146:147], v14 offset:1376
    ds_read_b64_tr_b16 v[148:149], v14 offset:128
    ds_read_b64_tr_b16 v[150:151], v14 offset:1408
    v_mfma_f32_16x16x32_bf16 v[44:47], v[192:195], v[176:179], v[44:47]
    ds_read_b128 v[152:155], v15 offset:4096
    ds_read_b64_tr_b16 v[156:157], v14 offset:5120
    v_mfma_f32_16x16x32_bf16 v[48:51], v[196:199], v[176:179], v[48:51]
    ds_read_b64_tr_b16 v[158:159], v14 offset:6400
    ds_read_b64_tr_b16 v[160:161], v14 offset:5152
    v_mfma_f32_16x16x32_bf16 v[32:35], v[204:207], v[200:203], v[32:35]
    ds_read_b64_tr_b16 v[162:163], v14 offset:6432
    ds_read_b64_tr_b16 v[164:165], v14 offset:5184
    ds_read_b64_tr_b16 v[166:167], v14 offset:6464
    v_mfma_f32_16x16x32_bf16 v[36:39], v[208:211], v[200:203], v[36:39]
    ds_read_b64_tr_b16 v[168:169], v14 offset:5216
    ds_read_b64_tr_b16 v[170:171], v14 offset:6496
    ds_read_b64_tr_b16 v[172:173], v14 offset:5248
    v_mfma_f32_16x16x32_bf16 v[40:43], v[212:215], v[200:203], v[40:43]
    ds_read_b64_tr_b16 v[174:175], v14 offset:6528
    ds_read_b64_tr_b16 v[180:181], v14 offset:10240
    ds_read_b64_tr_b16 v[182:183], v14 offset:11520
    v_mfma_f32_16x16x32_bf16 v[44:47], v[216:219], v[200:203], v[44:47]
    ds_read_b64_tr_b16 v[184:185], v14 offset:10272
    ds_read_b64_tr_b16 v[186:187], v14 offset:11552
    ds_read_b64_tr_b16 v[188:189], v14 offset:10304
    v_mfma_f32_16x16x32_bf16 v[48:51], v[220:223], v[200:203], v[48:51]
    ds_read_b64_tr_b16 v[190:191], v14 offset:11584
    ds_read_b64_tr_b16 v[192:193], v14 offset:10336
    ds_read_b64_tr_b16 v[194:195], v14 offset:11616
    s_waitcnt lgkmcnt(15)
    v_mfma_f32_16x16x32_bf16 v[32:35], v[132:135], v[128:131], v[32:35]
    ds_read_b64_tr_b16 v[196:197], v14 offset:10368
    ds_read_b64_tr_b16 v[198:199], v14 offset:11648
    v_mfma_f32_16x16x32_bf16 v[36:39], v[136:139], v[128:131], v[36:39]
    ds_read_b128 v[176:179], v15 offset:8192
    ds_read_b64_tr_b16 v[204:205], v14 offset:15360
    v_mfma_f32_16x16x32_bf16 v[40:43], v[140:143], v[128:131], v[40:43]
    ds_read_b64_tr_b16 v[206:207], v14 offset:16640
    ds_read_b64_tr_b16 v[208:209], v14 offset:15392
    ds_read_b64_tr_b16 v[210:211], v14 offset:16672
    v_mfma_f32_16x16x32_bf16 v[44:47], v[144:147], v[128:131], v[44:47]
    ds_read_b64_tr_b16 v[212:213], v14 offset:15424
    ds_read_b64_tr_b16 v[214:215], v14 offset:16704
    ds_read_b64_tr_b16 v[216:217], v14 offset:15456
    v_mfma_f32_16x16x32_bf16 v[48:51], v[148:151], v[128:131], v[48:51]
    ds_read_b64_tr_b16 v[218:219], v14 offset:16736
    ds_read_b64_tr_b16 v[220:221], v14 offset:15488
    ds_read_b64_tr_b16 v[222:223], v14 offset:16768
    v_mfma_f32_16x16x32_bf16 v[32:35], v[156:159], v[152:155], v[32:35]
    ds_read_b128 v[200:203], v15 offset:12288
    s_waitcnt lgkmcnt(15)
    v_mfma_f32_16x16x32_bf16 v[36:39], v[160:163], v[152:155], v[36:39]
    v_mfma_f32_16x16x32_bf16 v[40:43], v[164:167], v[152:155], v[40:43]
    v_mfma_f32_16x16x32_bf16 v[44:47], v[168:171], v[152:155], v[44:47]
    v_mfma_f32_16x16x32_bf16 v[48:51], v[172:175], v[152:155], v[48:51]
    s_waitcnt lgkmcnt(0)
    v_add_u32 v14, 49152, v12
    v_add_u32 v15, 102400, v13
    s_barrier
    ds_read_b128 v[128:131], v15 offset:0
    ds_read_b64_tr_b16 v[132:133], v14 offset:0
    v_mfma_f32_16x16x32_bf16 v[32:35], v[180:183], v[176:179], v[32:35]
    ds_read_b64_tr_b16 v[134:135], v14 offset:1280
    ds_read_b64_tr_b16 v[136:137], v14 offset:32
    ds_read_b64_tr_b16 v[138:139], v14 offset:1312
    v_mfma_f32_16x16x32_bf16 v[36:39], v[184:187], v[176:179], v[36:39]
    ds_read_b64_tr_b16 v[140:141], v14 offset:64
    ds_read_b64_tr_b16 v[142:143], v14 offset:1344
    ds_read_b64_tr_b16 v[144:145], v14 offset:96
    v_mfma_f32_16x16x32_bf16 v[40:43], v[188:191], v[176:179], v[40:43]
    ds_read_b64_tr_b16 v[146:147], v14 offset:1376
    ds_read_b64_tr_b16 v[148:149], v14 offset:128
    ds_read_b64_tr_b16 v[150:151], v14 offset:1408
    v_mfma_f32_16x16x32_bf16 v[44:47], v[192:195], v[176:179], v[44:47]
    ds_read_b128 v[152:155], v15 offset:4096
    ds_read_b64_tr_b16 v[156:157], v14 offset:5120
    v_mfma_f32_16x16x32_bf16 v[48:51], v[196:199], v[176:179], v[48:51]
    ds_read_b64_tr_b16 v[158:159], v14 offset:6400
    ds_read_b64_tr_b16 v[160:161], v14 offset:5152
    v_mfma_f32_16x16x32_bf16 v[32:35], v[204:207], v[200:203], v[32:35]
    ds_read_b64_tr_b16 v[162:163], v14 offset:6432
    ds_read_b64_tr_b16 v[164:165], v14 offset:5184
    ds_read_b64_tr_b16 v[166:167], v14 offset:6464
    v_mfma_f32_16x16x32_bf16 v[36:39], v[208:211], v[200:203], v[36:39]
    ds_read_b64_tr_b16 v[168:169], v14 offset:5216
    ds_read_b64_tr_b16 v[170:171], v14 offset:6496
    ds_read_b64_tr_b16 v[172:173], v14 offset:5248
    v_mfma_f32_16x16x32_bf16 v[40:43], v[212:215], v[200:203], v[40:43]
    ds_read_b64_tr_b16 v[174:175], v14 offset:6528
    ds_read_b64_tr_b16 v[180:181], v14 offset:10240
    ds_read_b64_tr_b16 v[182:183], v14 offset:11520
    v_mfma_f32_16x16x32_bf16 v[44:47], v[216:219], v[200:203], v[44:47]
    ds_read_b64_tr_b16 v[184:185], v14 offset:10272
    ds_read_b64_tr_b16 v[186:187], v14 offset:11552
    ds_read_b64_tr_b16 v[188:189], v14 offset:10304
    v_mfma_f32_16x16x32_bf16 v[48:51], v[220:223], v[200:203], v[48:51]
    ds_read_b64_tr_b16 v[190:191], v14 offset:11584
    ds_read_b64_tr_b16 v[192:193], v14 offset:10336
    ds_read_b64_tr_b16 v[194:195], v14 offset:11616
    s_waitcnt lgkmcnt(15)
    v_mfma_f32_16x16x32_bf16 v[32:35], v[132:135], v[128:131], v[32:35]
    ds_read_b64_tr_b16 v[196:197], v14 offset:10368
    ds_read_b64_tr_b16 v[198:199], v14 offset:11648
    v_mfma_f32_16x16x32_bf16 v[36:39], v[136:139], v[128:131], v[36:39]
    ds_read_b128 v[176:179], v15 offset:8192
    ds_read_b64_tr_b16 v[204:205], v14 offset:15360
    v_mfma_f32_16x16x32_bf16 v[40:43], v[140:143], v[128:131], v[40:43]
    ds_read_b64_tr_b16 v[206:207], v14 offset:16640
    ds_read_b64_tr_b16 v[208:209], v14 offset:15392
    ds_read_b64_tr_b16 v[210:211], v14 offset:16672
    v_mfma_f32_16x16x32_bf16 v[44:47], v[144:147], v[128:131], v[44:47]
    ds_read_b64_tr_b16 v[212:213], v14 offset:15424
    ds_read_b64_tr_b16 v[214:215], v14 offset:16704
    ds_read_b64_tr_b16 v[216:217], v14 offset:15456
    v_mfma_f32_16x16x32_bf16 v[48:51], v[148:151], v[128:131], v[48:51]
    ds_read_b64_tr_b16 v[218:219], v14 offset:16736
    ds_read_b64_tr_b16 v[220:221], v14 offset:15488
    ds_read_b64_tr_b16 v[222:223], v14 offset:16768
    v_mfma_f32_16x16x32_bf16 v[32:35], v[156:159], v[152:155], v[32:35]
    ds_read_b128 v[200:203], v15 offset:12288
    s_waitcnt lgkmcnt(15)
    v_mfma_f32_16x16x32_bf16 v[36:39], v[160:163], v[152:155], v[36:39]
    v_mfma_f32_16x16x32_bf16 v[40:43], v[164:167], v[152:155], v[40:43]
    v_mfma_f32_16x16x32_bf16 v[44:47], v[168:171], v[152:155], v[44:47]
    v_mfma_f32_16x16x32_bf16 v[48:51], v[172:175], v[152:155], v[48:51]
    s_waitcnt lgkmcnt(0)
    v_add_u32 v14, 69632, v12
    v_add_u32 v15, 126848, v13
    s_barrier
    ds_read_b128 v[128:131], v15 offset:0
    ds_read_b64_tr_b16 v[132:133], v14 offset:0
    v_mfma_f32_16x16x32_bf16 v[32:35], v[180:183], v[176:179], v[32:35]
    ds_read_b64_tr_b16 v[134:135], v14 offset:1280
    ds_read_b64_tr_b16 v[136:137], v14 offset:32
    ds_read_b64_tr_b16 v[138:139], v14 offset:1312
    v_mfma_f32_16x16x32_bf16 v[36:39], v[184:187], v[176:179], v[36:39]
    ds_read_b64_tr_b16 v[140:141], v14 offset:64
    ds_read_b64_tr_b16 v[142:143], v14 offset:1344
    ds_read_b64_tr_b16 v[144:145], v14 offset:96
    v_mfma_f32_16x16x32_bf16 v[40:43], v[188:191], v[176:179], v[40:43]
    ds_read_b64_tr_b16 v[146:147], v14 offset:1376
    ds_read_b64_tr_b16 v[148:149], v14 offset:128
    ds_read_b64_tr_b16 v[150:151], v14 offset:1408
    v_mfma_f32_16x16x32_bf16 v[44:47], v[192:195], v[176:179], v[44:47]
    ds_read_b128 v[152:155], v15 offset:4096
    ds_read_b64_tr_b16 v[156:157], v14 offset:5120
    v_mfma_f32_16x16x32_bf16 v[48:51], v[196:199], v[176:179], v[48:51]
    ds_read_b64_tr_b16 v[158:159], v14 offset:6400
    ds_read_b64_tr_b16 v[160:161], v14 offset:5152
    v_mfma_f32_16x16x32_bf16 v[32:35], v[204:207], v[200:203], v[32:35]
    ds_read_b64_tr_b16 v[162:163], v14 offset:6432
    ds_read_b64_tr_b16 v[164:165], v14 offset:5184
    ds_read_b64_tr_b16 v[166:167], v14 offset:6464
    v_mfma_f32_16x16x32_bf16 v[36:39], v[208:211], v[200:203], v[36:39]
    ds_read_b64_tr_b16 v[168:169], v14 offset:5216
    ds_read_b64_tr_b16 v[170:171], v14 offset:6496
    ds_read_b64_tr_b16 v[172:173], v14 offset:5248
    v_mfma_f32_16x16x32_bf16 v[40:43], v[212:215], v[200:203], v[40:43]
    ds_read_b64_tr_b16 v[174:175], v14 offset:6528
    ds_read_b64_tr_b16 v[180:181], v14 offset:10240
    ds_read_b64_tr_b16 v[182:183], v14 offset:11520
    v_mfma_f32_16x16x32_bf16 v[44:47], v[216:219], v[200:203], v[44:47]
    ds_read_b64_tr_b16 v[184:185], v14 offset:10272
    ds_read_b64_tr_b16 v[186:187], v14 offset:11552
    ds_read_b64_tr_b16 v[188:189], v14 offset:10304
    v_mfma_f32_16x16x32_bf16 v[48:51], v[220:223], v[200:203], v[48:51]
    ds_read_b64_tr_b16 v[190:191], v14 offset:11584
    ds_read_b64_tr_b16 v[192:193], v14 offset:10336
    ds_read_b64_tr_b16 v[194:195], v14 offset:11616
    s_waitcnt lgkmcnt(15)
    v_mfma_f32_16x16x32_bf16 v[32:35], v[132:135], v[128:131], v[32:35]
    ds_read_b64_tr_b16 v[196:197], v14 offset:10368
    ds_read_b64_tr_b16 v[198:199], v14 offset:11648
    v_mfma_f32_16x16x32_bf16 v[36:39], v[136:139], v[128:131], v[36:39]
    ds_read_b128 v[176:179], v15 offset:8192
    ds_read_b64_tr_b16 v[204:205], v14 offset:15360
    v_mfma_f32_16x16x32_bf16 v[40:43], v[140:143], v[128:131], v[40:43]
    ds_read_b64_tr_b16 v[206:207], v14 offset:16640
    ds_read_b64_tr_b16 v[208:209], v14 offset:15392
    ds_read_b64_tr_b16 v[210:211], v14 offset:16672
    v_mfma_f32_16x16x32_bf16 v[44:47], v[144:147], v[128:131], v[44:47]
    ds_read_b64_tr_b16 v[212:213], v14 offset:15424
    ds_read_b64_tr_b16 v[214:215], v14 offset:16704
    ds_read_b64_tr_b16 v[216:217], v14 offset:15456
    v_mfma_f32_16x16x32_bf16 v[48:51], v[148:151], v[128:131], v[48:51]
    ds_read_b64_tr_b16 v[218:219], v14 offset:16736
    ds_read_b64_tr_b16 v[220:221], v14 offset:15488
    ds_read_b64_tr_b16 v[222:223], v14 offset:16768
    v_mfma_f32_16x16x32_bf16 v[32:35], v[156:159], v[152:155], v[32:35]
    ds_read_b128 v[200:203], v15 offset:12288
    s_waitcnt lgkmcnt(15)
    v_mfma_f32_16x16x32_bf16 v[36:39], v[160:163], v[152:155], v[36:39]
    v_mfma_f32_16x16x32_bf16 v[40:43], v[164:167], v[152:155], v[40:43]
    v_mfma_f32_16x16x32_bf16 v[44:47], v[168:171], v[152:155], v[44:47]
    v_mfma_f32_16x16x32_bf16 v[48:51], v[172:175], v[152:155], v[48:51]
    s_waitcnt lgkmcnt(0)
    v_add_u32 v14, 49152, v11
    v_add_u32 v15, 90112, v10
    s_barrier
    ds_read_b64_tr_b16 v[128:129], v15 offset:0
    ds_read_b64_tr_b16 v[130:131], v15 offset:2048
    ds_read_b128 v[132:135], v14 offset:0
    v_mfma_f32_16x16x32_bf16 v[32:35], v[180:183], v[176:179], v[32:35]
    ds_read_b128 v[136:139], v14 offset:1024
    v_mfma_f32_16x16x32_bf16 v[36:39], v[184:187], v[176:179], v[36:39]
    ds_read_b128 v[140:143], v14 offset:2048
    ds_read_b128 v[144:147], v14 offset:3072
    v_mfma_f32_16x16x32_bf16 v[40:43], v[188:191], v[176:179], v[40:43]
    ds_read_b128 v[148:151], v14 offset:4096
    v_mfma_f32_16x16x32_bf16 v[44:47], v[192:195], v[176:179], v[44:47]
    ds_read_b64_tr_b16 v[152:153], v15 offset:4096
    ds_read_b64_tr_b16 v[154:155], v15 offset:6144
    ds_read_b128 v[156:159], v14 offset:5120
    v_mfma_f32_16x16x32_bf16 v[48:51], v[196:199], v[176:179], v[48:51]
    ds_read_b128 v[160:163], v14 offset:6144
    v_mfma_f32_16x16x32_bf16 v[32:35], v[204:207], v[200:203], v[32:35]
    ds_read_b128 v[164:167], v14 offset:7168
    v_mfma_f32_16x16x32_bf16 v[36:39], v[208:211], v[200:203], v[36:39]
    ds_read_b128 v[168:171], v14 offset:8192
    ds_read_b128 v[172:175], v14 offset:9216
    v_mfma_f32_16x16x32_bf16 v[40:43], v[212:215], v[200:203], v[40:43]
    ds_read_b128 v[180:183], v14 offset:10240
    v_mfma_f32_16x16x32_bf16 v[44:47], v[216:219], v[200:203], v[44:47]
    ds_read_b128 v[184:187], v14 offset:11264
    ds_read_b128 v[188:191], v14 offset:12288
    v_mfma_f32_16x16x32_bf16 v[48:51], v[220:223], v[200:203], v[48:51]
    ds_read_b128 v[192:195], v14 offset:13312
    s_waitcnt lgkmcnt(15)
    v_mfma_f32_16x16x32_bf16 v[52:55], v[132:135], v[128:131], 0
    ds_read_b128 v[196:199], v14 offset:14336
    s_waitcnt lgkmcnt(15)
    v_mfma_f32_16x16x32_bf16 v[56:59], v[136:139], v[128:131], 0
    ds_read_b64_tr_b16 v[176:177], v15 offset:8192
    ds_read_b64_tr_b16 v[178:179], v15 offset:10240
    ds_read_b128 v[204:207], v14 offset:15360
    s_waitcnt lgkmcnt(15)
    v_mfma_f32_16x16x32_bf16 v[60:63], v[140:143], v[128:131], 0
    ds_read_b128 v[208:211], v14 offset:16384
    v_mfma_f32_16x16x32_bf16 v[64:67], v[144:147], v[128:131], 0
    ds_read_b128 v[212:215], v14 offset:17408
    ds_read_b128 v[216:219], v14 offset:18432
    v_mfma_f32_16x16x32_bf16 v[68:71], v[148:151], v[128:131], 0
    ds_read_b128 v[220:223], v14 offset:19456
    s_waitcnt lgkmcnt(15)
    v_mfma_f32_16x16x32_bf16 v[52:55], v[156:159], v[152:155], v[52:55]
    ds_read_b64_tr_b16 v[200:201], v15 offset:12288
    ds_read_b64_tr_b16 v[202:203], v15 offset:14336
    v_mfma_f32_16x16x32_bf16 v[56:59], v[160:163], v[152:155], v[56:59]
    s_waitcnt lgkmcnt(15)
    v_mfma_f32_16x16x32_bf16 v[60:63], v[164:167], v[152:155], v[60:63]
    v_mfma_f32_16x16x32_bf16 v[64:67], v[168:171], v[152:155], v[64:67]
    s_waitcnt lgkmcnt(14)
    v_mfma_f32_16x16x32_bf16 v[68:71], v[172:175], v[152:155], v[68:71]
    s_waitcnt lgkmcnt(0)
    v_add_u32 v14, 122880, v11
    v_add_u32 v15, 106496, v10
    s_barrier
    ds_read_b64_tr_b16 v[128:129], v15 offset:0
    ds_read_b64_tr_b16 v[130:131], v15 offset:2048
    ds_read_b128 v[132:135], v14 offset:0
    v_mfma_f32_16x16x32_bf16 v[52:55], v[180:183], v[176:179], v[52:55]
    ds_read_b128 v[136:139], v14 offset:1024
    v_lshlrev_b32 v26, 16, v26
    v_sub_f32 v72, 1.0, v27
    v_mfma_f32_16x16x32_bf16 v[56:59], v[184:187], v[176:179], v[56:59]
    ds_read_b128 v[140:143], v14 offset:2048
    ds_read_b128 v[144:147], v14 offset:3072
    v_cvt_pk_bf16_f32 v72, v72, v72
    v_and_b32 v72, s3, v72
    v_mfma_f32_16x16x32_bf16 v[60:63], v[188:191], v[176:179], v[60:63]
    ds_read_b128 v[148:151], v14 offset:4096
    v_mul_u32_u24 v74, 1280, v20
    v_lshl_add_u32 v74, v2, 3, v74
    v_mfma_f32_16x16x32_bf16 v[64:67], v[192:195], v[176:179], v[64:67]
    ds_read_b64_tr_b16 v[152:153], v15 offset:4096
    ds_read_b64_tr_b16 v[154:155], v15 offset:6144
    ds_read_b128 v[156:159], v14 offset:5120
    s_mul_i32 s70, s61, 160
    v_and_b32 v75, 1, v2
    v_mfma_f32_16x16x32_bf16 v[68:71], v[196:199], v[176:179], v[68:71]
    ds_read_b128 v[160:163], v14 offset:6144
    v_mul_u32_u24 v75, 24, v75
    v_add_u32 v75, v75, v74
    v_mfma_f32_16x16x32_bf16 v[52:55], v[204:207], v[200:203], v[52:55]
    ds_read_b128 v[164:167], v14 offset:7168
    v_cvt_pk_bf16_f32 v33, v32, v33
    v_lshlrev_b32 v32, 16, v33
    v_mfma_f32_16x16x32_bf16 v[56:59], v[208:211], v[200:203], v[56:59]
    ds_read_b128 v[168:171], v14 offset:8192
    ds_read_b128 v[172:175], v14 offset:9216
    v_and_b32 v33, s3, v33
    v_mul_f32 v32, v32, v27
    v_mfma_f32_16x16x32_bf16 v[60:63], v[212:215], v[200:203], v[60:63]
    ds_read_b128 v[180:183], v14 offset:10240
    v_mul_f32 v33, v33, v27
    v_cvt_pk_bf16_f32 v33, v32, v33
    v_mfma_f32_16x16x32_bf16 v[64:67], v[216:219], v[200:203], v[64:67]
    ds_read_b128 v[184:187], v14 offset:11264
    ds_read_b128 v[188:191], v14 offset:12288
    v_lshlrev_b32 v32, 16, v33
    v_and_b32 v33, s3, v33
    v_mfma_f32_16x16x32_bf16 v[68:71], v[220:223], v[200:203], v[68:71]
    ds_read_b128 v[192:195], v14 offset:13312
    v_cvt_pk_bf16_f32 v35, v34, v35
    v_lshlrev_b32 v34, 16, v35
    s_waitcnt lgkmcnt(15)
    v_mfma_f32_16x16x32_bf16 v[52:55], v[132:135], v[128:131], v[52:55]
    ds_read_b128 v[196:199], v14 offset:14336
    v_and_b32 v35, s3, v35
    s_waitcnt lgkmcnt(15)
    v_mfma_f32_16x16x32_bf16 v[56:59], v[136:139], v[128:131], v[56:59]
    ds_read_b64_tr_b16 v[176:177], v15 offset:8192
    ds_read_b64_tr_b16 v[178:179], v15 offset:10240
    ds_read_b128 v[204:207], v14 offset:15360
    v_mul_f32 v34, v34, v27
    s_waitcnt lgkmcnt(15)
    v_mfma_f32_16x16x32_bf16 v[60:63], v[140:143], v[128:131], v[60:63]
    ds_read_b128 v[208:211], v14 offset:16384
    v_mul_f32 v35, v35, v27
    v_mfma_f32_16x16x32_bf16 v[64:67], v[144:147], v[128:131], v[64:67]
    ds_read_b128 v[212:215], v14 offset:17408
    ds_read_b128 v[216:219], v14 offset:18432
    v_cvt_pk_bf16_f32 v35, v34, v35
    v_mfma_f32_16x16x32_bf16 v[68:71], v[148:151], v[128:131], v[68:71]
    ds_read_b128 v[220:223], v14 offset:19456
    v_lshlrev_b32 v34, 16, v35
    s_waitcnt lgkmcnt(15)
    v_mfma_f32_16x16x32_bf16 v[52:55], v[156:159], v[152:155], v[52:55]
    ds_read_b64_tr_b16 v[200:201], v15 offset:12288
    ds_read_b64_tr_b16 v[202:203], v15 offset:14336
    v_and_b32 v35, s3, v35
    v_mfma_f32_16x16x32_bf16 v[56:59], v[160:163], v[152:155], v[56:59]
    v_cvt_pk_bf16_f32 v37, v36, v37
    s_waitcnt lgkmcnt(15)
    v_mfma_f32_16x16x32_bf16 v[60:63], v[164:167], v[152:155], v[60:63]
    v_lshlrev_b32 v36, 16, v37
    v_mfma_f32_16x16x32_bf16 v[64:67], v[168:171], v[152:155], v[64:67]
    v_and_b32 v37, s3, v37
    s_waitcnt lgkmcnt(14)
    v_mfma_f32_16x16x32_bf16 v[68:71], v[172:175], v[152:155], v[68:71]
    v_mul_f32 v36, v36, v27
    s_waitcnt lgkmcnt(0)
    v_add_u32 v14, 69632, v11
    v_add_u32 v15, 0, v10
    s_barrier
    ds_read_b64_tr_b16 v[128:129], v15 offset:0
    ds_read_b64_tr_b16 v[130:131], v15 offset:2048
    ds_read_b128 v[132:135], v14 offset:0
    v_mfma_f32_16x16x32_bf16 v[52:55], v[180:183], v[176:179], v[52:55]
    ds_read_b128 v[136:139], v14 offset:1024
    v_mul_f32 v37, v37, v27
    v_cvt_pk_bf16_f32 v37, v36, v37
    v_mfma_f32_16x16x32_bf16 v[56:59], v[184:187], v[176:179], v[56:59]
    ds_read_b128 v[140:143], v14 offset:2048
    ds_read_b128 v[144:147], v14 offset:3072
    v_lshlrev_b32 v36, 16, v37
    v_and_b32 v37, s3, v37
    v_mfma_f32_16x16x32_bf16 v[60:63], v[188:191], v[176:179], v[60:63]
    ds_read_b128 v[148:151], v14 offset:4096
    v_cvt_pk_bf16_f32 v39, v38, v39
    v_lshlrev_b32 v38, 16, v39
    v_mfma_f32_16x16x32_bf16 v[64:67], v[192:195], v[176:179], v[64:67]
    ds_read_b64_tr_b16 v[152:153], v15 offset:4096
    ds_read_b64_tr_b16 v[154:155], v15 offset:6144
    ds_read_b128 v[156:159], v14 offset:5120
    v_and_b32 v39, s3, v39
    v_mul_f32 v38, v38, v27
    v_mfma_f32_16x16x32_bf16 v[68:71], v[196:199], v[176:179], v[68:71]
    ds_read_b128 v[160:163], v14 offset:6144
    v_mul_f32 v39, v39, v27
    v_cvt_pk_bf16_f32 v39, v38, v39
    v_mfma_f32_16x16x32_bf16 v[52:55], v[204:207], v[200:203], v[52:55]
    ds_read_b128 v[164:167], v14 offset:7168
    v_lshlrev_b32 v38, 16, v39
    v_and_b32 v39, s3, v39
    v_mfma_f32_16x16x32_bf16 v[56:59], v[208:211], v[200:203], v[56:59]
    ds_read_b128 v[168:171], v14 offset:8192
    ds_read_b128 v[172:175], v14 offset:9216
    v_cvt_pk_bf16_f32 v41, v40, v41
    v_lshlrev_b32 v40, 16, v41
    v_mfma_f32_16x16x32_bf16 v[60:63], v[212:215], v[200:203], v[60:63]
    ds_read_b128 v[180:183], v14 offset:10240
    v_and_b32 v41, s3, v41
    v_mul_f32 v40, v40, v27
    v_mfma_f32_16x16x32_bf16 v[64:67], v[216:219], v[200:203], v[64:67]
    ds_read_b128 v[184:187], v14 offset:11264
    ds_read_b128 v[188:191], v14 offset:12288
    v_mul_f32 v41, v41, v27
    v_cvt_pk_bf16_f32 v41, v40, v41
    v_mfma_f32_16x16x32_bf16 v[68:71], v[220:223], v[200:203], v[68:71]
    ds_read_b128 v[192:195], v14 offset:13312
    v_lshlrev_b32 v40, 16, v41
    v_and_b32 v41, s3, v41
    s_waitcnt lgkmcnt(15)
    v_mfma_f32_16x16x32_bf16 v[52:55], v[132:135], v[128:131], v[52:55]
    ds_read_b128 v[196:199], v14 offset:14336
    v_cvt_pk_bf16_f32 v43, v42, v43
    s_waitcnt lgkmcnt(15)
    v_mfma_f32_16x16x32_bf16 v[56:59], v[136:139], v[128:131], v[56:59]
    ds_read_b64_tr_b16 v[176:177], v15 offset:8192
    ds_read_b64_tr_b16 v[178:179], v15 offset:10240
    ds_read_b128 v[204:207], v14 offset:15360
    v_lshlrev_b32 v42, 16, v43
    s_waitcnt lgkmcnt(15)
    v_mfma_f32_16x16x32_bf16 v[60:63], v[140:143], v[128:131], v[60:63]
    ds_read_b128 v[208:211], v14 offset:16384
    v_and_b32 v43, s3, v43
    v_mfma_f32_16x16x32_bf16 v[64:67], v[144:147], v[128:131], v[64:67]
    ds_read_b128 v[212:215], v14 offset:17408
    ds_read_b128 v[216:219], v14 offset:18432
    v_mul_f32 v42, v42, v27
    v_mfma_f32_16x16x32_bf16 v[68:71], v[148:151], v[128:131], v[68:71]
    ds_read_b128 v[220:223], v14 offset:19456
    v_mul_f32 v43, v43, v27
    s_waitcnt lgkmcnt(15)
    v_mfma_f32_16x16x32_bf16 v[52:55], v[156:159], v[152:155], v[52:55]
    ds_read_b64_tr_b16 v[200:201], v15 offset:12288
    ds_read_b64_tr_b16 v[202:203], v15 offset:14336
    v_cvt_pk_bf16_f32 v43, v42, v43
    v_mfma_f32_16x16x32_bf16 v[56:59], v[160:163], v[152:155], v[56:59]
    v_lshlrev_b32 v42, 16, v43
    s_waitcnt lgkmcnt(15)
    v_mfma_f32_16x16x32_bf16 v[60:63], v[164:167], v[152:155], v[60:63]
    v_and_b32 v43, s3, v43
    v_mfma_f32_16x16x32_bf16 v[64:67], v[168:171], v[152:155], v[64:67]
    v_cvt_pk_bf16_f32 v45, v44, v45
    s_waitcnt lgkmcnt(14)
    v_mfma_f32_16x16x32_bf16 v[68:71], v[172:175], v[152:155], v[68:71]
    v_lshlrev_b32 v44, 16, v45
    s_waitcnt lgkmcnt(0)
    v_add_u32 v14, 49152, v11
    v_add_u32 v15, 16384, v10
    s_barrier
    ds_read_b64_tr_b16 v[128:129], v15 offset:0
    ds_read_b64_tr_b16 v[130:131], v15 offset:2048
    ds_read_b128 v[132:135], v14 offset:0
    v_mfma_f32_16x16x32_bf16 v[52:55], v[180:183], v[176:179], v[52:55]
    ds_read_b128 v[136:139], v14 offset:1024
    v_and_b32 v45, s3, v45
    v_mul_f32 v44, v44, v27
    v_mfma_f32_16x16x32_bf16 v[56:59], v[184:187], v[176:179], v[56:59]
    ds_read_b128 v[140:143], v14 offset:2048
    ds_read_b128 v[144:147], v14 offset:3072
    v_mul_f32 v45, v45, v27
    v_cvt_pk_bf16_f32 v45, v44, v45
    v_mfma_f32_16x16x32_bf16 v[60:63], v[188:191], v[176:179], v[60:63]
    ds_read_b128 v[148:151], v14 offset:4096
    v_lshlrev_b32 v44, 16, v45
    v_and_b32 v45, s3, v45
    v_mfma_f32_16x16x32_bf16 v[64:67], v[192:195], v[176:179], v[64:67]
    ds_read_b64_tr_b16 v[152:153], v15 offset:4096
    ds_read_b64_tr_b16 v[154:155], v15 offset:6144
    ds_read_b128 v[156:159], v14 offset:5120
    v_cvt_pk_bf16_f32 v47, v46, v47
    v_lshlrev_b32 v46, 16, v47
    v_mfma_f32_16x16x32_bf16 v[68:71], v[196:199], v[176:179], v[68:71]
    ds_read_b128 v[160:163], v14 offset:6144
    v_and_b32 v47, s3, v47
    v_mul_f32 v46, v46, v27
    v_mfma_f32_16x16x32_bf16 v[52:55], v[204:207], v[200:203], v[52:55]
    ds_read_b128 v[164:167], v14 offset:7168
    v_mul_f32 v47, v47, v27
    v_cvt_pk_bf16_f32 v47, v46, v47
    v_mfma_f32_16x16x32_bf16 v[56:59], v[208:211], v[200:203], v[56:59]
    ds_read_b128 v[168:171], v14 offset:8192
    ds_read_b128 v[172:175], v14 offset:9216
    v_lshlrev_b32 v46, 16, v47
    v_and_b32 v47, s3, v47
    v_mfma_f32_16x16x32_bf16 v[60:63], v[212:215], v[200:203], v[60:63]
    ds_read_b128 v[180:183], v14 offset:10240
    v_cvt_pk_bf16_f32 v49, v48, v49
    v_lshlrev_b32 v48, 16, v49
    v_mfma_f32_16x16x32_bf16 v[64:67], v[216:219], v[200:203], v[64:67]
    ds_read_b128 v[184:187], v14 offset:11264
    ds_read_b128 v[188:191], v14 offset:12288
    v_and_b32 v49, s3, v49
    v_mul_f32 v48, v48, v27
    v_mfma_f32_16x16x32_bf16 v[68:71], v[220:223], v[200:203], v[68:71]
    ds_read_b128 v[192:195], v14 offset:13312
    v_mul_f32 v49, v49, v27
    v_cvt_pk_bf16_f32 v49, v48, v49
    s_waitcnt lgkmcnt(15)
    v_mfma_f32_16x16x32_bf16 v[52:55], v[132:135], v[128:131], v[52:55]
    ds_read_b128 v[196:199], v14 offset:14336
    v_lshlrev_b32 v48, 16, v49
    s_waitcnt lgkmcnt(15)
    v_mfma_f32_16x16x32_bf16 v[56:59], v[136:139], v[128:131], v[56:59]
    ds_read_b64_tr_b16 v[176:177], v15 offset:8192
    ds_read_b64_tr_b16 v[178:179], v15 offset:10240
    ds_read_b128 v[204:207], v14 offset:15360
    v_and_b32 v49, s3, v49
    s_waitcnt lgkmcnt(15)
    v_mfma_f32_16x16x32_bf16 v[60:63], v[140:143], v[128:131], v[60:63]
    ds_read_b128 v[208:211], v14 offset:16384
    v_cvt_pk_bf16_f32 v51, v50, v51
    v_mfma_f32_16x16x32_bf16 v[64:67], v[144:147], v[128:131], v[64:67]
    ds_read_b128 v[212:215], v14 offset:17408
    ds_read_b128 v[216:219], v14 offset:18432
    v_lshlrev_b32 v50, 16, v51
    v_mfma_f32_16x16x32_bf16 v[68:71], v[148:151], v[128:131], v[68:71]
    ds_read_b128 v[220:223], v14 offset:19456
    v_and_b32 v51, s3, v51
    s_waitcnt lgkmcnt(15)
    v_mfma_f32_16x16x32_bf16 v[52:55], v[156:159], v[152:155], v[52:55]
    ds_read_b64_tr_b16 v[200:201], v15 offset:12288
    ds_read_b64_tr_b16 v[202:203], v15 offset:14336
    v_mul_f32 v50, v50, v27
    v_mfma_f32_16x16x32_bf16 v[56:59], v[160:163], v[152:155], v[56:59]
    v_mul_f32 v51, v51, v27
    s_waitcnt lgkmcnt(15)
    v_mfma_f32_16x16x32_bf16 v[60:63], v[164:167], v[152:155], v[60:63]
    v_cvt_pk_bf16_f32 v51, v50, v51
    v_mfma_f32_16x16x32_bf16 v[64:67], v[168:171], v[152:155], v[64:67]
    v_lshlrev_b32 v50, 16, v51
    s_waitcnt lgkmcnt(14)
    v_mfma_f32_16x16x32_bf16 v[68:71], v[172:175], v[152:155], v[68:71]
    v_and_b32 v51, s3, v51
    s_waitcnt lgkmcnt(0)
    v_add_u32 v14, 106496, v11
    v_add_u32 v15, 32768, v10
    s_barrier
    ds_read_b64_tr_b16 v[128:129], v15 offset:0
    ds_read_b64_tr_b16 v[130:131], v15 offset:2048
    ds_read_b128 v[132:135], v14 offset:0
    v_mfma_f32_16x16x32_bf16 v[52:55], v[180:183], v[176:179], v[52:55]
    ds_read_b128 v[136:139], v14 offset:1024
    v_mfma_f32_16x16x32_bf16 v[56:59], v[184:187], v[176:179], v[56:59]
    ds_read_b128 v[140:143], v14 offset:2048
    ds_read_b128 v[144:147], v14 offset:3072
    v_mfma_f32_16x16x32_bf16 v[60:63], v[188:191], v[176:179], v[60:63]
    ds_read_b128 v[148:151], v14 offset:4096
    v_mfma_f32_16x16x32_bf16 v[64:67], v[192:195], v[176:179], v[64:67]
    ds_read_b64_tr_b16 v[152:153], v15 offset:4096
    ds_read_b64_tr_b16 v[154:155], v15 offset:6144
    ds_read_b128 v[156:159], v14 offset:5120
    v_mfma_f32_16x16x32_bf16 v[68:71], v[196:199], v[176:179], v[68:71]
    ds_read_b128 v[160:163], v14 offset:6144
    v_mfma_f32_16x16x32_bf16 v[52:55], v[204:207], v[200:203], v[52:55]
    ds_read_b128 v[164:167], v14 offset:7168
    v_mfma_f32_16x16x32_bf16 v[56:59], v[208:211], v[200:203], v[56:59]
    ds_read_b128 v[168:171], v14 offset:8192
    ds_read_b128 v[172:175], v14 offset:9216
    v_mfma_f32_16x16x32_bf16 v[60:63], v[212:215], v[200:203], v[60:63]
    ds_read_b128 v[180:183], v14 offset:10240
    v_mfma_f32_16x16x32_bf16 v[64:67], v[216:219], v[200:203], v[64:67]
    ds_read_b128 v[184:187], v14 offset:11264
    ds_read_b128 v[188:191], v14 offset:12288
    v_mfma_f32_16x16x32_bf16 v[68:71], v[220:223], v[200:203], v[68:71]
    ds_read_b128 v[192:195], v14 offset:13312
    s_waitcnt lgkmcnt(15)
    v_mfma_f32_16x16x32_bf16 v[52:55], v[132:135], v[128:131], v[52:55]
    ds_read_b128 v[196:199], v14 offset:14336
    s_waitcnt lgkmcnt(15)
    v_mfma_f32_16x16x32_bf16 v[56:59], v[136:139], v[128:131], v[56:59]
    ds_read_b64_tr_b16 v[176:177], v15 offset:8192
    ds_read_b64_tr_b16 v[178:179], v15 offset:10240
    ds_read_b128 v[204:207], v14 offset:15360
    s_waitcnt lgkmcnt(15)
    v_mfma_f32_16x16x32_bf16 v[60:63], v[140:143], v[128:131], v[60:63]
    ds_read_b128 v[208:211], v14 offset:16384
    v_mfma_f32_16x16x32_bf16 v[64:67], v[144:147], v[128:131], v[64:67]
    ds_read_b128 v[212:215], v14 offset:17408
    ds_read_b128 v[216:219], v14 offset:18432
    v_mfma_f32_16x16x32_bf16 v[68:71], v[148:151], v[128:131], v[68:71]
    ds_read_b128 v[220:223], v14 offset:19456
    s_waitcnt lgkmcnt(15)
    v_mfma_f32_16x16x32_bf16 v[52:55], v[156:159], v[152:155], v[52:55]
    ds_read_b64_tr_b16 v[200:201], v15 offset:12288
    ds_read_b64_tr_b16 v[202:203], v15 offset:14336
    v_mfma_f32_16x16x32_bf16 v[56:59], v[160:163], v[152:155], v[56:59]
    s_waitcnt lgkmcnt(15)
    v_mfma_f32_16x16x32_bf16 v[60:63], v[164:167], v[152:155], v[60:63]
    v_mfma_f32_16x16x32_bf16 v[64:67], v[168:171], v[152:155], v[64:67]
    s_waitcnt lgkmcnt(14)
    v_mfma_f32_16x16x32_bf16 v[68:71], v[172:175], v[152:155], v[68:71]
    s_waitcnt lgkmcnt(0)
    v_add_u32 v14, 69632, v11
    v_add_u32 v15, 143360, v10
    s_barrier
    ds_read_b64_tr_b16 v[128:129], v15 offset:0
    ds_read_b64_tr_b16 v[130:131], v15 offset:2048
    ds_read_b128 v[132:135], v14 offset:0
    v_mfma_f32_16x16x32_bf16 v[52:55], v[180:183], v[176:179], v[52:55]
    ds_read_b128 v[136:139], v14 offset:1024
    v_mfma_f32_16x16x32_bf16 v[56:59], v[184:187], v[176:179], v[56:59]
    ds_read_b128 v[140:143], v14 offset:2048
    ds_read_b128 v[144:147], v14 offset:3072
    v_mfma_f32_16x16x32_bf16 v[60:63], v[188:191], v[176:179], v[60:63]
    ds_read_b128 v[148:151], v14 offset:4096
    v_mfma_f32_16x16x32_bf16 v[64:67], v[192:195], v[176:179], v[64:67]
    ds_read_b64_tr_b16 v[152:153], v15 offset:4096
    ds_read_b64_tr_b16 v[154:155], v15 offset:6144
    ds_read_b128 v[156:159], v14 offset:5120
    v_mfma_f32_16x16x32_bf16 v[68:71], v[196:199], v[176:179], v[68:71]
    ds_read_b128 v[160:163], v14 offset:6144
    v_mfma_f32_16x16x32_bf16 v[52:55], v[204:207], v[200:203], v[52:55]
    ds_read_b128 v[164:167], v14 offset:7168
    v_mfma_f32_16x16x32_bf16 v[56:59], v[208:211], v[200:203], v[56:59]
    ds_read_b128 v[168:171], v14 offset:8192
    ds_read_b128 v[172:175], v14 offset:9216
    v_mfma_f32_16x16x32_bf16 v[60:63], v[212:215], v[200:203], v[60:63]
    ds_read_b128 v[180:183], v14 offset:10240
    v_mfma_f32_16x16x32_bf16 v[64:67], v[216:219], v[200:203], v[64:67]
    ds_read_b128 v[184:187], v14 offset:11264
    ds_read_b128 v[188:191], v14 offset:12288
    v_mfma_f32_16x16x32_bf16 v[68:71], v[220:223], v[200:203], v[68:71]
    ds_read_b128 v[192:195], v14 offset:13312
    s_waitcnt lgkmcnt(15)
    v_mfma_f32_16x16x32_bf16 v[52:55], v[132:135], v[128:131], v[52:55]
    ds_read_b128 v[196:199], v14 offset:14336
    s_waitcnt lgkmcnt(15)
    v_mfma_f32_16x16x32_bf16 v[56:59], v[136:139], v[128:131], v[56:59]
    ds_read_b64_tr_b16 v[176:177], v15 offset:8192
    ds_read_b64_tr_b16 v[178:179], v15 offset:10240
    ds_read_b128 v[204:207], v14 offset:15360
    s_waitcnt lgkmcnt(15)
    v_mfma_f32_16x16x32_bf16 v[60:63], v[140:143], v[128:131], v[60:63]
    ds_read_b128 v[208:211], v14 offset:16384
    v_mfma_f32_16x16x32_bf16 v[64:67], v[144:147], v[128:131], v[64:67]
    ds_read_b128 v[212:215], v14 offset:17408
    ds_read_b128 v[216:219], v14 offset:18432
    v_mfma_f32_16x16x32_bf16 v[68:71], v[148:151], v[128:131], v[68:71]
    ds_read_b128 v[220:223], v14 offset:19456
    s_waitcnt lgkmcnt(15)
    v_mfma_f32_16x16x32_bf16 v[52:55], v[156:159], v[152:155], v[52:55]
    ds_read_b64_tr_b16 v[200:201], v15 offset:12288
    ds_read_b64_tr_b16 v[202:203], v15 offset:14336
    v_mfma_f32_16x16x32_bf16 v[56:59], v[160:163], v[152:155], v[56:59]
    s_waitcnt lgkmcnt(15)
    v_mfma_f32_16x16x32_bf16 v[60:63], v[164:167], v[152:155], v[60:63]
    v_mfma_f32_16x16x32_bf16 v[64:67], v[168:171], v[152:155], v[64:67]
    s_waitcnt lgkmcnt(14)
    v_mfma_f32_16x16x32_bf16 v[68:71], v[172:175], v[152:155], v[68:71]
    s_waitcnt lgkmcnt(0)
    v_add_u32 v14, 49152, v11
    v_add_u32 v15, 90112, v10
    s_barrier
    ds_read_b64_tr_b16 v[128:129], v15 offset:0
    ds_read_b64_tr_b16 v[130:131], v15 offset:2048
    ds_read_b128 v[132:135], v14 offset:0
    v_mfma_f32_16x16x32_bf16 v[52:55], v[180:183], v[176:179], v[52:55]
    ds_read_b128 v[136:139], v14 offset:1024
    v_mfma_f32_16x16x32_bf16 v[56:59], v[184:187], v[176:179], v[56:59]
    ds_read_b128 v[140:143], v14 offset:2048
    ds_read_b128 v[144:147], v14 offset:3072
    v_mfma_f32_16x16x32_bf16 v[60:63], v[188:191], v[176:179], v[60:63]
    ds_read_b128 v[148:151], v14 offset:4096
    v_mfma_f32_16x16x32_bf16 v[64:67], v[192:195], v[176:179], v[64:67]
    ds_read_b64_tr_b16 v[152:153], v15 offset:4096
    ds_read_b64_tr_b16 v[154:155], v15 offset:6144
    ds_read_b128 v[156:159], v14 offset:5120
    v_mfma_f32_16x16x32_bf16 v[68:71], v[196:199], v[176:179], v[68:71]
    ds_read_b128 v[160:163], v14 offset:6144
    v_mfma_f32_16x16x32_bf16 v[52:55], v[204:207], v[200:203], v[52:55]
    ds_read_b128 v[164:167], v14 offset:7168
    v_mfma_f32_16x16x32_bf16 v[56:59], v[208:211], v[200:203], v[56:59]
    ds_read_b128 v[168:171], v14 offset:8192
    ds_read_b128 v[172:175], v14 offset:9216
    v_mfma_f32_16x16x32_bf16 v[60:63], v[212:215], v[200:203], v[60:63]
    ds_read_b128 v[180:183], v14 offset:10240
    v_mfma_f32_16x16x32_bf16 v[64:67], v[216:219], v[200:203], v[64:67]
    ds_read_b128 v[184:187], v14 offset:11264
    ds_read_b128 v[188:191], v14 offset:12288
    v_mfma_f32_16x16x32_bf16 v[68:71], v[220:223], v[200:203], v[68:71]
    ds_read_b128 v[192:195], v14 offset:13312
    s_waitcnt lgkmcnt(15)
    v_mfma_f32_16x16x32_bf16 v[52:55], v[132:135], v[128:131], v[52:55]
    ds_read_b128 v[196:199], v14 offset:14336
    s_waitcnt lgkmcnt(15)
    v_mfma_f32_16x16x32_bf16 v[56:59], v[136:139], v[128:131], v[56:59]
    ds_read_b64_tr_b16 v[176:177], v15 offset:8192
    ds_read_b64_tr_b16 v[178:179], v15 offset:10240
    ds_read_b128 v[204:207], v14 offset:15360
    s_waitcnt lgkmcnt(15)
    v_mfma_f32_16x16x32_bf16 v[60:63], v[140:143], v[128:131], v[60:63]
    ds_read_b128 v[208:211], v14 offset:16384
    v_mfma_f32_16x16x32_bf16 v[64:67], v[144:147], v[128:131], v[64:67]
    ds_read_b128 v[212:215], v14 offset:17408
    ds_read_b128 v[216:219], v14 offset:18432
    v_mfma_f32_16x16x32_bf16 v[68:71], v[148:151], v[128:131], v[68:71]
    ds_read_b128 v[220:223], v14 offset:19456
    s_waitcnt lgkmcnt(15)
    v_mfma_f32_16x16x32_bf16 v[52:55], v[156:159], v[152:155], v[52:55]
    ds_read_b64_tr_b16 v[200:201], v15 offset:12288
    ds_read_b64_tr_b16 v[202:203], v15 offset:14336
    v_mfma_f32_16x16x32_bf16 v[56:59], v[160:163], v[152:155], v[56:59]
    s_waitcnt lgkmcnt(15)
    v_mfma_f32_16x16x32_bf16 v[60:63], v[164:167], v[152:155], v[60:63]
    v_mfma_f32_16x16x32_bf16 v[64:67], v[168:171], v[152:155], v[64:67]
    s_waitcnt lgkmcnt(14)
    v_mfma_f32_16x16x32_bf16 v[68:71], v[172:175], v[152:155], v[68:71]
    s_waitcnt lgkmcnt(0)
    v_add_u32 v14, 106496, v11
    v_add_u32 v15, 126976, v10
    s_barrier
    ds_read_b64_tr_b16 v[128:129], v15 offset:0
    ds_read_b64_tr_b16 v[130:131], v15 offset:2048
    ds_read_b128 v[132:135], v14 offset:0
    v_mfma_f32_16x16x32_bf16 v[52:55], v[180:183], v[176:179], v[52:55]
    ds_read_b128 v[136:139], v14 offset:1024
    v_mfma_f32_16x16x32_bf16 v[56:59], v[184:187], v[176:179], v[56:59]
    ds_read_b128 v[140:143], v14 offset:2048
    ds_read_b128 v[144:147], v14 offset:3072
    v_mfma_f32_16x16x32_bf16 v[60:63], v[188:191], v[176:179], v[60:63]
    ds_read_b128 v[148:151], v14 offset:4096
    v_mfma_f32_16x16x32_bf16 v[64:67], v[192:195], v[176:179], v[64:67]
    ds_read_b64_tr_b16 v[152:153], v15 offset:4096
    ds_read_b64_tr_b16 v[154:155], v15 offset:6144
    ds_read_b128 v[156:159], v14 offset:5120
    v_mfma_f32_16x16x32_bf16 v[68:71], v[196:199], v[176:179], v[68:71]
    ds_read_b128 v[160:163], v14 offset:6144
    v_mfma_f32_16x16x32_bf16 v[52:55], v[204:207], v[200:203], v[52:55]
    ds_read_b128 v[164:167], v14 offset:7168
    v_mfma_f32_16x16x32_bf16 v[56:59], v[208:211], v[200:203], v[56:59]
    ds_read_b128 v[168:171], v14 offset:8192
    ds_read_b128 v[172:175], v14 offset:9216
    v_mfma_f32_16x16x32_bf16 v[60:63], v[212:215], v[200:203], v[60:63]
    ds_read_b128 v[180:183], v14 offset:10240
    v_mfma_f32_16x16x32_bf16 v[64:67], v[216:219], v[200:203], v[64:67]
    ds_read_b128 v[184:187], v14 offset:11264
    ds_read_b128 v[188:191], v14 offset:12288
    v_mfma_f32_16x16x32_bf16 v[68:71], v[220:223], v[200:203], v[68:71]
    ds_read_b128 v[192:195], v14 offset:13312
    s_waitcnt lgkmcnt(15)
    v_mfma_f32_16x16x32_bf16 v[52:55], v[132:135], v[128:131], v[52:55]
    ds_read_b128 v[196:199], v14 offset:14336
    s_waitcnt lgkmcnt(15)
    v_mfma_f32_16x16x32_bf16 v[56:59], v[136:139], v[128:131], v[56:59]
    ds_read_b64_tr_b16 v[176:177], v15 offset:8192
    ds_read_b64_tr_b16 v[178:179], v15 offset:10240
    ds_read_b128 v[204:207], v14 offset:15360
    s_waitcnt lgkmcnt(15)
    v_mfma_f32_16x16x32_bf16 v[60:63], v[140:143], v[128:131], v[60:63]
    ds_read_b128 v[208:211], v14 offset:16384
    v_mfma_f32_16x16x32_bf16 v[64:67], v[144:147], v[128:131], v[64:67]
    ds_read_b128 v[212:215], v14 offset:17408
    ds_read_b128 v[216:219], v14 offset:18432
    v_mfma_f32_16x16x32_bf16 v[68:71], v[148:151], v[128:131], v[68:71]
    ds_read_b128 v[220:223], v14 offset:19456
    s_waitcnt lgkmcnt(15)
    v_mfma_f32_16x16x32_bf16 v[52:55], v[156:159], v[152:155], v[52:55]
    ds_read_b64_tr_b16 v[200:201], v15 offset:12288
    ds_read_b64_tr_b16 v[202:203], v15 offset:14336
    v_mfma_f32_16x16x32_bf16 v[56:59], v[160:163], v[152:155], v[56:59]
    s_waitcnt lgkmcnt(15)
    v_mfma_f32_16x16x32_bf16 v[60:63], v[164:167], v[152:155], v[60:63]
    v_mfma_f32_16x16x32_bf16 v[64:67], v[168:171], v[152:155], v[64:67]
    s_waitcnt lgkmcnt(14)
    v_mfma_f32_16x16x32_bf16 v[68:71], v[172:175], v[152:155], v[68:71]
    s_waitcnt lgkmcnt(0)
    v_add_u32 v14, 69632, v11
    v_add_u32 v15, 0, v10
    s_barrier
    ds_read_b64_tr_b16 v[128:129], v15 offset:0
    ds_read_b64_tr_b16 v[130:131], v15 offset:2048
    ds_read_b128 v[132:135], v14 offset:0
    v_mfma_f32_16x16x32_bf16 v[52:55], v[180:183], v[176:179], v[52:55]
    ds_read_b128 v[136:139], v14 offset:1024
    v_mfma_f32_16x16x32_bf16 v[56:59], v[184:187], v[176:179], v[56:59]
    ds_read_b128 v[140:143], v14 offset:2048
    ds_read_b128 v[144:147], v14 offset:3072
    v_mfma_f32_16x16x32_bf16 v[60:63], v[188:191], v[176:179], v[60:63]
    ds_read_b128 v[148:151], v14 offset:4096
    v_mfma_f32_16x16x32_bf16 v[64:67], v[192:195], v[176:179], v[64:67]
    ds_read_b64_tr_b16 v[152:153], v15 offset:4096
    ds_read_b64_tr_b16 v[154:155], v15 offset:6144
    ds_read_b128 v[156:159], v14 offset:5120
    v_mfma_f32_16x16x32_bf16 v[68:71], v[196:199], v[176:179], v[68:71]
    ds_read_b128 v[160:163], v14 offset:6144
    v_mfma_f32_16x16x32_bf16 v[52:55], v[204:207], v[200:203], v[52:55]
    ds_read_b128 v[164:167], v14 offset:7168
    v_mfma_f32_16x16x32_bf16 v[56:59], v[208:211], v[200:203], v[56:59]
    ds_read_b128 v[168:171], v14 offset:8192
    ds_read_b128 v[172:175], v14 offset:9216
    v_mfma_f32_16x16x32_bf16 v[60:63], v[212:215], v[200:203], v[60:63]
    ds_read_b128 v[180:183], v14 offset:10240
    v_mfma_f32_16x16x32_bf16 v[64:67], v[216:219], v[200:203], v[64:67]
    ds_read_b128 v[184:187], v14 offset:11264
    ds_read_b128 v[188:191], v14 offset:12288
    v_mfma_f32_16x16x32_bf16 v[68:71], v[220:223], v[200:203], v[68:71]
    ds_read_b128 v[192:195], v14 offset:13312
    s_waitcnt lgkmcnt(15)
    v_mfma_f32_16x16x32_bf16 v[52:55], v[132:135], v[128:131], v[52:55]
    ds_read_b128 v[196:199], v14 offset:14336
    s_waitcnt lgkmcnt(15)
    v_mfma_f32_16x16x32_bf16 v[56:59], v[136:139], v[128:131], v[56:59]
    ds_read_b64_tr_b16 v[176:177], v15 offset:8192
    ds_read_b64_tr_b16 v[178:179], v15 offset:10240
    ds_read_b128 v[204:207], v14 offset:15360
    s_waitcnt lgkmcnt(15)
    v_mfma_f32_16x16x32_bf16 v[60:63], v[140:143], v[128:131], v[60:63]
    ds_read_b128 v[208:211], v14 offset:16384
    v_mfma_f32_16x16x32_bf16 v[64:67], v[144:147], v[128:131], v[64:67]
    ds_read_b128 v[212:215], v14 offset:17408
    ds_read_b128 v[216:219], v14 offset:18432
    v_mfma_f32_16x16x32_bf16 v[68:71], v[148:151], v[128:131], v[68:71]
    ds_read_b128 v[220:223], v14 offset:19456
    s_waitcnt lgkmcnt(15)
    v_mfma_f32_16x16x32_bf16 v[52:55], v[156:159], v[152:155], v[52:55]
    ds_read_b64_tr_b16 v[200:201], v15 offset:12288
    ds_read_b64_tr_b16 v[202:203], v15 offset:14336
    v_mfma_f32_16x16x32_bf16 v[56:59], v[160:163], v[152:155], v[56:59]
    s_waitcnt lgkmcnt(15)
    v_mfma_f32_16x16x32_bf16 v[60:63], v[164:167], v[152:155], v[60:63]
    v_mfma_f32_16x16x32_bf16 v[64:67], v[168:171], v[152:155], v[64:67]
    s_waitcnt lgkmcnt(14)
    v_mfma_f32_16x16x32_bf16 v[68:71], v[172:175], v[152:155], v[68:71]
    s_waitcnt lgkmcnt(0)
    v_add_u32 v14, 49152, v11
    v_add_u32 v15, 16384, v10
    s_barrier
    ds_read_b64_tr_b16 v[128:129], v15 offset:0
    ds_read_b64_tr_b16 v[130:131], v15 offset:2048
    ds_read_b128 v[132:135], v14 offset:0
    v_mfma_f32_16x16x32_bf16 v[52:55], v[180:183], v[176:179], v[52:55]
    ds_read_b128 v[136:139], v14 offset:1024
    v_mfma_f32_16x16x32_bf16 v[56:59], v[184:187], v[176:179], v[56:59]
    ds_read_b128 v[140:143], v14 offset:2048
    ds_read_b128 v[144:147], v14 offset:3072
    v_mfma_f32_16x16x32_bf16 v[60:63], v[188:191], v[176:179], v[60:63]
    ds_read_b128 v[148:151], v14 offset:4096
    v_mfma_f32_16x16x32_bf16 v[64:67], v[192:195], v[176:179], v[64:67]
    ds_read_b64_tr_b16 v[152:153], v15 offset:4096
    ds_read_b64_tr_b16 v[154:155], v15 offset:6144
    ds_read_b128 v[156:159], v14 offset:5120
    v_mfma_f32_16x16x32_bf16 v[68:71], v[196:199], v[176:179], v[68:71]
    ds_read_b128 v[160:163], v14 offset:6144
    v_mfma_f32_16x16x32_bf16 v[52:55], v[204:207], v[200:203], v[52:55]
    ds_read_b128 v[164:167], v14 offset:7168
    v_mfma_f32_16x16x32_bf16 v[56:59], v[208:211], v[200:203], v[56:59]
    ds_read_b128 v[168:171], v14 offset:8192
    ds_read_b128 v[172:175], v14 offset:9216
    v_mfma_f32_16x16x32_bf16 v[60:63], v[212:215], v[200:203], v[60:63]
    ds_read_b128 v[180:183], v14 offset:10240
    v_mfma_f32_16x16x32_bf16 v[64:67], v[216:219], v[200:203], v[64:67]
    ds_read_b128 v[184:187], v14 offset:11264
    ds_read_b128 v[188:191], v14 offset:12288
    v_mfma_f32_16x16x32_bf16 v[68:71], v[220:223], v[200:203], v[68:71]
    ds_read_b128 v[192:195], v14 offset:13312
    s_waitcnt lgkmcnt(15)
    v_mfma_f32_16x16x32_bf16 v[52:55], v[132:135], v[128:131], v[52:55]
    ds_read_b128 v[196:199], v14 offset:14336
    s_waitcnt lgkmcnt(15)
    v_mfma_f32_16x16x32_bf16 v[56:59], v[136:139], v[128:131], v[56:59]
    ds_read_b64_tr_b16 v[176:177], v15 offset:8192
    ds_read_b64_tr_b16 v[178:179], v15 offset:10240
    ds_read_b128 v[204:207], v14 offset:15360
    s_waitcnt lgkmcnt(15)
    v_mfma_f32_16x16x32_bf16 v[60:63], v[140:143], v[128:131], v[60:63]
    ds_read_b128 v[208:211], v14 offset:16384
    v_mfma_f32_16x16x32_bf16 v[64:67], v[144:147], v[128:131], v[64:67]
    ds_read_b128 v[212:215], v14 offset:17408
    ds_read_b128 v[216:219], v14 offset:18432
    v_mfma_f32_16x16x32_bf16 v[68:71], v[148:151], v[128:131], v[68:71]
    ds_read_b128 v[220:223], v14 offset:19456
    s_waitcnt lgkmcnt(15)
    v_mfma_f32_16x16x32_bf16 v[52:55], v[156:159], v[152:155], v[52:55]
    ds_read_b64_tr_b16 v[200:201], v15 offset:12288
    ds_read_b64_tr_b16 v[202:203], v15 offset:14336
    v_mfma_f32_16x16x32_bf16 v[56:59], v[160:163], v[152:155], v[56:59]
    s_waitcnt lgkmcnt(15)
    v_mfma_f32_16x16x32_bf16 v[60:63], v[164:167], v[152:155], v[60:63]
    v_mfma_f32_16x16x32_bf16 v[64:67], v[168:171], v[152:155], v[64:67]
    s_waitcnt lgkmcnt(14)
    v_mfma_f32_16x16x32_bf16 v[68:71], v[172:175], v[152:155], v[68:71]
    s_waitcnt lgkmcnt(0)
    v_add_u32 v14, 90112, v11
    v_add_u32 v15, 32768, v10
    s_barrier
    ds_read_b64_tr_b16 v[128:129], v15 offset:0
    ds_read_b64_tr_b16 v[130:131], v15 offset:2048
    ds_read_b128 v[132:135], v14 offset:0
    v_mfma_f32_16x16x32_bf16 v[52:55], v[180:183], v[176:179], v[52:55]
    ds_read_b128 v[136:139], v14 offset:1024
    v_mfma_f32_16x16x32_bf16 v[56:59], v[184:187], v[176:179], v[56:59]
    ds_read_b128 v[140:143], v14 offset:2048
    ds_read_b128 v[144:147], v14 offset:3072
    v_mfma_f32_16x16x32_bf16 v[60:63], v[188:191], v[176:179], v[60:63]
    ds_read_b128 v[148:151], v14 offset:4096
    v_mfma_f32_16x16x32_bf16 v[64:67], v[192:195], v[176:179], v[64:67]
    ds_read_b64_tr_b16 v[152:153], v15 offset:4096
    ds_read_b64_tr_b16 v[154:155], v15 offset:6144
    ds_read_b128 v[156:159], v14 offset:5120
    v_mfma_f32_16x16x32_bf16 v[68:71], v[196:199], v[176:179], v[68:71]
    ds_read_b128 v[160:163], v14 offset:6144
    v_mfma_f32_16x16x32_bf16 v[52:55], v[204:207], v[200:203], v[52:55]
    ds_read_b128 v[164:167], v14 offset:7168
    v_mfma_f32_16x16x32_bf16 v[56:59], v[208:211], v[200:203], v[56:59]
    ds_read_b128 v[168:171], v14 offset:8192
    ds_read_b128 v[172:175], v14 offset:9216
    v_mfma_f32_16x16x32_bf16 v[60:63], v[212:215], v[200:203], v[60:63]
    ds_read_b128 v[180:183], v14 offset:10240
    v_mfma_f32_16x16x32_bf16 v[64:67], v[216:219], v[200:203], v[64:67]
    ds_read_b128 v[184:187], v14 offset:11264
    ds_read_b128 v[188:191], v14 offset:12288
    v_mfma_f32_16x16x32_bf16 v[68:71], v[220:223], v[200:203], v[68:71]
    ds_read_b128 v[192:195], v14 offset:13312
    s_waitcnt lgkmcnt(15)
    v_mfma_f32_16x16x32_bf16 v[52:55], v[132:135], v[128:131], v[52:55]
    ds_read_b128 v[196:199], v14 offset:14336
    s_waitcnt lgkmcnt(15)
    v_mfma_f32_16x16x32_bf16 v[56:59], v[136:139], v[128:131], v[56:59]
    ds_read_b64_tr_b16 v[176:177], v15 offset:8192
    ds_read_b64_tr_b16 v[178:179], v15 offset:10240
    ds_read_b128 v[204:207], v14 offset:15360
    s_waitcnt lgkmcnt(15)
    v_mfma_f32_16x16x32_bf16 v[60:63], v[140:143], v[128:131], v[60:63]
    ds_read_b128 v[208:211], v14 offset:16384
    v_mfma_f32_16x16x32_bf16 v[64:67], v[144:147], v[128:131], v[64:67]
    ds_read_b128 v[212:215], v14 offset:17408
    ds_read_b128 v[216:219], v14 offset:18432
    v_mfma_f32_16x16x32_bf16 v[68:71], v[148:151], v[128:131], v[68:71]
    ds_read_b128 v[220:223], v14 offset:19456
    s_waitcnt lgkmcnt(15)
    v_mfma_f32_16x16x32_bf16 v[52:55], v[156:159], v[152:155], v[52:55]
    ds_read_b64_tr_b16 v[200:201], v15 offset:12288
    ds_read_b64_tr_b16 v[202:203], v15 offset:14336
    v_mfma_f32_16x16x32_bf16 v[56:59], v[160:163], v[152:155], v[56:59]
    s_waitcnt lgkmcnt(15)
    v_mfma_f32_16x16x32_bf16 v[60:63], v[164:167], v[152:155], v[60:63]
    v_mfma_f32_16x16x32_bf16 v[64:67], v[168:171], v[152:155], v[64:67]
    s_waitcnt lgkmcnt(14)
    v_mfma_f32_16x16x32_bf16 v[68:71], v[172:175], v[152:155], v[68:71]
    s_waitcnt lgkmcnt(0)
    v_add_u32 v14, 69632, v11
    v_add_u32 v15, 143360, v10
    s_barrier
    ds_read_b64_tr_b16 v[128:129], v15 offset:0
    ds_read_b64_tr_b16 v[130:131], v15 offset:2048
    ds_read_b128 v[132:135], v14 offset:0
    v_mfma_f32_16x16x32_bf16 v[52:55], v[180:183], v[176:179], v[52:55]
    ds_read_b128 v[136:139], v14 offset:1024
    v_mfma_f32_16x16x32_bf16 v[56:59], v[184:187], v[176:179], v[56:59]
    ds_read_b128 v[140:143], v14 offset:2048
    ds_read_b128 v[144:147], v14 offset:3072
    v_mfma_f32_16x16x32_bf16 v[60:63], v[188:191], v[176:179], v[60:63]
    ds_read_b128 v[148:151], v14 offset:4096
    v_mfma_f32_16x16x32_bf16 v[64:67], v[192:195], v[176:179], v[64:67]
    ds_read_b64_tr_b16 v[152:153], v15 offset:4096
    ds_read_b64_tr_b16 v[154:155], v15 offset:6144
    ds_read_b128 v[156:159], v14 offset:5120
    v_mfma_f32_16x16x32_bf16 v[68:71], v[196:199], v[176:179], v[68:71]
    ds_read_b128 v[160:163], v14 offset:6144
    v_mfma_f32_16x16x32_bf16 v[52:55], v[204:207], v[200:203], v[52:55]
    ds_read_b128 v[164:167], v14 offset:7168
    v_mfma_f32_16x16x32_bf16 v[56:59], v[208:211], v[200:203], v[56:59]
    ds_read_b128 v[168:171], v14 offset:8192
    ds_read_b128 v[172:175], v14 offset:9216
    v_mfma_f32_16x16x32_bf16 v[60:63], v[212:215], v[200:203], v[60:63]
    ds_read_b128 v[180:183], v14 offset:10240
    v_mfma_f32_16x16x32_bf16 v[64:67], v[216:219], v[200:203], v[64:67]
    ds_read_b128 v[184:187], v14 offset:11264
    ds_read_b128 v[188:191], v14 offset:12288
    v_mfma_f32_16x16x32_bf16 v[68:71], v[220:223], v[200:203], v[68:71]
    ds_read_b128 v[192:195], v14 offset:13312
    s_waitcnt lgkmcnt(15)
    v_mfma_f32_16x16x32_bf16 v[52:55], v[132:135], v[128:131], v[52:55]
    ds_read_b128 v[196:199], v14 offset:14336
    s_waitcnt lgkmcnt(15)
    v_mfma_f32_16x16x32_bf16 v[56:59], v[136:139], v[128:131], v[56:59]
    ds_read_b64_tr_b16 v[176:177], v15 offset:8192
    ds_read_b64_tr_b16 v[178:179], v15 offset:10240
    ds_read_b128 v[204:207], v14 offset:15360
    s_waitcnt lgkmcnt(15)
    v_mfma_f32_16x16x32_bf16 v[60:63], v[140:143], v[128:131], v[60:63]
    ds_read_b128 v[208:211], v14 offset:16384
    v_mfma_f32_16x16x32_bf16 v[64:67], v[144:147], v[128:131], v[64:67]
    ds_read_b128 v[212:215], v14 offset:17408
    ds_read_b128 v[216:219], v14 offset:18432
    v_mfma_f32_16x16x32_bf16 v[68:71], v[148:151], v[128:131], v[68:71]
    ds_read_b128 v[220:223], v14 offset:19456
    s_waitcnt lgkmcnt(15)
    v_mfma_f32_16x16x32_bf16 v[52:55], v[156:159], v[152:155], v[52:55]
    ds_read_b64_tr_b16 v[200:201], v15 offset:12288
    ds_read_b64_tr_b16 v[202:203], v15 offset:14336
    v_mfma_f32_16x16x32_bf16 v[56:59], v[160:163], v[152:155], v[56:59]
    s_waitcnt lgkmcnt(15)
    v_mfma_f32_16x16x32_bf16 v[60:63], v[164:167], v[152:155], v[60:63]
    v_mfma_f32_16x16x32_bf16 v[64:67], v[168:171], v[152:155], v[64:67]
    s_waitcnt lgkmcnt(14)
    v_mfma_f32_16x16x32_bf16 v[68:71], v[172:175], v[152:155], v[68:71]
    s_waitcnt lgkmcnt(0)
    v_mfma_f32_16x16x32_bf16 v[52:55], v[180:183], v[176:179], v[52:55]
    v_mfma_f32_16x16x32_bf16 v[56:59], v[184:187], v[176:179], v[56:59]
    v_mfma_f32_16x16x32_bf16 v[60:63], v[188:191], v[176:179], v[60:63]
    v_mfma_f32_16x16x32_bf16 v[64:67], v[192:195], v[176:179], v[64:67]
    v_mfma_f32_16x16x32_bf16 v[68:71], v[196:199], v[176:179], v[68:71]
    v_mfma_f32_16x16x32_bf16 v[52:55], v[204:207], v[200:203], v[52:55]
    v_mfma_f32_16x16x32_bf16 v[56:59], v[208:211], v[200:203], v[56:59]
    v_mfma_f32_16x16x32_bf16 v[60:63], v[212:215], v[200:203], v[60:63]
    v_mfma_f32_16x16x32_bf16 v[64:67], v[216:219], v[200:203], v[64:67]
    v_mfma_f32_16x16x32_bf16 v[68:71], v[220:223], v[200:203], v[68:71]
    s_nop 3
    v_cvt_pk_bf16_f32 v53, v52, v53
    v_lshlrev_b32 v52, 16, v53
    v_and_b32 v53, s3, v53
    v_cvt_pk_bf16_f32 v55, v54, v55
    v_lshlrev_b32 v54, 16, v55
    v_and_b32 v55, s3, v55
    v_pk_add_f32 v[52:53], v[52:53], v[26:27] op_sel_hi:[1,0]
    v_pk_add_f32 v[54:55], v[54:55], v[26:27] op_sel_hi:[1,0]
    v_cvt_pk_bf16_f32 v53, v52, v53
    v_lshlrev_b32 v52, 16, v53
    v_and_b32 v53, s3, v53
    v_cvt_pk_bf16_f32 v55, v54, v55
    v_lshlrev_b32 v54, 16, v55
    v_and_b32 v55, s3, v55
    v_pk_mul_f32 v[52:53], v[52:53], v[72:73] op_sel_hi:[1,0]
    v_pk_mul_f32 v[54:55], v[54:55], v[72:73] op_sel_hi:[1,0]
    v_cvt_pk_bf16_f32 v53, v52, v53
    v_lshlrev_b32 v52, 16, v53
    v_and_b32 v53, s3, v53
    v_cvt_pk_bf16_f32 v55, v54, v55
    v_lshlrev_b32 v54, 16, v55
    v_and_b32 v55, s3, v55
    v_pk_add_f32 v[32:33], v[32:33], v[52:53]
    v_pk_add_f32 v[34:35], v[34:35], v[54:55]
    v_cvt_pk_bf16_f32 v76, v32, v33
    v_cvt_pk_bf16_f32 v77, v34, v35
    v_cvt_pk_bf16_f32 v57, v56, v57
    v_lshlrev_b32 v56, 16, v57
    v_and_b32 v57, s3, v57
    v_cvt_pk_bf16_f32 v59, v58, v59
    v_lshlrev_b32 v58, 16, v59
    v_and_b32 v59, s3, v59
    v_pk_add_f32 v[56:57], v[56:57], v[26:27] op_sel_hi:[1,0]
    v_pk_add_f32 v[58:59], v[58:59], v[26:27] op_sel_hi:[1,0]
    v_cvt_pk_bf16_f32 v57, v56, v57
    v_lshlrev_b32 v56, 16, v57
    v_and_b32 v57, s3, v57
    v_cvt_pk_bf16_f32 v59, v58, v59
    v_lshlrev_b32 v58, 16, v59
    v_and_b32 v59, s3, v59
    v_pk_mul_f32 v[56:57], v[56:57], v[72:73] op_sel_hi:[1,0]
    v_pk_mul_f32 v[58:59], v[58:59], v[72:73] op_sel_hi:[1,0]
    v_cvt_pk_bf16_f32 v57, v56, v57
    v_lshlrev_b32 v56, 16, v57
    v_and_b32 v57, s3, v57
    v_cvt_pk_bf16_f32 v59, v58, v59
    v_lshlrev_b32 v58, 16, v59
    v_and_b32 v59, s3, v59
    v_pk_add_f32 v[36:37], v[36:37], v[56:57]
    v_pk_add_f32 v[38:39], v[38:39], v[58:59]
    v_cvt_pk_bf16_f32 v78, v36, v37
    v_cvt_pk_bf16_f32 v79, v38, v39
    s_nop 0
    v_permlane16_swap_b32 v76, v78
    v_permlane16_swap_b32 v77, v79
    buffer_store_dwordx4 v[76:79], v75, s[36:39], s70 offen offset:0
    v_cvt_pk_bf16_f32 v61, v60, v61
    v_lshlrev_b32 v60, 16, v61
    v_and_b32 v61, s3, v61
    v_cvt_pk_bf16_f32 v63, v62, v63
    v_lshlrev_b32 v62, 16, v63
    v_and_b32 v63, s3, v63
    v_pk_add_f32 v[60:61], v[60:61], v[26:27] op_sel_hi:[1,0]
    v_pk_add_f32 v[62:63], v[62:63], v[26:27] op_sel_hi:[1,0]
    v_cvt_pk_bf16_f32 v61, v60, v61
    v_lshlrev_b32 v60, 16, v61
    v_and_b32 v61, s3, v61
    v_cvt_pk_bf16_f32 v63, v62, v63
    v_lshlrev_b32 v62, 16, v63
    v_and_b32 v63, s3, v63
    v_pk_mul_f32 v[60:61], v[60:61], v[72:73] op_sel_hi:[1,0]
    v_pk_mul_f32 v[62:63], v[62:63], v[72:73] op_sel_hi:[1,0]
    v_cvt_pk_bf16_f32 v61, v60, v61
    v_lshlrev_b32 v60, 16, v61
    v_and_b32 v61, s3, v61
    v_cvt_pk_bf16_f32 v63, v62, v63
    v_lshlrev_b32 v62, 16, v63
    v_and_b32 v63, s3, v63
    v_pk_add_f32 v[40:41], v[40:41], v[60:61]
    v_pk_add_f32 v[42:43], v[42:43], v[62:63]
    v_cvt_pk_bf16_f32 v80, v40, v41
    v_cvt_pk_bf16_f32 v81, v42, v43
    v_cvt_pk_bf16_f32 v65, v64, v65
    v_lshlrev_b32 v64, 16, v65
    v_and_b32 v65, s3, v65
    v_cvt_pk_bf16_f32 v67, v66, v67
    v_lshlrev_b32 v66, 16, v67
    v_and_b32 v67, s3, v67
    v_pk_add_f32 v[64:65], v[64:65], v[26:27] op_sel_hi:[1,0]
    v_pk_add_f32 v[66:67], v[66:67], v[26:27] op_sel_hi:[1,0]
    v_cvt_pk_bf16_f32 v65, v64, v65
    v_lshlrev_b32 v64, 16, v65
    v_and_b32 v65, s3, v65
    v_cvt_pk_bf16_f32 v67, v66, v67
    v_lshlrev_b32 v66, 16, v67
    v_and_b32 v67, s3, v67
    v_pk_mul_f32 v[64:65], v[64:65], v[72:73] op_sel_hi:[1,0]
    v_pk_mul_f32 v[66:67], v[66:67], v[72:73] op_sel_hi:[1,0]
    v_cvt_pk_bf16_f32 v65, v64, v65
    v_lshlrev_b32 v64, 16, v65
    v_and_b32 v65, s3, v65
    v_cvt_pk_bf16_f32 v67, v66, v67
    v_lshlrev_b32 v66, 16, v67
    v_and_b32 v67, s3, v67
    v_pk_add_f32 v[44:45], v[44:45], v[64:65]
    v_pk_add_f32 v[46:47], v[46:47], v[66:67]
    v_cvt_pk_bf16_f32 v82, v44, v45
    v_cvt_pk_bf16_f32 v83, v46, v47
    s_nop 0
    v_permlane16_swap_b32 v80, v82
    v_permlane16_swap_b32 v81, v83
    buffer_store_dwordx4 v[80:83], v75, s[36:39], s70 offen offset:64
    v_cvt_pk_bf16_f32 v69, v68, v69
    v_lshlrev_b32 v68, 16, v69
    v_and_b32 v69, s3, v69
    v_cvt_pk_bf16_f32 v71, v70, v71
    v_lshlrev_b32 v70, 16, v71
    v_and_b32 v71, s3, v71
    v_pk_add_f32 v[68:69], v[68:69], v[26:27] op_sel_hi:[1,0]
    v_pk_add_f32 v[70:71], v[70:71], v[26:27] op_sel_hi:[1,0]
    v_cvt_pk_bf16_f32 v69, v68, v69
    v_lshlrev_b32 v68, 16, v69
    v_and_b32 v69, s3, v69
    v_cvt_pk_bf16_f32 v71, v70, v71
    v_lshlrev_b32 v70, 16, v71
    v_and_b32 v71, s3, v71
    v_pk_mul_f32 v[68:69], v[68:69], v[72:73] op_sel_hi:[1,0]
    v_pk_mul_f32 v[70:71], v[70:71], v[72:73] op_sel_hi:[1,0]
    v_cvt_pk_bf16_f32 v69, v68, v69
    v_lshlrev_b32 v68, 16, v69
    v_and_b32 v69, s3, v69
    v_cvt_pk_bf16_f32 v71, v70, v71
    v_lshlrev_b32 v70, 16, v71
    v_and_b32 v71, s3, v71
    v_pk_add_f32 v[48:49], v[48:49], v[68:69]
    v_pk_add_f32 v[50:51], v[50:51], v[70:71]
    v_cvt_pk_bf16_f32 v84, v48, v49
    v_cvt_pk_bf16_f32 v85, v50, v51
    buffer_store_dwordx2 v[84:85], v74, s[36:39], s70 offen offset:128
    s_endpgm
L_loaderB:
    s_mov_b32 s22, 6291456
    s_mov_b32 s23, 0x20000
    s_sub_u32 s69, s54, 16
    s_mul_i32 s68, s69, 205
    s_lshr_b32 s68, s68, 10
    s_lshr_b32 s66, s53, 1
    s_mul_i32 s58, s66, 3
    s_add_u32 s58, s58, s68
    s_mul_i32 s68, s68, 5
    s_sub_u32 s68, s69, s68
    s_and_b32 s67, s53, 1
    s_mul_i32 s57, s67, 5
    s_add_u32 s57, s57, s68
    s_cmp_lt_u32 s54, 31
    s_cselect_b32 s59, 1, 0
    s_add_u32 s66, s57, s58
    s_mul_i32 s67, s66, 205
    s_lshr_b32 s67, s67, 10
    s_mul_i32 s67, s67, 5
    s_sub_u32 s66, s66, s67
    s_and_b32 s67, s53, 1
    s_mul_i32 s67, s67, 5
    s_add_u32 s67, s67, s66
    s_mov_b32 s88, 0xa6453210
    s_mov_b32 s89, 0xefdcb987
    s_cmp_eq_u32 s67, 1
    s_cselect_b32 s88, 0x75643201, s88
    s_cselect_b32 s89, 0xfedca98b, s89
    s_cmp_eq_u32 s67, 2
    s_cselect_b32 s88, 0x67543102, s88
    s_cselect_b32 s89, 0xfedba9c8, s89
    s_cmp_eq_u32 s67, 3
    s_cselect_b32 s88, 0x86542103, s88
    s_cselect_b32 s89, 0xfecbad97, s89
    s_cmp_eq_u32 s67, 4
    s_cselect_b32 s88, 0x76532140, s88
    s_cselect_b32 s89, 0xfdcbea89, s89
    s_cmp_eq_u32 s67, 5
    s_cselect_b32 s88, 0x76432510, s88
    s_cselect_b32 s89, 0xedcfb9a8, s89
    s_cmp_eq_u32 s67, 6
    s_cselect_b32 s88, 0x75436201, s88
    s_cselect_b32 s89, 0xfedcab98, s89
    s_cmp_eq_u32 s67, 7
    s_cselect_b32 s88, 0x65473120, s88
    s_cselect_b32 s89, 0xfedbca98, s89
    s_cmp_eq_u32 s67, 8
    s_cselect_b32 s88, 0x65842310, s88
    s_cselect_b32 s89, 0xfecdba97, s89
    s_cmp_eq_u32 s67, 9
    s_cselect_b32 s88, 0x69534210, s88
    s_cselect_b32 s89, 0xfdecba87, s89
    v_lshrrev_b32 v40, 4, v0
    v_lshlrev_b32 v40, 1, v40
    v_and_b32 v41, 7, v0
    v_xor_b32 v40, v40, v41
    v_lshlrev_b32 v40, 4, v40
    v_lshrrev_b32 v41, 5, v0
    v_bfe_u32 v42, v0, 3, 2
    v_lshl_add_u32 v41, v41, 3, v42
    v_mul_u32_u24 v41, 3072, v41
    s_mul_i32 s66, s52, 98304
    s_lshl_b32 s67, s58, 8
    s_add_u32 s66, s66, s67
    v_add3_u32 v41, v41, v40, s66
    v_add_u32 v60, 0, v41
    v_add_u32 v61, 11264, v41
    v_add_u32 v62, 47104, v41
    v_add_u32 v63, 58368, v41
    v_add_u32 v64, 128, v41
    v_add_u32 v65, 11392, v41
    v_add_u32 v66, 47232, v41
    v_add_u32 v67, 58496, v41
    s_lshl_b32 s76, s52, 12
    s_setprio 1
    s_waitcnt vmcnt(0)
    s_barrier
    s_cmp_eq_u32 s59, 0
    s_cbranch_scc1 L_skip1
    s_add_u32 m0, s76, 0
    s_bfe_u32 s70, s88, 0x40000
    s_mul_i32 s70, s70, 393216
    buffer_load_dwordx4 v60, s[20:23], s70 offen lds
    buffer_load_dwordx4 v61, s[20:23], s70 offen offset:1024 lds
    buffer_load_dwordx4 v62, s[20:23], s70 offen offset:2048 lds
    buffer_load_dwordx4 v63, s[20:23], s70 offen offset:3072 lds
    s_add_u32 m0, s76, 16384
    s_nop 0
    buffer_load_dwordx4 v64, s[20:23], s70 offen lds
    buffer_load_dwordx4 v65, s[20:23], s70 offen offset:1024 lds
    buffer_load_dwordx4 v66, s[20:23], s70 offen offset:2048 lds
    buffer_load_dwordx4 v67, s[20:23], s70 offen offset:3072 lds
    s_add_u32 m0, s76, 49152
    s_bfe_u32 s70, s88, 0x40004
    s_mul_i32 s70, s70, 393216
    buffer_load_dwordx4 v60, s[20:23], s70 offen lds
    buffer_load_dwordx4 v61, s[20:23], s70 offen offset:1024 lds
    buffer_load_dwordx4 v62, s[20:23], s70 offen offset:2048 lds
    buffer_load_dwordx4 v63, s[20:23], s70 offen offset:3072 lds
    s_add_u32 m0, s76, 65536
    s_nop 0
    buffer_load_dwordx4 v64, s[20:23], s70 offen lds
    buffer_load_dwordx4 v65, s[20:23], s70 offen offset:1024 lds
    buffer_load_dwordx4 v66, s[20:23], s70 offen offset:2048 lds
    buffer_load_dwordx4 v67, s[20:23], s70 offen offset:3072 lds
L_skip1:
    s_setprio 1
    s_mov_b32 s26, 6291456
    s_mov_b32 s27, 0x20000
    s_lshr_b32 s66, s53, 1
    s_and_b32 s67, s53, 1
    s_lshr_b32 s68, s54, 2
    s_lshl3_add_u32 s60, s66, s68
    s_and_b32 s68, s54, 3
    s_lshl2_add_u32 s61, s67, s68
    s_lshr_b32 s66, s54, 2
    s_add_u32 s66, s66, s54
    s_and_b32 s66, s66, 3
    s_and_b32 s67, s53, 1
    s_mul_i32 s67, s67, 4
    s_add_u32 s67, s67, s66
    s_mov_b32 s92, 0x65834210
    s_mov_b32 s93, 0xba97
    s_cmp_eq_u32 s67, 1
    s_cselect_b32 s92, 0x69453201, s92
    s_cselect_b32 s93, 0xba87, s93
    s_cmp_eq_u32 s67, 2
    s_cselect_b32 s92, 0xa5643102, s92
    s_cselect_b32 s93, 0xb987, s93
    s_cmp_eq_u32 s67, 3
    s_cselect_b32 s92, 0x67542103, s92
    s_cselect_b32 s93, 0xa98b, s93
    s_cmp_eq_u32 s67, 4
    s_cselect_b32 s92, 0x86532140, s92
    s_cselect_b32 s93, 0xba97, s93
    s_cmp_eq_u32 s67, 5
    s_cselect_b32 s92, 0x76432501, s92
    s_cselect_b32 s93, 0xba89, s93
    s_cmp_eq_u32 s67, 6
    s_cselect_b32 s92, 0x75436120, s92
    s_cselect_b32 s93, 0xb9a8, s93
    s_cmp_eq_u32 s67, 7
    s_cselect_b32 s92, 0x65472310, s92
    s_cselect_b32 s93, 0xab98, s93
    s_mov_b32 s90, 0x34210
    s_cmp_eq_u32 s66, 1
    s_cselect_b32 s90, 0x43201, s90
    s_cmp_eq_u32 s66, 2
    s_cselect_b32 s90, 0x43120, s90
    s_cmp_eq_u32 s66, 3
    s_cselect_b32 s90, 0x42310, s90
    v_lshrrev_b32 v40, 4, v0
    v_lshlrev_b32 v40, 1, v40
    v_and_b32 v41, 7, v0
    v_xor_b32 v40, v40, v41
    v_lshlrev_b32 v40, 4, v40
    v_lshrrev_b32 v41, 3, v0
    v_lshlrev_b32 v41, 12, v41
    s_lshl_b32 s66, s52, 17
    s_lshl_b32 s67, s60, 7
    s_add_u32 s66, s66, s67
    v_add3_u32 v41, v41, v40, s66
    v_add_u32 v78, 0, v41
    v_add_u32 v79, 31744, v41
    v_add_u32 v80, 63488, v41
    v_add_u32 v81, 95232, v41
    v_lshlrev_b32 v40, 4, v0
    v_add_u32 v37, s76, v40
    s_mul_i32 s77, s52, 5120
    s_mul_i32 s66, s61, 245760
    s_add_u32 s66, s66, s77
    s_add_u32 s66, s66, 3145728
    v_add_u32 v32, s66, v40
    v_add_u32 v33, 4096, v32
    s_mul_i32 s66, s60, 81920
    s_add_u32 s66, s66, s76
    s_add_u32 s66, s66, 5242880
    v_add_u32 v36, s66, v40
    s_mul_i32 s66, s61, 102400
    s_add_u32 s66, s66, s77
    s_add_u32 s66, s66, 11534336
    v_add_u32 v34, s66, v40
    v_add_u32 v35, 4096, v34
    s_mul_i32 s66, s57, 278528
    s_add_u32 s66, s66, s76
    v_add_u32 v68, s66, v40
    s_barrier
    s_cmp_eq_u32 s59, 0
    s_cbranch_scc1 L_skip2
    s_add_u32 m0, s76, 32768
    s_bfe_u32 s70, s88, 0x40000
    s_mul_i32 s70, s70, 16384
    buffer_load_dwordx4 v68, s[28:31], s70 offen sc1 lds
    buffer_load_dwordx4 v68, s[28:31], s70 offen offset:1024 sc1 lds
    buffer_load_dwordx4 v68, s[28:31], s70 offen offset:2048 sc1 lds
    buffer_load_dwordx4 v68, s[28:31], s70 offen offset:3072 sc1 lds
    s_add_u32 m0, s76, 81920
    s_bfe_u32 s70, s88, 0x40004
    s_mul_i32 s70, s70, 16384
    buffer_load_dwordx4 v68, s[28:31], s70 offen sc1 lds
    buffer_load_dwordx4 v68, s[28:31], s70 offen offset:1024 sc1 lds
    buffer_load_dwordx4 v68, s[28:31], s70 offen offset:2048 sc1 lds
    buffer_load_dwordx4 v68, s[28:31], s70 offen offset:3072 sc1 lds
L_skip2:
    s_mov_b32 s67, 7864320
    s_mov_b32 exec_lo, 1
    s_mov_b32 exec_hi, 1
    buffer_store_dword v139, v126, s[28:31], s67 offen sc1
    s_mov_b64 exec, -1
    s_waitcnt vmcnt(63)
    buffer_store_dwordx4 v[200:203], v187, s[28:31], s73 offen sc1
    s_waitcnt vmcnt(6)
    s_barrier
    s_cmp_eq_u32 s59, 0
    s_cbranch_scc1 L_skip3
    s_add_u32 m0, s76, 98304
    s_bfe_u32 s70, s88, 0x40008
    s_mul_i32 s70, s70, 393216
    buffer_load_dwordx4 v60, s[20:23], s70 offen lds
    buffer_load_dwordx4 v61, s[20:23], s70 offen offset:1024 lds
    buffer_load_dwordx4 v62, s[20:23], s70 offen offset:2048 lds
    buffer_load_dwordx4 v63, s[20:23], s70 offen offset:3072 lds
    s_add_u32 m0, s76, 114688
    s_nop 0
    buffer_load_dwordx4 v64, s[20:23], s70 offen lds
    buffer_load_dwordx4 v65, s[20:23], s70 offen offset:1024 lds
    buffer_load_dwordx4 v66, s[20:23], s70 offen offset:2048 lds
    buffer_load_dwordx4 v67, s[20:23], s70 offen offset:3072 lds
    s_add_u32 m0, s76, 131072
    s_bfe_u32 s70, s88, 0x40008
    s_mul_i32 s70, s70, 16384
    buffer_load_dwordx4 v68, s[28:31], s70 offen sc1 lds
    buffer_load_dwordx4 v68, s[28:31], s70 offen offset:1024 sc1 lds
    buffer_load_dwordx4 v68, s[28:31], s70 offen offset:2048 sc1 lds
    buffer_load_dwordx4 v68, s[28:31], s70 offen offset:3072 sc1 lds
L_skip3:
    s_waitcnt vmcnt(14)
    s_barrier
    s_cmp_eq_u32 s59, 0
    s_cbranch_scc1 L_skip4
    s_add_u32 m0, s76, 0
    s_bfe_u32 s70, s88, 0x4000c
    s_mul_i32 s70, s70, 393216
    buffer_load_dwordx4 v60, s[20:23], s70 offen lds
    buffer_load_dwordx4 v61, s[20:23], s70 offen offset:1024 lds
    buffer_load_dwordx4 v62, s[20:23], s70 offen offset:2048 lds
    buffer_load_dwordx4 v63, s[20:23], s70 offen offset:3072 lds
    s_add_u32 m0, s76, 16384
    s_nop 0
    buffer_load_dwordx4 v64, s[20:23], s70 offen lds
    buffer_load_dwordx4 v65, s[20:23], s70 offen offset:1024 lds
    buffer_load_dwordx4 v66, s[20:23], s70 offen offset:2048 lds
    buffer_load_dwordx4 v67, s[20:23], s70 offen offset:3072 lds
    s_add_u32 m0, s76, 32768
    s_bfe_u32 s70, s88, 0x4000c
    s_mul_i32 s70, s70, 16384
    buffer_load_dwordx4 v68, s[28:31], s70 offen sc1 lds
    buffer_load_dwordx4 v68, s[28:31], s70 offen offset:1024 sc1 lds
    buffer_load_dwordx4 v68, s[28:31], s70 offen offset:2048 sc1 lds
    buffer_load_dwordx4 v68, s[28:31], s70 offen offset:3072 sc1 lds
L_skip4:
    s_waitcnt vmcnt(12)
    s_barrier
    s_cmp_eq_u32 s59, 0
    s_cbranch_scc1 L_skip5
    s_add_u32 m0, s76, 49152
    s_bfe_u32 s70, s88, 0x40010
    s_mul_i32 s70, s70, 393216
    buffer_load_dwordx4 v60, s[20:23], s70 offen lds
    buffer_load_dwordx4 v61, s[20:23], s70 offen offset:1024 lds
    buffer_load_dwordx4 v62, s[20:23], s70 offen offset:2048 lds
    buffer_load_dwordx4 v63, s[20:23], s70 offen offset:3072 lds
    s_add_u32 m0, s76, 65536
    s_nop 0
    buffer_load_dwordx4 v64, s[20:23], s70 offen lds
    buffer_load_dwordx4 v65, s[20:23], s70 offen offset:1024 lds
    buffer_load_dwordx4 v66, s[20:23], s70 offen offset:2048 lds
    buffer_load_dwordx4 v67, s[20:23], s70 offen offset:3072 lds
    s_add_u32 m0, s76, 81920
    s_bfe_u32 s70, s88, 0x40010
    s_mul_i32 s70, s70, 16384
    buffer_load_dwordx4 v68, s[28:31], s70 offen sc1 lds
    buffer_load_dwordx4 v68, s[28:31], s70 offen offset:1024 sc1 lds
    buffer_load_dwordx4 v68, s[28:31], s70 offen offset:2048 sc1 lds
    buffer_load_dwordx4 v68, s[28:31], s70 offen offset:3072 sc1 lds
L_skip5:
    s_waitcnt vmcnt(12)
    s_cmp_eq_u32 s59, 1
    s_cbranch_scc1 L_side
    s_waitcnt vmcnt(0)
L_side:
    s_barrier
    s_cmp_eq_u32 s59, 0
    s_cbranch_scc1 L_skip6
    s_add_u32 m0, s76, 98304
    s_bfe_u32 s70, s88, 0x40014
    s_mul_i32 s70, s70, 393216
    buffer_load_dwordx4 v60, s[20:23], s70 offen lds
    buffer_load_dwordx4 v61, s[20:23], s70 offen offset:1024 lds
    buffer_load_dwordx4 v62, s[20:23], s70 offen offset:2048 lds
    buffer_load_dwordx4 v63, s[20:23], s70 offen offset:3072 lds
    s_add_u32 m0, s76, 114688
    s_nop 0
    buffer_load_dwordx4 v64, s[20:23], s70 offen lds
    buffer_load_dwordx4 v65, s[20:23], s70 offen offset:1024 lds
    buffer_load_dwordx4 v66, s[20:23], s70 offen offset:2048 lds
    buffer_load_dwordx4 v67, s[20:23], s70 offen offset:3072 lds
    s_add_u32 m0, s76, 131072
    s_bfe_u32 s70, s88, 0x40014
    s_mul_i32 s70, s70, 16384
    buffer_load_dwordx4 v68, s[28:31], s70 offen sc1 lds
    buffer_load_dwordx4 v68, s[28:31], s70 offen offset:1024 sc1 lds
    buffer_load_dwordx4 v68, s[28:31], s70 offen offset:2048 sc1 lds
    buffer_load_dwordx4 v68, s[28:31], s70 offen offset:3072 sc1 lds
L_skip6:
    s_waitcnt vmcnt(12)
    s_barrier
    s_cmp_eq_u32 s59, 0
    s_cbranch_scc1 L_skip7
    s_add_u32 m0, s76, 0
    s_bfe_u32 s70, s88, 0x40018
    s_mul_i32 s70, s70, 393216
    buffer_load_dwordx4 v60, s[20:23], s70 offen lds
    buffer_load_dwordx4 v61, s[20:23], s70 offen offset:1024 lds
    buffer_load_dwordx4 v62, s[20:23], s70 offen offset:2048 lds
    buffer_load_dwordx4 v63, s[20:23], s70 offen offset:3072 lds
    s_add_u32 m0, s76, 16384
    s_nop 0
    buffer_load_dwordx4 v64, s[20:23], s70 offen lds
    buffer_load_dwordx4 v65, s[20:23], s70 offen offset:1024 lds
    buffer_load_dwordx4 v66, s[20:23], s70 offen offset:2048 lds
    buffer_load_dwordx4 v67, s[20:23], s70 offen offset:3072 lds
    s_add_u32 m0, s76, 32768
    s_bfe_u32 s70, s88, 0x40018
    s_mul_i32 s70, s70, 16384
    buffer_load_dwordx4 v68, s[28:31], s70 offen sc1 lds
    buffer_load_dwordx4 v68, s[28:31], s70 offen offset:1024 sc1 lds
    buffer_load_dwordx4 v68, s[28:31], s70 offen offset:2048 sc1 lds
    buffer_load_dwordx4 v68, s[28:31], s70 offen offset:3072 sc1 lds
L_skip7:
    s_waitcnt vmcnt(12)
    s_barrier
    s_cmp_eq_u32 s59, 0
    s_cbranch_scc1 L_skip8
    s_add_u32 m0, s76, 49152
    s_bfe_u32 s70, s88, 0x4001c
    s_mul_i32 s70, s70, 393216
    buffer_load_dwordx4 v60, s[20:23], s70 offen lds
    buffer_load_dwordx4 v61, s[20:23], s70 offen offset:1024 lds
    buffer_load_dwordx4 v62, s[20:23], s70 offen offset:2048 lds
    buffer_load_dwordx4 v63, s[20:23], s70 offen offset:3072 lds
    s_add_u32 m0, s76, 65536
    s_nop 0
    buffer_load_dwordx4 v64, s[20:23], s70 offen lds
    buffer_load_dwordx4 v65, s[20:23], s70 offen offset:1024 lds
    buffer_load_dwordx4 v66, s[20:23], s70 offen offset:2048 lds
    buffer_load_dwordx4 v67, s[20:23], s70 offen offset:3072 lds
    s_add_u32 m0, s76, 81920
    s_bfe_u32 s70, s88, 0x4001c
    s_mul_i32 s70, s70, 16384
    buffer_load_dwordx4 v68, s[28:31], s70 offen sc1 lds
    buffer_load_dwordx4 v68, s[28:31], s70 offen offset:1024 sc1 lds
    buffer_load_dwordx4 v68, s[28:31], s70 offen offset:2048 sc1 lds
    buffer_load_dwordx4 v68, s[28:31], s70 offen offset:3072 sc1 lds
L_skip8:
    s_waitcnt vmcnt(12)
    s_barrier
    s_cmp_eq_u32 s59, 0
    s_cbranch_scc1 L_skip9
    s_add_u32 m0, s76, 98304
    s_bfe_u32 s70, s89, 0x40000
    s_mul_i32 s70, s70, 393216
    buffer_load_dwordx4 v60, s[20:23], s70 offen lds
    buffer_load_dwordx4 v61, s[20:23], s70 offen offset:1024 lds
    buffer_load_dwordx4 v62, s[20:23], s70 offen offset:2048 lds
    buffer_load_dwordx4 v63, s[20:23], s70 offen offset:3072 lds
    s_add_u32 m0, s76, 114688
    s_nop 0
    buffer_load_dwordx4 v64, s[20:23], s70 offen lds
    buffer_load_dwordx4 v65, s[20:23], s70 offen offset:1024 lds
    buffer_load_dwordx4 v66, s[20:23], s70 offen offset:2048 lds
    buffer_load_dwordx4 v67, s[20:23], s70 offen offset:3072 lds
    s_add_u32 m0, s76, 131072
    s_bfe_u32 s70, s89, 0x40000
    s_mul_i32 s70, s70, 16384
    buffer_load_dwordx4 v68, s[28:31], s70 offen sc1 lds
    buffer_load_dwordx4 v68, s[28:31], s70 offen offset:1024 sc1 lds
    buffer_load_dwordx4 v68, s[28:31], s70 offen offset:2048 sc1 lds
    buffer_load_dwordx4 v68, s[28:31], s70 offen offset:3072 sc1 lds
L_skip9:
    s_waitcnt vmcnt(12)
    s_barrier
    s_cmp_eq_u32 s59, 0
    s_cbranch_scc1 L_skip10
    s_add_u32 m0, s76, 0
    s_bfe_u32 s70, s89, 0x40004
    s_mul_i32 s70, s70, 393216
    buffer_load_dwordx4 v60, s[20:23], s70 offen lds
    buffer_load_dwordx4 v61, s[20:23], s70 offen offset:1024 lds
    buffer_load_dwordx4 v62, s[20:23], s70 offen offset:2048 lds
    buffer_load_dwordx4 v63, s[20:23], s70 offen offset:3072 lds
    s_add_u32 m0, s76, 16384
    s_nop 0
    buffer_load_dwordx4 v64, s[20:23], s70 offen lds
    buffer_load_dwordx4 v65, s[20:23], s70 offen offset:1024 lds
    buffer_load_dwordx4 v66, s[20:23], s70 offen offset:2048 lds
    buffer_load_dwordx4 v67, s[20:23], s70 offen offset:3072 lds
    s_add_u32 m0, s76, 32768
    s_bfe_u32 s70, s89, 0x40004
    s_mul_i32 s70, s70, 16384
    buffer_load_dwordx4 v68, s[28:31], s70 offen sc1 lds
    buffer_load_dwordx4 v68, s[28:31], s70 offen offset:1024 sc1 lds
    buffer_load_dwordx4 v68, s[28:31], s70 offen offset:2048 sc1 lds
    buffer_load_dwordx4 v68, s[28:31], s70 offen offset:3072 sc1 lds
L_skip10:
    s_waitcnt vmcnt(12)
    s_barrier
    s_cmp_eq_u32 s59, 0
    s_cbranch_scc1 L_skip11
    s_add_u32 m0, s76, 49152
    s_bfe_u32 s70, s89, 0x40008
    s_mul_i32 s70, s70, 393216
    buffer_load_dwordx4 v60, s[20:23], s70 offen lds
    buffer_load_dwordx4 v61, s[20:23], s70 offen offset:1024 lds
    buffer_load_dwordx4 v62, s[20:23], s70 offen offset:2048 lds
    buffer_load_dwordx4 v63, s[20:23], s70 offen offset:3072 lds
    s_add_u32 m0, s76, 65536
    s_nop 0
    buffer_load_dwordx4 v64, s[20:23], s70 offen lds
    buffer_load_dwordx4 v65, s[20:23], s70 offen offset:1024 lds
    buffer_load_dwordx4 v66, s[20:23], s70 offen offset:2048 lds
    buffer_load_dwordx4 v67, s[20:23], s70 offen offset:3072 lds
    s_add_u32 m0, s76, 81920
    s_bfe_u32 s70, s89, 0x40008
    s_mul_i32 s70, s70, 16384
    buffer_load_dwordx4 v68, s[28:31], s70 offen sc1 lds
    buffer_load_dwordx4 v68, s[28:31], s70 offen offset:1024 sc1 lds
    buffer_load_dwordx4 v68, s[28:31], s70 offen offset:2048 sc1 lds
    buffer_load_dwordx4 v68, s[28:31], s70 offen offset:3072 sc1 lds
L_skip11:
    s_waitcnt vmcnt(12)
    s_barrier
    s_cmp_eq_u32 s59, 0
    s_cbranch_scc1 L_skip12
    s_add_u32 m0, s76, 98304
    s_bfe_u32 s70, s89, 0x4000c
    s_mul_i32 s70, s70, 393216
    buffer_load_dwordx4 v60, s[20:23], s70 offen lds
    buffer_load_dwordx4 v61, s[20:23], s70 offen offset:1024 lds
    buffer_load_dwordx4 v62, s[20:23], s70 offen offset:2048 lds
    buffer_load_dwordx4 v63, s[20:23], s70 offen offset:3072 lds
    s_add_u32 m0, s76, 114688
    s_nop 0
    buffer_load_dwordx4 v64, s[20:23], s70 offen lds
    buffer_load_dwordx4 v65, s[20:23], s70 offen offset:1024 lds
    buffer_load_dwordx4 v66, s[20:23], s70 offen offset:2048 lds
    buffer_load_dwordx4 v67, s[20:23], s70 offen offset:3072 lds
    s_add_u32 m0, s76, 131072
    s_bfe_u32 s70, s89, 0x4000c
    s_mul_i32 s70, s70, 16384
    buffer_load_dwordx4 v68, s[28:31], s70 offen sc1 lds
    buffer_load_dwordx4 v68, s[28:31], s70 offen offset:1024 sc1 lds
    buffer_load_dwordx4 v68, s[28:31], s70 offen offset:2048 sc1 lds
    buffer_load_dwordx4 v68, s[28:31], s70 offen offset:3072 sc1 lds
L_skip12:
    s_waitcnt vmcnt(12)
    s_barrier
    s_cmp_eq_u32 s59, 0
    s_cbranch_scc1 L_skip13
    s_add_u32 m0, s76, 0
    s_bfe_u32 s70, s89, 0x40010
    s_mul_i32 s70, s70, 393216
    buffer_load_dwordx4 v60, s[20:23], s70 offen lds
    buffer_load_dwordx4 v61, s[20:23], s70 offen offset:1024 lds
    buffer_load_dwordx4 v62, s[20:23], s70 offen offset:2048 lds
    buffer_load_dwordx4 v63, s[20:23], s70 offen offset:3072 lds
    s_add_u32 m0, s76, 16384
    s_nop 0
    buffer_load_dwordx4 v64, s[20:23], s70 offen lds
    buffer_load_dwordx4 v65, s[20:23], s70 offen offset:1024 lds
    buffer_load_dwordx4 v66, s[20:23], s70 offen offset:2048 lds
    buffer_load_dwordx4 v67, s[20:23], s70 offen offset:3072 lds
    s_add_u32 m0, s76, 32768
    s_bfe_u32 s70, s89, 0x40010
    s_mul_i32 s70, s70, 16384
    buffer_load_dwordx4 v68, s[28:31], s70 offen sc1 lds
    buffer_load_dwordx4 v68, s[28:31], s70 offen offset:1024 sc1 lds
    buffer_load_dwordx4 v68, s[28:31], s70 offen offset:2048 sc1 lds
    buffer_load_dwordx4 v68, s[28:31], s70 offen offset:3072 sc1 lds
L_skip13:
    s_waitcnt vmcnt(12)
    s_barrier
    s_mov_b32 s66, 8093696
    v_lshl_add_u32 v48, v0, 7, s66
    s_movk_i32 s75, 8192
    s_cmp_eq_u32 s52, 0
    s_cselect_b32 s66, 0, 12582912
    v_add_u32 v48, s66, v48
    buffer_load_dword v50, v48, s[28:31], 0 offen sc1
    buffer_load_dword v51, v48, s[28:31], s75 offen sc1
    s_cmp_eq_u32 s59, 0
    s_cbranch_scc1 L_skip14
    s_add_u32 m0, s76, 49152
    s_bfe_u32 s70, s89, 0x40014
    s_mul_i32 s70, s70, 393216
    buffer_load_dwordx4 v60, s[20:23], s70 offen lds
    buffer_load_dwordx4 v61, s[20:23], s70 offen offset:1024 lds
    buffer_load_dwordx4 v62, s[20:23], s70 offen offset:2048 lds
    buffer_load_dwordx4 v63, s[20:23], s70 offen offset:3072 lds
    s_add_u32 m0, s76, 65536
    s_nop 0
    buffer_load_dwordx4 v64, s[20:23], s70 offen lds
    buffer_load_dwordx4 v65, s[20:23], s70 offen offset:1024 lds
    buffer_load_dwordx4 v66, s[20:23], s70 offen offset:2048 lds
    buffer_load_dwordx4 v67, s[20:23], s70 offen offset:3072 lds
    s_add_u32 m0, s76, 81920
    s_bfe_u32 s70, s89, 0x40014
    s_mul_i32 s70, s70, 16384
    buffer_load_dwordx4 v68, s[28:31], s70 offen sc1 lds
    buffer_load_dwordx4 v68, s[28:31], s70 offen offset:1024 sc1 lds
    buffer_load_dwordx4 v68, s[28:31], s70 offen offset:2048 sc1 lds
    buffer_load_dwordx4 v68, s[28:31], s70 offen offset:3072 sc1 lds
L_skip14:
    s_waitcnt vmcnt(14)
    s_cmp_eq_u32 s59, 1
    s_cbranch_scc1 L_counted
    s_waitcnt vmcnt(0)
L_counted:
    s_waitcnt vmcnt(12)
    s_mov_b32 s67, 0x40000
    s_cmp_lg_u32 s52, 0
    s_cbranch_scc1 L_poll_Bh_ok
L_poll_Bh:
    v_xor_b32 v50, v50, v29
    v_xor_b32 v51, v51, v29
    v_or_b32 v50, v50, v51
    v_cmp_eq_u32 vcc, 0, v50
    s_nop 1
    s_cmp_lg_u64 vcc, -1
    s_cbranch_scc1 L_poll_Bh_again
L_poll_Bh_ok:
    s_barrier
    s_cmp_eq_u32 s59, 0
    s_cbranch_scc1 L_skip15
    s_add_u32 m0, s76, 98304
    s_bfe_u32 s70, s89, 0x40018
    s_mul_i32 s70, s70, 393216
    buffer_load_dwordx4 v60, s[20:23], s70 offen lds
    buffer_load_dwordx4 v61, s[20:23], s70 offen offset:1024 lds
    buffer_load_dwordx4 v62, s[20:23], s70 offen offset:2048 lds
    buffer_load_dwordx4 v63, s[20:23], s70 offen offset:3072 lds
    s_add_u32 m0, s76, 114688
    s_nop 0
    buffer_load_dwordx4 v64, s[20:23], s70 offen lds
    buffer_load_dwordx4 v65, s[20:23], s70 offen offset:1024 lds
    buffer_load_dwordx4 v66, s[20:23], s70 offen offset:2048 lds
    buffer_load_dwordx4 v67, s[20:23], s70 offen offset:3072 lds
    s_add_u32 m0, s76, 131072
    s_bfe_u32 s70, s89, 0x40018
    s_mul_i32 s70, s70, 16384
    buffer_load_dwordx4 v68, s[28:31], s70 offen sc1 lds
    buffer_load_dwordx4 v68, s[28:31], s70 offen offset:1024 sc1 lds
    buffer_load_dwordx4 v68, s[28:31], s70 offen offset:2048 sc1 lds
    buffer_load_dwordx4 v68, s[28:31], s70 offen offset:3072 sc1 lds
L_skip15:
    s_waitcnt vmcnt(12)
    s_barrier
    s_cmp_eq_u32 s59, 0
    s_cbranch_scc1 L_skip16
    s_add_u32 m0, s76, 0
    s_bfe_u32 s70, s89, 0x4001c
    s_mul_i32 s70, s70, 393216
    buffer_load_dwordx4 v60, s[20:23], s70 offen lds
    buffer_load_dwordx4 v61, s[20:23], s70 offen offset:1024 lds
    buffer_load_dwordx4 v62, s[20:23], s70 offen offset:2048 lds
    buffer_load_dwordx4 v63, s[20:23], s70 offen offset:3072 lds
    s_add_u32 m0, s76, 16384
    s_nop 0
    buffer_load_dwordx4 v64, s[20:23], s70 offen lds
    buffer_load_dwordx4 v65, s[20:23], s70 offen offset:1024 lds
    buffer_load_dwordx4 v66, s[20:23], s70 offen offset:2048 lds
    buffer_load_dwordx4 v67, s[20:23], s70 offen offset:3072 lds
    s_add_u32 m0, s76, 32768
    s_bfe_u32 s70, s89, 0x4001c
    s_mul_i32 s70, s70, 16384
    buffer_load_dwordx4 v68, s[28:31], s70 offen sc1 lds
    buffer_load_dwordx4 v68, s[28:31], s70 offen offset:1024 sc1 lds
    buffer_load_dwordx4 v68, s[28:31], s70 offen offset:2048 sc1 lds
    buffer_load_dwordx4 v68, s[28:31], s70 offen offset:3072 sc1 lds
L_skip16:
    s_waitcnt vmcnt(12)
    s_barrier
    s_add_u32 m0, s77, 49152
    s_bfe_u32 s70, s90, 0x40000
    s_mul_i32 s70, s70, 20480
    buffer_load_dwordx4 v34, s[28:31], s70 offen sc1 lds
    buffer_load_dwordx4 v34, s[28:31], s70 offen offset:1024 sc1 lds
    buffer_load_dwordx4 v34, s[28:31], s70 offen offset:2048 sc1 lds
    buffer_load_dwordx4 v34, s[28:31], s70 offen offset:3072 sc1 lds
    s_add_u32 m0, m0, 4096
    s_nop 0
    buffer_load_dwordx4 v35, s[28:31], s70 offen sc1 lds
    s_waitcnt vmcnt(5)
    s_barrier
    s_add_u32 m0, s77, 69632
    s_bfe_u32 s70, s90, 0x40004
    s_mul_i32 s70, s70, 20480
    buffer_load_dwordx4 v34, s[28:31], s70 offen sc1 lds
    buffer_load_dwordx4 v34, s[28:31], s70 offen offset:1024 sc1 lds
    buffer_load_dwordx4 v34, s[28:31], s70 offen offset:2048 sc1 lds
    buffer_load_dwordx4 v34, s[28:31], s70 offen offset:3072 sc1 lds
    s_add_u32 m0, m0, 4096
    s_nop 0
    buffer_load_dwordx4 v35, s[28:31], s70 offen sc1 lds
    s_add_u32 m0, s76, 90112
    s_bfe_u32 s70, s92, 0x40000
    s_mul_i32 s70, s70, 524288
    buffer_load_dwordx4 v78, s[24:27], s70 offen lds
    buffer_load_dwordx4 v79, s[24:27], s70 offen offset:1024 lds
    buffer_load_dwordx4 v80, s[24:27], s70 offen offset:2048 lds
    buffer_load_dwordx4 v81, s[24:27], s70 offen offset:3072 lds
    s_add_u32 m0, s76, 106496
    s_bfe_u32 s70, s92, 0x40004
    s_mul_i32 s70, s70, 524288
    buffer_load_dwordx4 v78, s[24:27], s70 offen lds
    buffer_load_dwordx4 v79, s[24:27], s70 offen offset:1024 lds
    buffer_load_dwordx4 v80, s[24:27], s70 offen offset:2048 lds
    buffer_load_dwordx4 v81, s[24:27], s70 offen offset:3072 lds
    s_lshr_b32 s66, s60, 2
    s_lshl_b32 s66, s66, 11
    s_add_u32 s66, s66, 7929856
    v_and_b32 v48, 15, v0
    v_lshl_add_u32 v48, v48, 7, s66
    buffer_load_dword v50, v48, s[28:31], 0 offen sc1
    s_waitcnt vmcnt(0)
    s_mov_b32 s67, 0x40000
L_poll_Bo:
    v_xor_b32 v50, v50, v29
    v_cmp_eq_u32 vcc, 0, v50
    s_nop 1
    s_cmp_lg_u64 vcc, -1
    s_cbranch_scc1 L_poll_Bo_again
L_poll_Bo_ok:
    s_add_u32 m0, s76, 122880
    s_bfe_u32 s70, s90, 0x40000
    s_mul_i32 s70, s70, 16384
    buffer_load_dwordx4 v36, s[28:31], s70 offen sc1 lds
    buffer_load_dwordx4 v36, s[28:31], s70 offen offset:1024 sc1 lds
    buffer_load_dwordx4 v36, s[28:31], s70 offen offset:2048 sc1 lds
    buffer_load_dwordx4 v36, s[28:31], s70 offen offset:3072 sc1 lds
    s_add_u32 m0, s76, 139264
    s_bfe_u32 s70, s90, 0x40004
    s_mul_i32 s70, s70, 16384
    buffer_load_dwordx4 v36, s[28:31], s70 offen sc1 lds
    buffer_load_dwordx4 v36, s[28:31], s70 offen offset:1024 sc1 lds
    buffer_load_dwordx4 v36, s[28:31], s70 offen offset:2048 sc1 lds
    buffer_load_dwordx4 v36, s[28:31], s70 offen offset:3072 sc1 lds
    s_waitcnt vmcnt(4)
    s_barrier
    s_add_u32 m0, s77, 0
    s_bfe_u32 s70, s90, 0x40008
    s_mul_i32 s70, s70, 20480
    buffer_load_dwordx4 v34, s[28:31], s70 offen sc1 lds
    buffer_load_dwordx4 v34, s[28:31], s70 offen offset:1024 sc1 lds
    buffer_load_dwordx4 v34, s[28:31], s70 offen offset:2048 sc1 lds
    buffer_load_dwordx4 v34, s[28:31], s70 offen offset:3072 sc1 lds
    s_add_u32 m0, m0, 4096
    s_nop 0
    buffer_load_dwordx4 v35, s[28:31], s70 offen sc1 lds
    s_add_u32 m0, s76, 20480
    s_bfe_u32 s70, s90, 0x40008
    s_mul_i32 s70, s70, 16384
    buffer_load_dwordx4 v36, s[28:31], s70 offen sc1 lds
    buffer_load_dwordx4 v36, s[28:31], s70 offen offset:1024 sc1 lds
    buffer_load_dwordx4 v36, s[28:31], s70 offen offset:2048 sc1 lds
    buffer_load_dwordx4 v36, s[28:31], s70 offen offset:3072 sc1 lds
    s_waitcnt vmcnt(9)
    s_barrier
    s_add_u32 m0, s77, 49152
    s_bfe_u32 s70, s90, 0x4000c
    s_mul_i32 s70, s70, 20480
    buffer_load_dwordx4 v34, s[28:31], s70 offen sc1 lds
    buffer_load_dwordx4 v34, s[28:31], s70 offen offset:1024 sc1 lds
    buffer_load_dwordx4 v34, s[28:31], s70 offen offset:2048 sc1 lds
    buffer_load_dwordx4 v34, s[28:31], s70 offen offset:3072 sc1 lds
    s_add_u32 m0, m0, 4096
    s_nop 0
    buffer_load_dwordx4 v35, s[28:31], s70 offen sc1 lds
    s_add_u32 m0, s76, 122880
    s_bfe_u32 s70, s90, 0x4000c
    s_mul_i32 s70, s70, 16384
    buffer_load_dwordx4 v36, s[28:31], s70 offen sc1 lds
    buffer_load_dwordx4 v36, s[28:31], s70 offen offset:1024 sc1 lds
    buffer_load_dwordx4 v36, s[28:31], s70 offen offset:2048 sc1 lds
    buffer_load_dwordx4 v36, s[28:31], s70 offen offset:3072 sc1 lds
    s_waitcnt vmcnt(9)
    s_barrier
    s_add_u32 m0, s77, 69632
    s_bfe_u32 s70, s90, 0x40010
    s_mul_i32 s70, s70, 20480
    buffer_load_dwordx4 v34, s[28:31], s70 offen sc1 lds
    buffer_load_dwordx4 v34, s[28:31], s70 offen offset:1024 sc1 lds
    buffer_load_dwordx4 v34, s[28:31], s70 offen offset:2048 sc1 lds
    buffer_load_dwordx4 v34, s[28:31], s70 offen offset:3072 sc1 lds
    s_add_u32 m0, m0, 4096
    s_nop 0
    buffer_load_dwordx4 v35, s[28:31], s70 offen sc1 lds
    s_add_u32 m0, s76, 147328
    s_bfe_u32 s70, s90, 0x40010
    s_mul_i32 s70, s70, 16384
    buffer_load_dwordx4 v36, s[28:31], s70 offen sc1 lds
    buffer_load_dwordx4 v36, s[28:31], s70 offen offset:1024 sc1 lds
    buffer_load_dwordx4 v36, s[28:31], s70 offen offset:2048 sc1 lds
    buffer_load_dwordx4 v36, s[28:31], s70 offen offset:3072 sc1 lds
    s_waitcnt vmcnt(9)
    s_barrier
    s_add_u32 m0, s76, 0
    s_bfe_u32 s70, s92, 0x40008
    s_mul_i32 s70, s70, 524288
    buffer_load_dwordx4 v78, s[24:27], s70 offen lds
    buffer_load_dwordx4 v79, s[24:27], s70 offen offset:1024 lds
    buffer_load_dwordx4 v80, s[24:27], s70 offen offset:2048 lds
    buffer_load_dwordx4 v81, s[24:27], s70 offen offset:3072 lds
    s_add_u32 m0, s76, 16384
    s_bfe_u32 s70, s92, 0x4000c
    s_mul_i32 s70, s70, 524288
    buffer_load_dwordx4 v78, s[24:27], s70 offen lds
    buffer_load_dwordx4 v79, s[24:27], s70 offen offset:1024 lds
    buffer_load_dwordx4 v80, s[24:27], s70 offen offset:2048 lds
    buffer_load_dwordx4 v81, s[24:27], s70 offen offset:3072 lds
    s_add_u32 m0, s76, 32768
    s_bfe_u32 s70, s92, 0x40010
    s_mul_i32 s70, s70, 524288
    buffer_load_dwordx4 v78, s[24:27], s70 offen lds
    buffer_load_dwordx4 v79, s[24:27], s70 offen offset:1024 lds
    buffer_load_dwordx4 v80, s[24:27], s70 offen offset:2048 lds
    buffer_load_dwordx4 v81, s[24:27], s70 offen offset:3072 lds
    s_waitcnt vmcnt(12)
    s_barrier
    s_mul_i32 s66, s61, 80
    s_lshr_b32 s66, s66, 6
    s_mul_i32 s66, s66, 1536
    s_add_u32 s66, s66, 7995392
    v_min_u32 v48, 23, v0
    v_lshl_add_u32 v48, v48, 7, s66
    buffer_load_dword v50, v48, s[28:31], 0 offen sc1
    s_waitcnt vmcnt(0)
    v_cmp_eq_u32 vcc, v50, v29
    s_mov_b32 s73, 0x40000
    s_nop 0
    s_mov_b32 s72, vcc_lo
    s_bfe_u32 s68, s92, 0x40000
L_UB0:
    s_lshr_b32 s66, s72, s68
    s_and_b32 s66, s66, 4097
    s_cmp_lg_u32 s66, 4097
    s_cbranch_scc1 L_UB0_again
L_UB0_ok:
    s_add_u32 m0, s77, 49152
    s_bfe_u32 s70, s92, 0x40000
    s_mul_i32 s70, s70, 20480
    buffer_load_dwordx4 v32, s[28:31], s70 offen sc1 lds
    buffer_load_dwordx4 v32, s[28:31], s70 offen offset:1024 sc1 lds
    buffer_load_dwordx4 v32, s[28:31], s70 offen offset:2048 sc1 lds
    buffer_load_dwordx4 v32, s[28:31], s70 offen offset:3072 sc1 lds
    s_add_u32 m0, m0, 4096
    s_nop 0
    buffer_load_dwordx4 v33, s[28:31], s70 offen sc1 lds
    s_bfe_u32 s68, s92, 0x40004
L_UB1:
    s_lshr_b32 s66, s72, s68
    s_and_b32 s66, s66, 4097
    s_cmp_lg_u32 s66, 4097
    s_cbranch_scc1 L_UB1_again
L_UB1_ok:
    s_add_u32 m0, s77, 122880
    s_bfe_u32 s70, s92, 0x40004
    s_mul_i32 s70, s70, 20480
    buffer_load_dwordx4 v32, s[28:31], s70 offen sc1 lds
    buffer_load_dwordx4 v32, s[28:31], s70 offen offset:1024 sc1 lds
    buffer_load_dwordx4 v32, s[28:31], s70 offen offset:2048 sc1 lds
    buffer_load_dwordx4 v32, s[28:31], s70 offen offset:3072 sc1 lds
    s_add_u32 m0, m0, 4096
    s_nop 0
    buffer_load_dwordx4 v33, s[28:31], s70 offen sc1 lds
    s_waitcnt vmcnt(5)
    s_barrier
    s_bfe_u32 s68, s92, 0x40008
L_UB2:
    s_lshr_b32 s66, s72, s68
    s_and_b32 s66, s66, 4097
    s_cmp_lg_u32 s66, 4097
    s_cbranch_scc1 L_UB2_again
L_UB2_ok:
    s_add_u32 m0, s77, 69632
    s_bfe_u32 s70, s92, 0x40008
    s_mul_i32 s70, s70, 20480
    buffer_load_dwordx4 v32, s[28:31], s70 offen sc1 lds
    buffer_load_dwordx4 v32, s[28:31], s70 offen offset:1024 sc1 lds
    buffer_load_dwordx4 v32, s[28:31], s70 offen offset:2048 sc1 lds
    buffer_load_dwordx4 v32, s[28:31], s70 offen offset:3072 sc1 lds
    s_add_u32 m0, m0, 4096
    s_nop 0
    buffer_load_dwordx4 v33, s[28:31], s70 offen sc1 lds
    s_add_u32 m0, s76, 143360
    s_bfe_u32 s70, s92, 0x40014
    s_mul_i32 s70, s70, 524288
    buffer_load_dwordx4 v78, s[24:27], s70 offen lds
    buffer_load_dwordx4 v79, s[24:27], s70 offen offset:1024 lds
    buffer_load_dwordx4 v80, s[24:27], s70 offen offset:2048 lds
    buffer_load_dwordx4 v81, s[24:27], s70 offen offset:3072 lds
    s_waitcnt vmcnt(9)
    s_barrier
    s_bfe_u32 s68, s92, 0x4000c
L_UB3:
    s_lshr_b32 s66, s72, s68
    s_and_b32 s66, s66, 4097
    s_cmp_lg_u32 s66, 4097
    s_cbranch_scc1 L_UB3_again
L_UB3_ok:
    s_add_u32 m0, s77, 49152
    s_bfe_u32 s70, s92, 0x4000c
    s_mul_i32 s70, s70, 20480
    buffer_load_dwordx4 v32, s[28:31], s70 offen sc1 lds
    buffer_load_dwordx4 v32, s[28:31], s70 offen offset:1024 sc1 lds
    buffer_load_dwordx4 v32, s[28:31], s70 offen offset:2048 sc1 lds
    buffer_load_dwordx4 v32, s[28:31], s70 offen offset:3072 sc1 lds
    s_add_u32 m0, m0, 4096
    s_nop 0
    buffer_load_dwordx4 v33, s[28:31], s70 offen sc1 lds
    s_add_u32 m0, s76, 90112
    s_bfe_u32 s70, s92, 0x40018
    s_mul_i32 s70, s70, 524288
    buffer_load_dwordx4 v78, s[24:27], s70 offen lds
    buffer_load_dwordx4 v79, s[24:27], s70 offen offset:1024 lds
    buffer_load_dwordx4 v80, s[24:27], s70 offen offset:2048 lds
    buffer_load_dwordx4 v81, s[24:27], s70 offen offset:3072 lds
    s_waitcnt vmcnt(13)
    s_barrier
    s_bfe_u32 s68, s92, 0x40010
L_UB4:
    s_lshr_b32 s66, s72, s68
    s_and_b32 s66, s66, 4097
    s_cmp_lg_u32 s66, 4097
    s_cbranch_scc1 L_UB4_again
L_UB4_ok:
    s_add_u32 m0, s77, 106496
    s_bfe_u32 s70, s92, 0x40010
    s_mul_i32 s70, s70, 20480
    buffer_load_dwordx4 v32, s[28:31], s70 offen sc1 lds
    buffer_load_dwordx4 v32, s[28:31], s70 offen offset:1024 sc1 lds
    buffer_load_dwordx4 v32, s[28:31], s70 offen offset:2048 sc1 lds
    buffer_load_dwordx4 v32, s[28:31], s70 offen offset:3072 sc1 lds
    s_add_u32 m0, m0, 4096
    s_nop 0
    buffer_load_dwordx4 v33, s[28:31], s70 offen sc1 lds
    s_add_u32 m0, s76, 126976
    s_bfe_u32 s70, s92, 0x4001c
    s_mul_i32 s70, s70, 524288
    buffer_load_dwordx4 v78, s[24:27], s70 offen lds
    buffer_load_dwordx4 v79, s[24:27], s70 offen offset:1024 lds
    buffer_load_dwordx4 v80, s[24:27], s70 offen offset:2048 lds
    buffer_load_dwordx4 v81, s[24:27], s70 offen offset:3072 lds
    s_waitcnt vmcnt(13)
    s_barrier
    s_bfe_u32 s68, s92, 0x40014
L_UB5:
    s_lshr_b32 s66, s72, s68
    s_and_b32 s66, s66, 4097
    s_cmp_lg_u32 s66, 4097
    s_cbranch_scc1 L_UB5_again
L_UB5_ok:
    s_add_u32 m0, s77, 69632
    s_bfe_u32 s70, s92, 0x40014
    s_mul_i32 s70, s70, 20480
    buffer_load_dwordx4 v32, s[28:31], s70 offen sc1 lds
    buffer_load_dwordx4 v32, s[28:31], s70 offen offset:1024 sc1 lds
    buffer_load_dwordx4 v32, s[28:31], s70 offen offset:2048 sc1 lds
    buffer_load_dwordx4 v32, s[28:31], s70 offen offset:3072 sc1 lds
    s_add_u32 m0, m0, 4096
    s_nop 0
    buffer_load_dwordx4 v33, s[28:31], s70 offen sc1 lds
    s_add_u32 m0, s76, 0
    s_bfe_u32 s70, s93, 0x40000
    s_mul_i32 s70, s70, 524288
    buffer_load_dwordx4 v78, s[24:27], s70 offen lds
    buffer_load_dwordx4 v79, s[24:27], s70 offen offset:1024 lds
    buffer_load_dwordx4 v80, s[24:27], s70 offen offset:2048 lds
    buffer_load_dwordx4 v81, s[24:27], s70 offen offset:3072 lds
    s_waitcnt vmcnt(13)
    s_barrier
    s_bfe_u32 s68, s92, 0x40018
L_UB6:
    s_lshr_b32 s66, s72, s68
    s_and_b32 s66, s66, 4097
    s_cmp_lg_u32 s66, 4097
    s_cbranch_scc1 L_UB6_again
L_UB6_ok:
    s_add_u32 m0, s77, 49152
    s_bfe_u32 s70, s92, 0x40018
    s_mul_i32 s70, s70, 20480
    buffer_load_dwordx4 v32, s[28:31], s70 offen sc1 lds
    buffer_load_dwordx4 v32, s[28:31], s70 offen offset:1024 sc1 lds
    buffer_load_dwordx4 v32, s[28:31], s70 offen offset:2048 sc1 lds
    buffer_load_dwordx4 v32, s[28:31], s70 offen offset:3072 sc1 lds
    s_add_u32 m0, m0, 4096
    s_nop 0
    buffer_load_dwordx4 v33, s[28:31], s70 offen sc1 lds
    s_add_u32 m0, s76, 16384
    s_bfe_u32 s70, s93, 0x40004
    s_mul_i32 s70, s70, 524288
    buffer_load_dwordx4 v78, s[24:27], s70 offen lds
    buffer_load_dwordx4 v79, s[24:27], s70 offen offset:1024 lds
    buffer_load_dwordx4 v80, s[24:27], s70 offen offset:2048 lds
    buffer_load_dwordx4 v81, s[24:27], s70 offen offset:3072 lds
    s_waitcnt vmcnt(13)
    s_barrier
    s_bfe_u32 s68, s92, 0x4001c
L_UB7:
    s_lshr_b32 s66, s72, s68
    s_and_b32 s66, s66, 4097
    s_cmp_lg_u32 s66, 4097
    s_cbranch_scc1 L_UB7_again
L_UB7_ok:
    s_add_u32 m0, s77, 106496
    s_bfe_u32 s70, s92, 0x4001c
    s_mul_i32 s70, s70, 20480
    buffer_load_dwordx4 v32, s[28:31], s70 offen sc1 lds
    buffer_load_dwordx4 v32, s[28:31], s70 offen offset:1024 sc1 lds
    buffer_load_dwordx4 v32, s[28:31], s70 offen offset:2048 sc1 lds
    buffer_load_dwordx4 v32, s[28:31], s70 offen offset:3072 sc1 lds
    s_add_u32 m0, m0, 4096
    s_nop 0
    buffer_load_dwordx4 v33, s[28:31], s70 offen sc1 lds
    s_add_u32 m0, s76, 32768
    s_bfe_u32 s70, s93, 0x40008
    s_mul_i32 s70, s70, 524288
    buffer_load_dwordx4 v78, s[24:27], s70 offen lds
    buffer_load_dwordx4 v79, s[24:27], s70 offen offset:1024 lds
    buffer_load_dwordx4 v80, s[24:27], s70 offen offset:2048 lds
    buffer_load_dwordx4 v81, s[24:27], s70 offen offset:3072 lds
    s_waitcnt vmcnt(13)
    s_barrier
    s_bfe_u32 s68, s93, 0x40000
L_UB8:
    s_lshr_b32 s66, s72, s68
    s_and_b32 s66, s66, 4097
    s_cmp_lg_u32 s66, 4097
    s_cbranch_scc1 L_UB8_again
L_UB8_ok:
    s_add_u32 m0, s77, 69632
    s_bfe_u32 s70, s93, 0x40000
    s_mul_i32 s70, s70, 20480
    buffer_load_dwordx4 v32, s[28:31], s70 offen sc1 lds
    buffer_load_dwordx4 v32, s[28:31], s70 offen offset:1024 sc1 lds
    buffer_load_dwordx4 v32, s[28:31], s70 offen offset:2048 sc1 lds
    buffer_load_dwordx4 v32, s[28:31], s70 offen offset:3072 sc1 lds
    s_add_u32 m0, m0, 4096
    s_nop 0
    buffer_load_dwordx4 v33, s[28:31], s70 offen sc1 lds
    s_add_u32 m0, s76, 143360
    s_bfe_u32 s70, s93, 0x4000c
    s_mul_i32 s70, s70, 524288
    buffer_load_dwordx4 v78, s[24:27], s70 offen lds
    buffer_load_dwordx4 v79, s[24:27], s70 offen offset:1024 lds
    buffer_load_dwordx4 v80, s[24:27], s70 offen offset:2048 lds
    buffer_load_dwordx4 v81, s[24:27], s70 offen offset:3072 lds
    s_waitcnt vmcnt(13)
    s_barrier
    s_bfe_u32 s68, s93, 0x40004
L_UB9:
    s_lshr_b32 s66, s72, s68
    s_and_b32 s66, s66, 4097
    s_cmp_lg_u32 s66, 4097
    s_cbranch_scc1 L_UB9_again
L_UB9_ok:
    s_add_u32 m0, s77, 49152
    s_bfe_u32 s70, s93, 0x40004
    s_mul_i32 s70, s70, 20480
    buffer_load_dwordx4 v32, s[28:31], s70 offen sc1 lds
    buffer_load_dwordx4 v32, s[28:31], s70 offen offset:1024 sc1 lds
    buffer_load_dwordx4 v32, s[28:31], s70 offen offset:2048 sc1 lds
    buffer_load_dwordx4 v32, s[28:31], s70 offen offset:3072 sc1 lds
    s_add_u32 m0, m0, 4096
    s_nop 0
    buffer_load_dwordx4 v33, s[28:31], s70 offen sc1 lds
    s_waitcnt vmcnt(9)
    s_barrier
    s_bfe_u32 s68, s93, 0x40008
L_UB10:
    s_lshr_b32 s66, s72, s68
    s_and_b32 s66, s66, 4097
    s_cmp_lg_u32 s66, 4097
    s_cbranch_scc1 L_UB10_again
L_UB10_ok:
    s_add_u32 m0, s77, 90112
    s_bfe_u32 s70, s93, 0x40008
    s_mul_i32 s70, s70, 20480
    buffer_load_dwordx4 v32, s[28:31], s70 offen sc1 lds
    buffer_load_dwordx4 v32, s[28:31], s70 offen offset:1024 sc1 lds
    buffer_load_dwordx4 v32, s[28:31], s70 offen offset:2048 sc1 lds
    buffer_load_dwordx4 v32, s[28:31], s70 offen offset:3072 sc1 lds
    s_add_u32 m0, m0, 4096
    s_nop 0
    buffer_load_dwordx4 v33, s[28:31], s70 offen sc1 lds
    s_waitcnt vmcnt(5)
    s_barrier
    s_bfe_u32 s68, s93, 0x4000c
L_UB11:
    s_lshr_b32 s66, s72, s68
    s_and_b32 s66, s66, 4097
    s_cmp_lg_u32 s66, 4097
    s_cbranch_scc1 L_UB11_again
L_UB11_ok:
    s_add_u32 m0, s77, 69632
    s_bfe_u32 s70, s93, 0x4000c
    s_mul_i32 s70, s70, 20480
    buffer_load_dwordx4 v32, s[28:31], s70 offen sc1 lds
    buffer_load_dwordx4 v32, s[28:31], s70 offen offset:1024 sc1 lds
    buffer_load_dwordx4 v32, s[28:31], s70 offen offset:2048 sc1 lds
    buffer_load_dwordx4 v32, s[28:31], s70 offen offset:3072 sc1 lds
    s_add_u32 m0, m0, 4096
    s_nop 0
    buffer_load_dwordx4 v33, s[28:31], s70 offen sc1 lds
    s_waitcnt vmcnt(5)
    s_barrier
    s_waitcnt vmcnt(0)
    s_barrier
    s_endpgm
L_poll_Bh_again:
    s_sub_u32 s67, s67, 1
    s_cbranch_scc1 L_poll_Bh_ok
    s_sleep 12
    buffer_load_dword v50, v48, s[28:31], 0 offen sc1
    buffer_load_dword v51, v48, s[28:31], s75 offen sc1
    s_waitcnt vmcnt(0)
    s_branch L_poll_Bh
L_poll_Bo_again:
    s_sub_u32 s67, s67, 1
    s_cbranch_scc1 L_poll_Bo_ok
    s_sleep 12
    buffer_load_dword v50, v48, s[28:31], 0 offen sc1
    s_waitcnt vmcnt(0)
    s_branch L_poll_Bo
L_UB0_again:
    s_sub_u32 s73, s73, 1
    s_cbranch_scc1 L_UB0_ok
    buffer_load_dword v50, v48, s[28:31], 0 offen sc1
    s_waitcnt vmcnt(0)
    v_cmp_eq_u32 vcc, v50, v29
    s_nop 1
    s_cmp_eq_u32 vcc_lo, s72
    s_mov_b32 s72, vcc_lo
    s_cbranch_scc0 L_UB0
    s_sleep 12
    s_branch L_UB0
L_UB1_again:
    s_sub_u32 s73, s73, 1
    s_cbranch_scc1 L_UB1_ok
    buffer_load_dword v50, v48, s[28:31], 0 offen sc1
    s_waitcnt vmcnt(0)
    v_cmp_eq_u32 vcc, v50, v29
    s_nop 1
    s_cmp_eq_u32 vcc_lo, s72
    s_mov_b32 s72, vcc_lo
    s_cbranch_scc0 L_UB1
    s_sleep 12
    s_branch L_UB1
L_UB2_again:
    s_sub_u32 s73, s73, 1
    s_cbranch_scc1 L_UB2_ok
    buffer_load_dword v50, v48, s[28:31], 0 offen sc1
    s_waitcnt vmcnt(0)
    v_cmp_eq_u32 vcc, v50, v29
    s_nop 1
    s_cmp_eq_u32 vcc_lo, s72
    s_mov_b32 s72, vcc_lo
    s_cbranch_scc0 L_UB2
    s_sleep 12
    s_branch L_UB2
L_UB3_again:
    s_sub_u32 s73, s73, 1
    s_cbranch_scc1 L_UB3_ok
    buffer_load_dword v50, v48, s[28:31], 0 offen sc1
    s_waitcnt vmcnt(0)
    v_cmp_eq_u32 vcc, v50, v29
    s_nop 1
    s_cmp_eq_u32 vcc_lo, s72
    s_mov_b32 s72, vcc_lo
    s_cbranch_scc0 L_UB3
    s_sleep 12
    s_branch L_UB3
L_UB4_again:
    s_sub_u32 s73, s73, 1
    s_cbranch_scc1 L_UB4_ok
    buffer_load_dword v50, v48, s[28:31], 0 offen sc1
    s_waitcnt vmcnt(0)
    v_cmp_eq_u32 vcc, v50, v29
    s_nop 1
    s_cmp_eq_u32 vcc_lo, s72
    s_mov_b32 s72, vcc_lo
    s_cbranch_scc0 L_UB4
    s_sleep 12
    s_branch L_UB4
L_UB5_again:
    s_sub_u32 s73, s73, 1
    s_cbranch_scc1 L_UB5_ok
    buffer_load_dword v50, v48, s[28:31], 0 offen sc1
    s_waitcnt vmcnt(0)
    v_cmp_eq_u32 vcc, v50, v29
    s_nop 1
    s_cmp_eq_u32 vcc_lo, s72
    s_mov_b32 s72, vcc_lo
    s_cbranch_scc0 L_UB5
    s_sleep 12
    s_branch L_UB5
L_UB6_again:
    s_sub_u32 s73, s73, 1
    s_cbranch_scc1 L_UB6_ok
    buffer_load_dword v50, v48, s[28:31], 0 offen sc1
    s_waitcnt vmcnt(0)
    v_cmp_eq_u32 vcc, v50, v29
    s_nop 1
    s_cmp_eq_u32 vcc_lo, s72
    s_mov_b32 s72, vcc_lo
    s_cbranch_scc0 L_UB6
    s_sleep 12
    s_branch L_UB6
L_UB7_again:
    s_sub_u32 s73, s73, 1
    s_cbranch_scc1 L_UB7_ok
    buffer_load_dword v50, v48, s[28:31], 0 offen sc1
    s_waitcnt vmcnt(0)
    v_cmp_eq_u32 vcc, v50, v29
    s_nop 1
    s_cmp_eq_u32 vcc_lo, s72
    s_mov_b32 s72, vcc_lo
    s_cbranch_scc0 L_UB7
    s_sleep 12
    s_branch L_UB7
L_UB8_again:
    s_sub_u32 s73, s73, 1
    s_cbranch_scc1 L_UB8_ok
    buffer_load_dword v50, v48, s[28:31], 0 offen sc1
    s_waitcnt vmcnt(0)
    v_cmp_eq_u32 vcc, v50, v29
    s_nop 1
    s_cmp_eq_u32 vcc_lo, s72
    s_mov_b32 s72, vcc_lo
    s_cbranch_scc0 L_UB8
    s_sleep 12
    s_branch L_UB8
L_UB9_again:
    s_sub_u32 s73, s73, 1
    s_cbranch_scc1 L_UB9_ok
    buffer_load_dword v50, v48, s[28:31], 0 offen sc1
    s_waitcnt vmcnt(0)
    v_cmp_eq_u32 vcc, v50, v29
    s_nop 1
    s_cmp_eq_u32 vcc_lo, s72
    s_mov_b32 s72, vcc_lo
    s_cbranch_scc0 L_UB9
    s_sleep 12
    s_branch L_UB9
L_UB10_again:
    s_sub_u32 s73, s73, 1
    s_cbranch_scc1 L_UB10_ok
    buffer_load_dword v50, v48, s[28:31], 0 offen sc1
    s_waitcnt vmcnt(0)
    v_cmp_eq_u32 vcc, v50, v29
    s_nop 1
    s_cmp_eq_u32 vcc_lo, s72
    s_mov_b32 s72, vcc_lo
    s_cbranch_scc0 L_UB10
    s_sleep 12
    s_branch L_UB10
L_UB11_again:
    s_sub_u32 s73, s73, 1
    s_cbranch_scc1 L_UB11_ok
    buffer_load_dword v50, v48, s[28:31], 0 offen sc1
    s_waitcnt vmcnt(0)
    v_cmp_eq_u32 vcc, v50, v29
    s_nop 1
    s_cmp_eq_u32 vcc_lo, s72
    s_mov_b32 s72, vcc_lo
    s_cbranch_scc0 L_UB11
    s_sleep 12
    s_branch L_UB11
L_loaderA2:
    s_mov_b32 s14, 2457600
    s_mov_b32 s15, 0x20000
    v_lshrrev_b32 v40, 5, v0
    v_bfe_u32 v41, v0, 4, 1
    v_lshl_add_u32 v40, v40, 2, v41
    v_mul_u32_u24 v44, 15360, v40
    s_lshr_b32 s66, s52, 1
    s_and_b32 s67, s52, 1
    s_lshl2_add_u32 s66, s66, s67
    s_mul_i32 s67, s66, 30720
    s_mul_i32 s66, s56, 80
    s_add_u32 s66, s66, 1280
    s_add_u32 s66, s66, s67
    v_and_b32 v42, 15, v0
    v_min_u32 v42, 14, v42
    v_lshl_add_u32 v43, v42, 4, v44
    v_add_u32 v43, s66, v43
    v_add_u32 v44, 1200, v43
    v_cmp_le_u32 vcc, 5, v42
    s_nop 1
    v_cndmask_b32 v43, v43, v44, vcc
    v_subrev_u32 v44, 2640, v43
    v_cmp_le_u32 vcc, 10, v42
    s_nop 1
    v_cndmask_b32 v69, v43, v44, vcc
    v_add_u32 v70, 2784, v69
    v_add_u32 v71, 5568, v69
    v_add_u32 v72, 8352, v69
    s_mul_i32 s75, s52, 4224
    s_mov_b32 s30, 12582912
    s_mov_b32 s31, 0x20000
    v_mov_b32 v28, 0
    s_mov_b32 s66, 8126464
    buffer_load_dword v21, v28, s[28:31], s66 offen sc1
    s_add_u32 m0, s75, 34816
    s_bfe_u32 s70, s86, 0x40000
    s_mul_i32 s70, s70, 245760
    buffer_load_dwordx4 v69, s[12:15], s70 offen lds
    buffer_load_dwordx4 v70, s[12:15], s70 offen offset:1056 lds
    buffer_load_dwordx4 v71, s[12:15], s70 offen offset:2112 lds
    buffer_load_dwordx4 v72, s[12:15], s70 offen offset:3168 lds
    s_mov_b32 s86, 0x86534210
    s_mov_b32 s87, 0x97
    s_cmp_eq_u32 s78, 1
    s_cselect_b32 s86, 0x76453201, s86
    s_cselect_b32 s87, 0x89, s87
    s_cmp_eq_u32 s78, 2
    s_cselect_b32 s86, 0x75643120, s86
    s_cselect_b32 s87, 0x98, s87
    s_cmp_eq_u32 s78, 3
    s_cselect_b32 s86, 0x67542310, s86
    s_cselect_b32 s87, 0x98, s87
    s_bfe_u32 s70, s86, 0x40004
    s_mul_i32 s70, s70, 128
    s_add_u32 m0, s74, 51712
    s_nop 0
    buffer_load_dwordx4 v60, s[8:11], s70 offen lds
    s_add_u32 m0, m0, s65
    s_nop 0
    buffer_load_dwordx4 v61, s[8:11], s70 offen lds
    s_add_u32 m0, m0, s65
    s_nop 0
    buffer_load_dwordx4 v62, s[8:11], s70 offen lds
    s_add_u32 m0, m0, s65
    s_nop 0
    buffer_load_dwordx4 v63, s[8:11], s70 offen lds
    s_add_u32 m0, m0, s65
    s_nop 0
    buffer_load_dwordx4 v64, s[8:11], s70 offen lds
    s_add_u32 m0, m0, s65
    s_nop 0
    buffer_load_dwordx4 v65, s[8:11], s70 offen lds
    s_add_u32 m0, m0, s65
    s_nop 0
    buffer_load_dwordx4 v66, s[8:11], s70 offen lds
    s_add_u32 m0, m0, s65
    s_nop 0
    buffer_load_dwordx4 v67, s[8:11], s70 offen lds
    s_add_u32 m0, m0, s65
    s_mov_b32 exec_hi, 0
    buffer_load_dwordx4 v68, s[8:11], s70 offen lds
    s_mov_b32 exec_hi, -1
    s_add_u32 m0, s75, 86528
    s_bfe_u32 s70, s86, 0x40004
    s_mul_i32 s70, s70, 245760
    buffer_load_dwordx4 v69, s[12:15], s70 offen lds
    buffer_load_dwordx4 v70, s[12:15], s70 offen offset:1056 lds
    buffer_load_dwordx4 v71, s[12:15], s70 offen offset:2112 lds
    buffer_load_dwordx4 v72, s[12:15], s70 offen offset:3168 lds
    s_lshl_b32 s76, s52, 12
    s_setprio 1
    s_waitcnt vmcnt(13)
    s_barrier
    s_bfe_u32 s70, s86, 0x40008
    s_mul_i32 s70, s70, 128
    s_add_u32 m0, s74, 103424
    s_nop 0
    buffer_load_dwordx4 v60, s[8:11], s70 offen lds
    s_add_u32 m0, m0, s65
    s_nop 0
    buffer_load_dwordx4 v61, s[8:11], s70 offen lds
    s_add_u32 m0, m0, s65
    s_nop 0
    buffer_load_dwordx4 v62, s[8:11], s70 offen lds
    s_add_u32 m0, m0, s65
    s_nop 0
    buffer_load_dwordx4 v63, s[8:11], s70 offen lds
    s_add_u32 m0, m0, s65
    s_nop 0
    buffer_load_dwordx4 v64, s[8:11], s70 offen lds
    s_add_u32 m0, m0, s65
    s_nop 0
    buffer_load_dwordx4 v65, s[8:11], s70 offen lds
    s_add_u32 m0, m0, s65
    s_nop 0
    buffer_load_dwordx4 v66, s[8:11], s70 offen lds
    s_add_u32 m0, m0, s65
    s_nop 0
    buffer_load_dwordx4 v67, s[8:11], s70 offen lds
    s_add_u32 m0, m0, s65
    s_mov_b32 exec_hi, 0
    buffer_load_dwordx4 v68, s[8:11], s70 offen lds
    s_mov_b32 exec_hi, -1
    s_add_u32 m0, s75, 138240
    s_bfe_u32 s70, s86, 0x40008
    s_mul_i32 s70, s70, 245760
    buffer_load_dwordx4 v69, s[12:15], s70 offen lds
    buffer_load_dwordx4 v70, s[12:15], s70 offen offset:1056 lds
    buffer_load_dwordx4 v71, s[12:15], s70 offen offset:2112 lds
    buffer_load_dwordx4 v72, s[12:15], s70 offen offset:3168 lds
    s_mov_b32 s26, 6291456
    s_mov_b32 s27, 0x20000
    s_lshr_b32 s66, s53, 1
    s_and_b32 s67, s53, 1
    s_lshr_b32 s68, s54, 2
    s_lshl3_add_u32 s60, s66, s68
    s_and_b32 s68, s54, 3
    s_lshl2_add_u32 s61, s67, s68
    s_lshr_b32 s66, s54, 2
    s_add_u32 s66, s66, s54
    s_and_b32 s66, s66, 3
    s_and_b32 s67, s53, 1
    s_mul_i32 s67, s67, 4
    s_add_u32 s67, s67, s66
    s_mov_b32 s92, 0x65834210
    s_mov_b32 s93, 0xba97
    s_cmp_eq_u32 s67, 1
    s_cselect_b32 s92, 0x69453201, s92
    s_cselect_b32 s93, 0xba87, s93
    s_cmp_eq_u32 s67, 2
    s_cselect_b32 s92, 0xa5643102, s92
    s_cselect_b32 s93, 0xb987, s93
    s_cmp_eq_u32 s67, 3
    s_cselect_b32 s92, 0x67542103, s92
    s_cselect_b32 s93, 0xa98b, s93
    s_cmp_eq_u32 s67, 4
    s_cselect_b32 s92, 0x86532140, s92
    s_cselect_b32 s93, 0xba97, s93
    s_cmp_eq_u32 s67, 5
    s_cselect_b32 s92, 0x76432501, s92
    s_cselect_b32 s93, 0xba89, s93
    s_cmp_eq_u32 s67, 6
    s_cselect_b32 s92, 0x75436120, s92
    s_cselect_b32 s93, 0xb9a8, s93
    s_cmp_eq_u32 s67, 7
    s_cselect_b32 s92, 0x65472310, s92
    s_cselect_b32 s93, 0xab98, s93
    s_mov_b32 s90, 0x34210
    s_cmp_eq_u32 s66, 1
    s_cselect_b32 s90, 0x43201, s90
    s_cmp_eq_u32 s66, 2
    s_cselect_b32 s90, 0x43120, s90
    s_cmp_eq_u32 s66, 3
    s_cselect_b32 s90, 0x42310, s90
    v_lshrrev_b32 v40, 4, v0
    v_lshlrev_b32 v40, 1, v40
    v_and_b32 v41, 7, v0
    v_xor_b32 v40, v40, v41
    v_lshlrev_b32 v40, 4, v40
    v_lshrrev_b32 v41, 3, v0
    v_lshlrev_b32 v41, 12, v41
    s_lshl_b32 s66, s52, 17
    s_waitcnt vmcnt(13)
    s_barrier
    s_bfe_u32 s70, s86, 0x4000c
    s_mul_i32 s70, s70, 128
    s_add_u32 m0, s74, 0
    s_nop 0
    buffer_load_dwordx4 v60, s[8:11], s70 offen lds
    s_add_u32 m0, m0, s65
    s_nop 0
    buffer_load_dwordx4 v61, s[8:11], s70 offen lds
    s_add_u32 m0, m0, s65
    s_nop 0
    buffer_load_dwordx4 v62, s[8:11], s70 offen lds
    s_add_u32 m0, m0, s65
    s_nop 0
    buffer_load_dwordx4 v63, s[8:11], s70 offen lds
    s_add_u32 m0, m0, s65
    s_nop 0
    buffer_load_dwordx4 v64, s[8:11], s70 offen lds
    s_add_u32 m0, m0, s65
    s_nop 0
    buffer_load_dwordx4 v65, s[8:11], s70 offen lds
    s_add_u32 m0, m0, s65
    s_nop 0
    buffer_load_dwordx4 v66, s[8:11], s70 offen lds
    s_add_u32 m0, m0, s65
    s_nop 0
    buffer_load_dwordx4 v67, s[8:11], s70 offen lds
    s_add_u32 m0, m0, s65
    s_mov_b32 exec_hi, 0
    buffer_load_dwordx4 v68, s[8:11], s70 offen lds
    s_mov_b32 exec_hi, -1
    s_add_u32 m0, s75, 34816
    s_bfe_u32 s70, s86, 0x4000c
    s_mul_i32 s70, s70, 245760
    buffer_load_dwordx4 v69, s[12:15], s70 offen lds
    buffer_load_dwordx4 v70, s[12:15], s70 offen offset:1056 lds
    buffer_load_dwordx4 v71, s[12:15], s70 offen offset:2112 lds
    buffer_load_dwordx4 v72, s[12:15], s70 offen offset:3168 lds
    s_lshl_b32 s67, s60, 7
    s_add_u32 s66, s66, s67
    v_add3_u32 v41, v41, v40, s66
    v_add_u32 v78, 0, v41
    v_add_u32 v79, 31744, v41
    v_add_u32 v80, 63488, v41
    v_add_u32 v81, 95232, v41
    v_lshlrev_b32 v40, 4, v0
    v_add_u32 v37, s76, v40
    s_mul_i32 s77, s52, 5120
    s_mul_i32 s66, s61, 245760
    s_add_u32 s66, s66, s77
    s_add_u32 s66, s66, 3145728
    v_add_u32 v32, s66, v40
    v_add_u32 v33, 4096, v32
    s_mul_i32 s66, s60, 81920
    s_add_u32 s66, s66, s76
    s_add_u32 s66, s66, 5242880
    v_add_u32 v36, s66, v40
    s_mul_i32 s66, s61, 102400
    s_add_u32 s66, s66, s77
    s_add_u32 s66, s66, 11534336
    v_add_u32 v34, s66, v40
    v_add_u32 v35, 4096, v34
    s_mov_b32 s79, 1
    s_mov_b32 s3, 0xffff0000
    v_and_b32 v1, 15, v0
    v_lshrrev_b32 v2, 4, v0
    s_lshl4_add_u32 s66, s55, s56
    s_lshl_b32 s66, s66, 7
    s_add_u32 s64, s66, 7929856
    s_lshl_b32 s66, s52, 5
    s_add_u32 s66, s66, 16
    v_add_u32 v244, s66, v1
    v_lshrrev_b32 v245, 2, v0
    s_waitcnt vmcnt(13)
    s_barrier
    s_bfe_u32 s70, s86, 0x40010
    s_mul_i32 s70, s70, 128
    s_add_u32 m0, s74, 51712
    s_nop 0
    buffer_load_dwordx4 v60, s[8:11], s70 offen lds
    s_add_u32 m0, m0, s65
    s_nop 0
    buffer_load_dwordx4 v61, s[8:11], s70 offen lds
    s_add_u32 m0, m0, s65
    s_nop 0
    buffer_load_dwordx4 v62, s[8:11], s70 offen lds
    s_add_u32 m0, m0, s65
    s_nop 0
    buffer_load_dwordx4 v63, s[8:11], s70 offen lds
    s_add_u32 m0, m0, s65
    s_nop 0
    buffer_load_dwordx4 v64, s[8:11], s70 offen lds
    s_add_u32 m0, m0, s65
    s_nop 0
    buffer_load_dwordx4 v65, s[8:11], s70 offen lds
    s_add_u32 m0, m0, s65
    s_nop 0
    buffer_load_dwordx4 v66, s[8:11], s70 offen lds
    s_add_u32 m0, m0, s65
    s_nop 0
    buffer_load_dwordx4 v67, s[8:11], s70 offen lds
    s_add_u32 m0, m0, s65
    s_mov_b32 exec_hi, 0
    buffer_load_dwordx4 v68, s[8:11], s70 offen lds
    s_mov_b32 exec_hi, -1
    s_add_u32 m0, s75, 86528
    s_bfe_u32 s70, s86, 0x40010
    s_mul_i32 s70, s70, 245760
    buffer_load_dwordx4 v69, s[12:15], s70 offen lds
    buffer_load_dwordx4 v70, s[12:15], s70 offen offset:1056 lds
    buffer_load_dwordx4 v71, s[12:15], s70 offen offset:2112 lds
    buffer_load_dwordx4 v72, s[12:15], s70 offen offset:3168 lds
    v_add_u32 v245, s66, v245
    v_mul_u32_u24 v244, 336, v244
    v_lshl_add_u32 v244, v2, 4, v244
    v_add_u32 v234, 51712, v244
    v_mul_u32_u24 v245, 336, v245
    v_and_b32 v244, 3, v0
    v_lshl_add_u32 v245, v244, 3, v245
    v_add_u32 v237, 51792, v245
    s_add_u32 s66, s66, 16
    v_add_u32 v244, s66, v1
    v_lshrrev_b32 v245, 2, v0
    v_add_u32 v245, s66, v245
    v_min_u32 v244, 135, v244
    v_min_u32 v245, 135, v245
    v_mul_u32_u24 v244, 336, v244
    v_lshl_add_u32 v244, v2, 4, v244
    v_add_u32 v235, 51712, v244
    v_mul_u32_u24 v245, 336, v245
    v_and_b32 v244, 3, v0
    v_lshl_add_u32 v245, v244, 3, v245
    v_add_u32 v238, 51792, v245
    s_add_u32 s66, s66, 16
    s_lshl_b32 s66, s52, 5
    v_add_u32 v244, s66, v1
    v_mul_u32_u24 v244, 208, v244
    v_lshl_add_u32 v244, v2, 4, v244
    v_add_u32 v240, 102400, v244
    v_cmp_gt_u32 vcc, 3, v2
    v_nop
    v_nop
    v_cndmask_b32 v232, 0, -1, vcc
    v_cmp_gt_u32 vcc, 2, v2
    v_nop
    v_nop
    v_cndmask_b32 v233, 0, -1, vcc
    s_mov_b32 s66, 0
    v_add_u32 v244, 1, v1
    v_max_u32 v244, s66, v244
    v_add_u32 v245, 8, v1
    v_mov_b32 v250, 1.0
    v_mov_b32 v251, 0xce6e6b28
    v_lshl_add_u32 v246, v2, 2, 0
    v_cmp_ge_u32 s[80:81], v246, v244
    v_cmp_le_u32 vcc, v246, v245
    v_add_u32 v246, 16, v246
    s_nop 0
    s_and_b64 s[80:81], s[80:81], vcc
    s_waitcnt vmcnt(13)
    s_barrier
    s_bfe_u32 s70, s86, 0x40014
    s_mul_i32 s70, s70, 128
    s_add_u32 m0, s74, 103424
    s_nop 0
    buffer_load_dwordx4 v60, s[8:11], s70 offen lds
    s_add_u32 m0, m0, s65
    s_nop 0
    buffer_load_dwordx4 v61, s[8:11], s70 offen lds
    s_add_u32 m0, m0, s65
    s_nop 0
    buffer_load_dwordx4 v62, s[8:11], s70 offen lds
    s_add_u32 m0, m0, s65
    s_nop 0
    buffer_load_dwordx4 v63, s[8:11], s70 offen lds
    s_add_u32 m0, m0, s65
    s_nop 0
    buffer_load_dwordx4 v64, s[8:11], s70 offen lds
    s_add_u32 m0, m0, s65
    s_nop 0
    buffer_load_dwordx4 v65, s[8:11], s70 offen lds
    s_add_u32 m0, m0, s65
    s_nop 0
    buffer_load_dwordx4 v66, s[8:11], s70 offen lds
    s_add_u32 m0, m0, s65
    s_nop 0
    buffer_load_dwordx4 v67, s[8:11], s70 offen lds
    s_add_u32 m0, m0, s65
    s_mov_b32 exec_hi, 0
    buffer_load_dwordx4 v68, s[8:11], s70 offen lds
    s_mov_b32 exec_hi, -1
    s_add_u32 m0, s75, 138240
    s_bfe_u32 s70, s86, 0x40014
    s_mul_i32 s70, s70, 245760
    buffer_load_dwordx4 v69, s[12:15], s70 offen lds
    buffer_load_dwordx4 v70, s[12:15], s70 offen offset:1056 lds
    buffer_load_dwordx4 v71, s[12:15], s70 offen offset:2112 lds
    buffer_load_dwordx4 v72, s[12:15], s70 offen offset:3168 lds
    v_cmp_le_u32 s[82:83], v246, v245
    v_cndmask_b32 v216, 0, v250, s[80:81]
    v_mov_b32 v246, 0xffff
    v_cndmask_b32 v220, 0, v250, s[82:83]
    v_cndmask_b32 v247, 0, v246, s[82:83]
    s_or_b64 s[80:81], s[80:81], s[82:83]
    v_cndmask_b32 v224, v251, 0, s[80:81]
    v_mov_b32 v230, v247
    v_lshl_add_u32 v246, v2, 2, 1
    v_cmp_ge_u32 s[80:81], v246, v244
    v_cmp_le_u32 vcc, v246, v245
    v_add_u32 v246, 16, v246
    s_nop 0
    s_and_b64 s[80:81], s[80:81], vcc
    v_cmp_le_u32 s[82:83], v246, v245
    v_cndmask_b32 v217, 0, v250, s[80:81]
    v_mov_b32 v246, 0xffff0000
    v_cndmask_b32 v221, 0, v250, s[82:83]
    v_cndmask_b32 v247, 0, v246, s[82:83]
    s_or_b64 s[80:81], s[80:81], s[82:83]
    v_cndmask_b32 v225, v251, 0, s[80:81]
    v_or_b32 v230, v230, v247
    v_not_b32 v228, v230
    v_lshl_add_u32 v246, v2, 2, 2
    v_cmp_ge_u32 s[80:81], v246, v244
    v_cmp_le_u32 vcc, v246, v245
    v_add_u32 v246, 16, v246
    s_nop 0
    s_and_b64 s[80:81], s[80:81], vcc
    v_cmp_le_u32 s[82:83], v246, v245
    v_cndmask_b32 v218, 0, v250, s[80:81]
    v_mov_b32 v246, 0xffff
    v_cndmask_b32 v222, 0, v250, s[82:83]
    v_cndmask_b32 v247, 0, v246, s[82:83]
    s_or_b64 s[80:81], s[80:81], s[82:83]
    v_cndmask_b32 v226, v251, 0, s[80:81]
    v_mov_b32 v231, v247
    v_lshl_add_u32 v246, v2, 2, 3
    v_cmp_ge_u32 s[80:81], v246, v244
    v_cmp_le_u32 vcc, v246, v245
    v_add_u32 v246, 16, v246
    s_nop 0
    s_and_b64 s[80:81], s[80:81], vcc
    v_cmp_le_u32 s[82:83], v246, v245
    v_cndmask_b32 v219, 0, v250, s[80:81]
    v_mov_b32 v246, 0xffff0000
    v_cndmask_b32 v223, 0, v250, s[82:83]
    v_cndmask_b32 v247, 0, v246, s[82:83]
    s_or_b64 s[80:81], s[80:81], s[82:83]
    v_cndmask_b32 v227, v251, 0, s[80:81]
    v_or_b32 v231, v231, v247
    s_waitcnt vmcnt(13)
    s_barrier
    s_bfe_u32 s70, s86, 0x40018
    s_mul_i32 s70, s70, 128
    s_add_u32 m0, s74, 0
    s_nop 0
    buffer_load_dwordx4 v60, s[8:11], s70 offen lds
    s_add_u32 m0, m0, s65
    s_nop 0
    buffer_load_dwordx4 v61, s[8:11], s70 offen lds
    s_add_u32 m0, m0, s65
    s_nop 0
    buffer_load_dwordx4 v62, s[8:11], s70 offen lds
    s_add_u32 m0, m0, s65
    s_nop 0
    buffer_load_dwordx4 v63, s[8:11], s70 offen lds
    s_add_u32 m0, m0, s65
    s_nop 0
    buffer_load_dwordx4 v64, s[8:11], s70 offen lds
    s_add_u32 m0, m0, s65
    s_nop 0
    buffer_load_dwordx4 v65, s[8:11], s70 offen lds
    s_add_u32 m0, m0, s65
    s_nop 0
    buffer_load_dwordx4 v66, s[8:11], s70 offen lds
    s_add_u32 m0, m0, s65
    s_nop 0
    buffer_load_dwordx4 v67, s[8:11], s70 offen lds
    s_add_u32 m0, m0, s65
    s_mov_b32 exec_hi, 0
    buffer_load_dwordx4 v68, s[8:11], s70 offen lds
    s_mov_b32 exec_hi, -1
    s_add_u32 m0, s75, 34816
    s_bfe_u32 s70, s86, 0x40018
    s_mul_i32 s70, s70, 245760
    buffer_load_dwordx4 v69, s[12:15], s70 offen lds
    buffer_load_dwordx4 v70, s[12:15], s70 offen offset:1056 lds
    buffer_load_dwordx4 v71, s[12:15], s70 offen offset:2112 lds
    buffer_load_dwordx4 v72, s[12:15], s70 offen offset:3168 lds
    v_not_b32 v229, v231
    v_and_b32 v244, 1, v2
    v_lshl_add_u32 v244, v1, 1, v244
    v_lshrrev_b32 v243, 4, v244
    v_lshlrev_b32 v243, 10, v243
    v_and_b32 v244, 15, v244
    v_lshl_add_u32 v243, v244, 4, v243
    s_lshl2_add_u32 s66, s55, s52
    s_mul_i32 s66, s66, 81920
    s_add_u32 s66, s66, 5244928
    v_add_u32 v243, s66, v243
    s_mul_i32 s66, s56, 5
    v_lshrrev_b32 v245, 5, v0
    v_add_u32 v244, s66, v245
    v_lshrrev_b32 v241, 2, v244
    v_lshl_add_u32 v241, v241, 12, v243
    v_and_b32 v246, 3, v244
    v_lshl_add_u32 v241, v246, 8, v241
    v_add_u32 v244, 3, v244
    v_lshrrev_b32 v242, 2, v244
    v_lshl_add_u32 v242, v242, 12, v243
    v_and_b32 v246, 3, v244
    v_lshl_add_u32 v242, v246, 8, v242
    v_add_u32 v244, 3, v244
    s_add_u32 s66, s66, 2
    s_and_b32 s67, s66, 3
    s_lshr_b32 s66, s66, 2
    s_lshl4_add_u32 s66, s66, s67
    s_lshl_b32 s66, s66, 8
    v_mul_u32_u24 v245, 12582912, v245
    v_add3_u32 v243, v243, v245, s66
    s_waitcnt vmcnt(13)
    s_barrier
    s_bfe_u32 s70, s86, 0x4001c
    s_mul_i32 s70, s70, 128
    s_add_u32 m0, s74, 51712
    s_nop 0
    buffer_load_dwordx4 v60, s[8:11], s70 offen lds
    s_add_u32 m0, m0, s65
    s_nop 0
    buffer_load_dwordx4 v61, s[8:11], s70 offen lds
    s_add_u32 m0, m0, s65
    s_nop 0
    buffer_load_dwordx4 v62, s[8:11], s70 offen lds
    s_add_u32 m0, m0, s65
    s_nop 0
    buffer_load_dwordx4 v63, s[8:11], s70 offen lds
    s_add_u32 m0, m0, s65
    s_nop 0
    buffer_load_dwordx4 v64, s[8:11], s70 offen lds
    s_add_u32 m0, m0, s65
    s_nop 0
    buffer_load_dwordx4 v65, s[8:11], s70 offen lds
    s_add_u32 m0, m0, s65
    s_nop 0
    buffer_load_dwordx4 v66, s[8:11], s70 offen lds
    s_add_u32 m0, m0, s65
    s_nop 0
    buffer_load_dwordx4 v67, s[8:11], s70 offen lds
    s_add_u32 m0, m0, s65
    s_mov_b32 exec_hi, 0
    buffer_load_dwordx4 v68, s[8:11], s70 offen lds
    s_mov_b32 exec_hi, -1
    s_add_u32 m0, s75, 86528
    s_bfe_u32 s70, s86, 0x4001c
    s_mul_i32 s70, s70, 245760
    buffer_load_dwordx4 v69, s[12:15], s70 offen lds
    buffer_load_dwordx4 v70, s[12:15], s70 offen offset:1056 lds
    buffer_load_dwordx4 v71, s[12:15], s70 offen offset:2112 lds
    buffer_load_dwordx4 v72, s[12:15], s70 offen offset:3168 lds
    s_waitcnt vmcnt(13)
    s_barrier
    s_bfe_u32 s70, s87, 0x40000
    s_mul_i32 s70, s70, 128
    s_add_u32 m0, s74, 103424
    s_nop 0
    buffer_load_dwordx4 v60, s[8:11], s70 offen lds
    s_add_u32 m0, m0, s65
    s_nop 0
    buffer_load_dwordx4 v61, s[8:11], s70 offen lds
    s_add_u32 m0, m0, s65
    s_nop 0
    buffer_load_dwordx4 v62, s[8:11], s70 offen lds
    s_add_u32 m0, m0, s65
    s_nop 0
    buffer_load_dwordx4 v63, s[8:11], s70 offen lds
    s_add_u32 m0, m0, s65
    s_nop 0
    buffer_load_dwordx4 v64, s[8:11], s70 offen lds
    s_add_u32 m0, m0, s65
    s_nop 0
    buffer_load_dwordx4 v65, s[8:11], s70 offen lds
    s_add_u32 m0, m0, s65
    s_nop 0
    buffer_load_dwordx4 v66, s[8:11], s70 offen lds
    s_add_u32 m0, m0, s65
    s_nop 0
    buffer_load_dwordx4 v67, s[8:11], s70 offen lds
    s_add_u32 m0, m0, s65
    s_mov_b32 exec_hi, 0
    buffer_load_dwordx4 v68, s[8:11], s70 offen lds
    s_mov_b32 exec_hi, -1
    s_add_u32 m0, s75, 138240
    s_bfe_u32 s70, s87, 0x40000
    s_mul_i32 s70, s70, 245760
    buffer_load_dwordx4 v69, s[12:15], s70 offen lds
    buffer_load_dwordx4 v70, s[12:15], s70 offen offset:1056 lds
    buffer_load_dwordx4 v71, s[12:15], s70 offen offset:2112 lds
    buffer_load_dwordx4 v72, s[12:15], s70 offen offset:3168 lds
    s_waitcnt vmcnt(13)
    s_barrier
    s_bfe_u32 s70, s87, 0x40004
    s_mul_i32 s70, s70, 128
    s_add_u32 m0, s74, 0
    s_nop 0
    buffer_load_dwordx4 v60, s[8:11], s70 offen lds
    s_add_u32 m0, m0, s65
    s_nop 0
    buffer_load_dwordx4 v61, s[8:11], s70 offen lds
    s_add_u32 m0, m0, s65
    s_nop 0
    buffer_load_dwordx4 v62, s[8:11], s70 offen lds
    s_add_u32 m0, m0, s65
    s_nop 0
    buffer_load_dwordx4 v63, s[8:11], s70 offen lds
    s_add_u32 m0, m0, s65
    s_nop 0
    buffer_load_dwordx4 v64, s[8:11], s70 offen lds
    s_add_u32 m0, m0, s65
    s_nop 0
    buffer_load_dwordx4 v65, s[8:11], s70 offen lds
    s_add_u32 m0, m0, s65
    s_nop 0
    buffer_load_dwordx4 v66, s[8:11], s70 offen lds
    s_add_u32 m0, m0, s65
    s_nop 0
    buffer_load_dwordx4 v67, s[8:11], s70 offen lds
    s_add_u32 m0, m0, s65
    s_mov_b32 exec_hi, 0
    buffer_load_dwordx4 v68, s[8:11], s70 offen lds
    s_mov_b32 exec_hi, -1
    s_add_u32 m0, s75, 34816
    s_bfe_u32 s70, s87, 0x40004
    s_mul_i32 s70, s70, 245760
    buffer_load_dwordx4 v69, s[12:15], s70 offen lds
    buffer_load_dwordx4 v70, s[12:15], s70 offen offset:1056 lds
    buffer_load_dwordx4 v71, s[12:15], s70 offen offset:2112 lds
    buffer_load_dwordx4 v72, s[12:15], s70 offen offset:3168 lds
    s_waitcnt vmcnt(13)
    s_barrier
    s_waitcnt vmcnt(0)
    s_barrier
    s_mov_b32 s66, 0x9e3779b1
    v_mul_lo_u32 v29, v21, s66
    v_add_u32 v29, 0x7f4a7c15, v29
    s_mov_b32 s66, 8093696
    v_lshl_add_u32 v48, v0, 7, s66
    s_movk_i32 s71, 8192
    s_cmp_eq_u32 s52, 0
    s_cselect_b32 s66, 0, 12582912
    v_add_u32 v48, s66, v48
    buffer_load_dword v50, v48, s[28:31], 0 offen sc1
    buffer_load_dword v51, v48, s[28:31], s71 offen sc1
    s_mov_b32 s22, 6291456
    s_mov_b32 s23, 0x20000
    s_lshl2_add_u32 s66, s54, s52
    v_add_u32 v40, 0, v0
    v_min_u32 v40, 59, v40
    v_mul_u32_u24 v41, 171, v40
    v_lshrrev_b32 v41, 10, v41
    v_mad_i32_i24 v40, v41, -6, v40
    v_mul_u32_u24 v41, 3072, v41
    v_lshl_add_u32 v40, v40, 7, v41
    s_mul_i32 s67, s66, 30720
    s_lshr_b32 s68, s53, 1
    s_mul_i32 s68, s68, 768
    s_add_u32 s67, s67, s68
    s_add_u32 s67, s67, 4325376
    buffer_load_dword v42, v40, s[20:23], s67 offen
    v_min_u32 v40, 49, v0
    v_mul_u32_u24 v41, 205, v40
    v_lshrrev_b32 v41, 10, v41
    v_mad_i32_i24 v40, v41, -5, v40
    v_mul_u32_u24 v40, 278528, v40
    v_lshl_add_u32 v40, v41, 7, v40
    s_mul_i32 s67, s66, 1280
    s_and_b32 s68, s53, 1
    s_mul_i32 s68, s68, 1392640
    s_add_u32 s67, s67, s68
    s_add_u32 s67, s67, 180224
    buffer_load_dword v42, v40, s[28:31], s67 offen sc1
    s_waitcnt vmcnt(2)
    s_mov_b32 s67, 0x40000
    s_cmp_lg_u32 s52, 0
    s_cbranch_scc1 L_poll_Ah_ok
L_poll_Ah:
    v_xor_b32 v50, v50, v29
    v_xor_b32 v51, v51, v29
    v_or_b32 v50, v50, v51
    v_cmp_eq_u32 vcc, 0, v50
    s_nop 1
    s_cmp_lg_u64 vcc, -1
    s_cbranch_scc1 L_poll_Ah_again
L_poll_Ah_ok:
    s_or_b32 s66, s2, s52
    s_cbranch_scc0 L_epoch
L_epoch_done:
    s_barrier
    s_add_u32 m0, s77, 125696
    s_bfe_u32 s70, s90, 0x40000
    s_mul_i32 s70, s70, 20480
    buffer_load_dwordx4 v34, s[28:31], s70 offen sc1 lds
    buffer_load_dwordx4 v34, s[28:31], s70 offen offset:1024 sc1 lds
    buffer_load_dwordx4 v34, s[28:31], s70 offen offset:2048 sc1 lds
    buffer_load_dwordx4 v34, s[28:31], s70 offen offset:3072 sc1 lds
    s_add_u32 m0, m0, 4096
    s_nop 0
    buffer_load_dwordx4 v35, s[28:31], s70 offen sc1 lds
    s_add_u32 m0, s77, 0
    s_bfe_u32 s70, s90, 0x40004
    s_mul_i32 s70, s70, 20480
    buffer_load_dwordx4 v34, s[28:31], s70 offen sc1 lds
    buffer_load_dwordx4 v34, s[28:31], s70 offen offset:1024 sc1 lds
    buffer_load_dwordx4 v34, s[28:31], s70 offen offset:2048 sc1 lds
    buffer_load_dwordx4 v34, s[28:31], s70 offen offset:3072 sc1 lds
    s_add_u32 m0, m0, 4096
    s_nop 0
    buffer_load_dwordx4 v35, s[28:31], s70 offen sc1 lds
    s_add_u32 m0, s76, 146176
    s_bfe_u32 s70, s92, 0x40000
    s_mul_i32 s70, s70, 524288
    buffer_load_dwordx4 v78, s[24:27], s70 offen lds
    buffer_load_dwordx4 v79, s[24:27], s70 offen offset:1024 lds
    buffer_load_dwordx4 v80, s[24:27], s70 offen offset:2048 lds
    buffer_load_dwordx4 v81, s[24:27], s70 offen offset:3072 lds
    s_add_u32 m0, s76, 20480
    s_bfe_u32 s70, s92, 0x40004
    s_mul_i32 s70, s70, 524288
    buffer_load_dwordx4 v78, s[24:27], s70 offen lds
    buffer_load_dwordx4 v79, s[24:27], s70 offen offset:1024 lds
    buffer_load_dwordx4 v80, s[24:27], s70 offen offset:2048 lds
    buffer_load_dwordx4 v81, s[24:27], s70 offen offset:3072 lds
    s_setprio 2
    s_branch L_att
L_att_back:
    s_setprio 1
    v_mov_b32 v40, 163832
L_ownA:
    s_sleep 1
    ds_read_b32 v41, v40
    s_waitcnt lgkmcnt(0)
    v_readfirstlane_b32 s66, v41
    s_nop 1
    s_cmp_lt_u32 s66, 8
    s_cbranch_scc1 L_ownA
    s_add_u32 m0, s76, 69632
    s_bfe_u32 s70, s92, 0x40008
    s_mul_i32 s70, s70, 524288
    buffer_load_dwordx4 v78, s[24:27], s70 offen lds
    buffer_load_dwordx4 v79, s[24:27], s70 offen offset:1024 lds
    buffer_load_dwordx4 v80, s[24:27], s70 offen offset:2048 lds
    buffer_load_dwordx4 v81, s[24:27], s70 offen offset:3072 lds
    s_add_u32 m0, s76, 86016
    s_bfe_u32 s70, s92, 0x4000c
    s_mul_i32 s70, s70, 524288
    buffer_load_dwordx4 v78, s[24:27], s70 offen lds
    buffer_load_dwordx4 v79, s[24:27], s70 offen offset:1024 lds
    buffer_load_dwordx4 v80, s[24:27], s70 offen offset:2048 lds
    buffer_load_dwordx4 v81, s[24:27], s70 offen offset:3072 lds
    s_waitcnt vmcnt(0)
    s_lshr_b32 s66, s60, 2
    s_lshl_b32 s66, s66, 11
    s_add_u32 s66, s66, 7929856
    v_and_b32 v48, 15, v0
    v_lshl_add_u32 v48, v48, 7, s66
    buffer_load_dword v50, v48, s[28:31], 0 offen sc1
    s_waitcnt vmcnt(0)
    s_mov_b32 s67, 0x40000
L_poll_Ao:
    v_xor_b32 v50, v50, v29
    v_cmp_eq_u32 vcc, 0, v50
    s_nop 1
    s_cmp_lg_u64 vcc, -1
    s_cbranch_scc1 L_poll_Ao_again
L_poll_Ao_ok:
    s_add_u32 m0, s76, 36864
    s_bfe_u32 s70, s90, 0x40000
    s_mul_i32 s70, s70, 16384
    buffer_load_dwordx4 v36, s[28:31], s70 offen sc1 lds
    buffer_load_dwordx4 v36, s[28:31], s70 offen offset:1024 sc1 lds
    buffer_load_dwordx4 v36, s[28:31], s70 offen offset:2048 sc1 lds
    buffer_load_dwordx4 v36, s[28:31], s70 offen offset:3072 sc1 lds
    s_add_u32 m0, s76, 53248
    s_bfe_u32 s70, s90, 0x40004
    s_mul_i32 s70, s70, 16384
    buffer_load_dwordx4 v36, s[28:31], s70 offen sc1 lds
    buffer_load_dwordx4 v36, s[28:31], s70 offen offset:1024 sc1 lds
    buffer_load_dwordx4 v36, s[28:31], s70 offen offset:2048 sc1 lds
    buffer_load_dwordx4 v36, s[28:31], s70 offen offset:3072 sc1 lds
    s_waitcnt vmcnt(4)
    s_barrier
    s_add_u32 m0, s77, 102400
    s_bfe_u32 s70, s90, 0x40008
    s_mul_i32 s70, s70, 20480
    buffer_load_dwordx4 v34, s[28:31], s70 offen sc1 lds
    buffer_load_dwordx4 v34, s[28:31], s70 offen offset:1024 sc1 lds
    buffer_load_dwordx4 v34, s[28:31], s70 offen offset:2048 sc1 lds
    buffer_load_dwordx4 v34, s[28:31], s70 offen offset:3072 sc1 lds
    s_add_u32 m0, m0, 4096
    s_nop 0
    buffer_load_dwordx4 v35, s[28:31], s70 offen sc1 lds
    s_waitcnt vmcnt(5)
    s_barrier
    s_add_u32 m0, s76, 36864
    s_bfe_u32 s70, s90, 0x40008
    s_mul_i32 s70, s70, 16384
    buffer_load_dwordx4 v36, s[28:31], s70 offen sc1 lds
    buffer_load_dwordx4 v36, s[28:31], s70 offen offset:1024 sc1 lds
    buffer_load_dwordx4 v36, s[28:31], s70 offen offset:2048 sc1 lds
    buffer_load_dwordx4 v36, s[28:31], s70 offen offset:3072 sc1 lds
    s_add_u32 m0, s77, 122880
    s_bfe_u32 s70, s90, 0x4000c
    s_mul_i32 s70, s70, 20480
    buffer_load_dwordx4 v34, s[28:31], s70 offen sc1 lds
    buffer_load_dwordx4 v34, s[28:31], s70 offen offset:1024 sc1 lds
    buffer_load_dwordx4 v34, s[28:31], s70 offen offset:2048 sc1 lds
    buffer_load_dwordx4 v34, s[28:31], s70 offen offset:3072 sc1 lds
    s_add_u32 m0, m0, 4096
    s_nop 0
    buffer_load_dwordx4 v35, s[28:31], s70 offen sc1 lds
    s_waitcnt vmcnt(5)
    s_barrier
    s_add_u32 m0, s76, 0
    s_bfe_u32 s70, s90, 0x4000c
    s_mul_i32 s70, s70, 16384
    buffer_load_dwordx4 v36, s[28:31], s70 offen sc1 lds
    buffer_load_dwordx4 v36, s[28:31], s70 offen offset:1024 sc1 lds
    buffer_load_dwordx4 v36, s[28:31], s70 offen offset:2048 sc1 lds
    buffer_load_dwordx4 v36, s[28:31], s70 offen offset:3072 sc1 lds
    s_add_u32 m0, s76, 53248
    s_bfe_u32 s70, s90, 0x40010
    s_mul_i32 s70, s70, 16384
    buffer_load_dwordx4 v36, s[28:31], s70 offen sc1 lds
    buffer_load_dwordx4 v36, s[28:31], s70 offen offset:1024 sc1 lds
    buffer_load_dwordx4 v36, s[28:31], s70 offen offset:2048 sc1 lds
    buffer_load_dwordx4 v36, s[28:31], s70 offen offset:3072 sc1 lds
    s_waitcnt vmcnt(4)
    s_barrier
    s_add_u32 m0, s77, 102400
    s_bfe_u32 s70, s90, 0x40010
    s_mul_i32 s70, s70, 20480
    buffer_load_dwordx4 v34, s[28:31], s70 offen sc1 lds
    buffer_load_dwordx4 v34, s[28:31], s70 offen offset:1024 sc1 lds
    buffer_load_dwordx4 v34, s[28:31], s70 offen offset:2048 sc1 lds
    buffer_load_dwordx4 v34, s[28:31], s70 offen offset:3072 sc1 lds
    s_add_u32 m0, m0, 4096
    s_nop 0
    buffer_load_dwordx4 v35, s[28:31], s70 offen sc1 lds
    s_add_u32 m0, s76, 36864
    s_bfe_u32 s70, s92, 0x40010
    s_mul_i32 s70, s70, 524288
    buffer_load_dwordx4 v78, s[24:27], s70 offen lds
    buffer_load_dwordx4 v79, s[24:27], s70 offen offset:1024 lds
    buffer_load_dwordx4 v80, s[24:27], s70 offen offset:2048 lds
    buffer_load_dwordx4 v81, s[24:27], s70 offen offset:3072 lds
    s_waitcnt vmcnt(4)
    s_barrier
    s_mul_i32 s66, s61, 80
    s_lshr_b32 s66, s66, 6
    s_mul_i32 s66, s66, 1536
    s_add_u32 s66, s66, 7995392
    v_min_u32 v48, 23, v0
    v_lshl_add_u32 v48, v48, 7, s66
    buffer_load_dword v50, v48, s[28:31], 0 offen sc1
    s_waitcnt vmcnt(0)
    v_cmp_eq_u32 vcc, v50, v29
    s_mov_b32 s73, 0x40000
    s_nop 0
    s_mov_b32 s72, vcc_lo
    s_bfe_u32 s68, s92, 0x40000
L_UA0:
    s_lshr_b32 s66, s72, s68
    s_and_b32 s66, s66, 4097
    s_cmp_lg_u32 s66, 4097
    s_cbranch_scc1 L_UA0_again
L_UA0_ok:
    s_add_u32 m0, s77, 0
    s_bfe_u32 s70, s92, 0x40000
    s_mul_i32 s70, s70, 20480
    buffer_load_dwordx4 v32, s[28:31], s70 offen sc1 lds
    buffer_load_dwordx4 v32, s[28:31], s70 offen offset:1024 sc1 lds
    buffer_load_dwordx4 v32, s[28:31], s70 offen offset:2048 sc1 lds
    buffer_load_dwordx4 v32, s[28:31], s70 offen offset:3072 sc1 lds
    s_add_u32 m0, m0, 4096
    s_nop 0
    buffer_load_dwordx4 v33, s[28:31], s70 offen sc1 lds
    s_bfe_u32 s68, s92, 0x40004
L_UA1:
    s_lshr_b32 s66, s72, s68
    s_and_b32 s66, s66, 4097
    s_cmp_lg_u32 s66, 4097
    s_cbranch_scc1 L_UA1_again
L_UA1_ok:
    s_add_u32 m0, s77, 122880
    s_bfe_u32 s70, s92, 0x40004
    s_mul_i32 s70, s70, 20480
    buffer_load_dwordx4 v32, s[28:31], s70 offen sc1 lds
    buffer_load_dwordx4 v32, s[28:31], s70 offen offset:1024 sc1 lds
    buffer_load_dwordx4 v32, s[28:31], s70 offen offset:2048 sc1 lds
    buffer_load_dwordx4 v32, s[28:31], s70 offen offset:3072 sc1 lds
    s_add_u32 m0, m0, 4096
    s_nop 0
    buffer_load_dwordx4 v33, s[28:31], s70 offen sc1 lds
    s_waitcnt vmcnt(5)
    s_barrier
    s_bfe_u32 s68, s92, 0x40008
L_UA2:
    s_lshr_b32 s66, s72, s68
    s_and_b32 s66, s66, 4097
    s_cmp_lg_u32 s66, 4097
    s_cbranch_scc1 L_UA2_again
L_UA2_ok:
    s_add_u32 m0, s77, 102400
    s_bfe_u32 s70, s92, 0x40008
    s_mul_i32 s70, s70, 20480
    buffer_load_dwordx4 v32, s[28:31], s70 offen sc1 lds
    buffer_load_dwordx4 v32, s[28:31], s70 offen offset:1024 sc1 lds
    buffer_load_dwordx4 v32, s[28:31], s70 offen offset:2048 sc1 lds
    buffer_load_dwordx4 v32, s[28:31], s70 offen offset:3072 sc1 lds
    s_add_u32 m0, m0, 4096
    s_nop 0
    buffer_load_dwordx4 v33, s[28:31], s70 offen sc1 lds
    s_add_u32 m0, s76, 53248
    s_bfe_u32 s70, s92, 0x40014
    s_mul_i32 s70, s70, 524288
    buffer_load_dwordx4 v78, s[24:27], s70 offen lds
    buffer_load_dwordx4 v79, s[24:27], s70 offen offset:1024 lds
    buffer_load_dwordx4 v80, s[24:27], s70 offen offset:2048 lds
    buffer_load_dwordx4 v81, s[24:27], s70 offen offset:3072 lds
    s_waitcnt vmcnt(9)
    s_barrier
    s_bfe_u32 s68, s92, 0x4000c
L_UA3:
    s_lshr_b32 s66, s72, s68
    s_and_b32 s66, s66, 4097
    s_cmp_lg_u32 s66, 4097
    s_cbranch_scc1 L_UA3_again
L_UA3_ok:
    s_add_u32 m0, s77, 0
    s_bfe_u32 s70, s92, 0x4000c
    s_mul_i32 s70, s70, 20480
    buffer_load_dwordx4 v32, s[28:31], s70 offen sc1 lds
    buffer_load_dwordx4 v32, s[28:31], s70 offen offset:1024 sc1 lds
    buffer_load_dwordx4 v32, s[28:31], s70 offen offset:2048 sc1 lds
    buffer_load_dwordx4 v32, s[28:31], s70 offen offset:3072 sc1 lds
    s_add_u32 m0, m0, 4096
    s_nop 0
    buffer_load_dwordx4 v33, s[28:31], s70 offen sc1 lds
    s_add_u32 m0, s76, 143360
    s_bfe_u32 s70, s92, 0x40018
    s_mul_i32 s70, s70, 524288
    buffer_load_dwordx4 v78, s[24:27], s70 offen lds
    buffer_load_dwordx4 v79, s[24:27], s70 offen offset:1024 lds
    buffer_load_dwordx4 v80, s[24:27], s70 offen offset:2048 lds
    buffer_load_dwordx4 v81, s[24:27], s70 offen offset:3072 lds
    s_waitcnt vmcnt(13)
    s_barrier
    s_bfe_u32 s68, s92, 0x40010
L_UA4:
    s_lshr_b32 s66, s72, s68
    s_and_b32 s66, s66, 4097
    s_cmp_lg_u32 s66, 4097
    s_cbranch_scc1 L_UA4_again
L_UA4_ok:
    s_add_u32 m0, s77, 122880
    s_bfe_u32 s70, s92, 0x40010
    s_mul_i32 s70, s70, 20480
    buffer_load_dwordx4 v32, s[28:31], s70 offen sc1 lds
    buffer_load_dwordx4 v32, s[28:31], s70 offen offset:1024 sc1 lds
    buffer_load_dwordx4 v32, s[28:31], s70 offen offset:2048 sc1 lds
    buffer_load_dwordx4 v32, s[28:31], s70 offen offset:3072 sc1 lds
    s_add_u32 m0, m0, 4096
    s_nop 0
    buffer_load_dwordx4 v33, s[28:31], s70 offen sc1 lds
    s_add_u32 m0, s76, 20480
    s_bfe_u32 s70, s92, 0x4001c
    s_mul_i32 s70, s70, 524288
    buffer_load_dwordx4 v78, s[24:27], s70 offen lds
    buffer_load_dwordx4 v79, s[24:27], s70 offen offset:1024 lds
    buffer_load_dwordx4 v80, s[24:27], s70 offen offset:2048 lds
    buffer_load_dwordx4 v81, s[24:27], s70 offen offset:3072 lds
    s_waitcnt vmcnt(13)
    s_barrier
    s_bfe_u32 s68, s92, 0x40014
L_UA5:
    s_lshr_b32 s66, s72, s68
    s_and_b32 s66, s66, 4097
    s_cmp_lg_u32 s66, 4097
    s_cbranch_scc1 L_UA5_again
L_UA5_ok:
    s_add_u32 m0, s77, 102400
    s_bfe_u32 s70, s92, 0x40014
    s_mul_i32 s70, s70, 20480
    buffer_load_dwordx4 v32, s[28:31], s70 offen sc1 lds
    buffer_load_dwordx4 v32, s[28:31], s70 offen offset:1024 sc1 lds
    buffer_load_dwordx4 v32, s[28:31], s70 offen offset:2048 sc1 lds
    buffer_load_dwordx4 v32, s[28:31], s70 offen offset:3072 sc1 lds
    s_add_u32 m0, m0, 4096
    s_nop 0
    buffer_load_dwordx4 v33, s[28:31], s70 offen sc1 lds
    s_add_u32 m0, s76, 69632
    s_bfe_u32 s70, s93, 0x40000
    s_mul_i32 s70, s70, 524288
    buffer_load_dwordx4 v78, s[24:27], s70 offen lds
    buffer_load_dwordx4 v79, s[24:27], s70 offen offset:1024 lds
    buffer_load_dwordx4 v80, s[24:27], s70 offen offset:2048 lds
    buffer_load_dwordx4 v81, s[24:27], s70 offen offset:3072 lds
    s_waitcnt vmcnt(13)
    s_barrier
    s_bfe_u32 s68, s92, 0x40018
L_UA6:
    s_lshr_b32 s66, s72, s68
    s_and_b32 s66, s66, 4097
    s_cmp_lg_u32 s66, 4097
    s_cbranch_scc1 L_UA6_again
L_UA6_ok:
    s_add_u32 m0, s77, 0
    s_bfe_u32 s70, s92, 0x40018
    s_mul_i32 s70, s70, 20480
    buffer_load_dwordx4 v32, s[28:31], s70 offen sc1 lds
    buffer_load_dwordx4 v32, s[28:31], s70 offen offset:1024 sc1 lds
    buffer_load_dwordx4 v32, s[28:31], s70 offen offset:2048 sc1 lds
    buffer_load_dwordx4 v32, s[28:31], s70 offen offset:3072 sc1 lds
    s_add_u32 m0, m0, 4096
    s_nop 0
    buffer_load_dwordx4 v33, s[28:31], s70 offen sc1 lds
    s_add_u32 m0, s76, 86016
    s_bfe_u32 s70, s93, 0x40004
    s_mul_i32 s70, s70, 524288
    buffer_load_dwordx4 v78, s[24:27], s70 offen lds
    buffer_load_dwordx4 v79, s[24:27], s70 offen offset:1024 lds
    buffer_load_dwordx4 v80, s[24:27], s70 offen offset:2048 lds
    buffer_load_dwordx4 v81, s[24:27], s70 offen offset:3072 lds
    s_waitcnt vmcnt(13)
    s_barrier
    s_bfe_u32 s68, s92, 0x4001c
L_UA7:
    s_lshr_b32 s66, s72, s68
    s_and_b32 s66, s66, 4097
    s_cmp_lg_u32 s66, 4097
    s_cbranch_scc1 L_UA7_again
L_UA7_ok:
    s_add_u32 m0, s77, 122880
    s_bfe_u32 s70, s92, 0x4001c
    s_mul_i32 s70, s70, 20480
    buffer_load_dwordx4 v32, s[28:31], s70 offen sc1 lds
    buffer_load_dwordx4 v32, s[28:31], s70 offen offset:1024 sc1 lds
    buffer_load_dwordx4 v32, s[28:31], s70 offen offset:2048 sc1 lds
    buffer_load_dwordx4 v32, s[28:31], s70 offen offset:3072 sc1 lds
    s_add_u32 m0, m0, 4096
    s_nop 0
    buffer_load_dwordx4 v33, s[28:31], s70 offen sc1 lds
    s_add_u32 m0, s76, 36864
    s_bfe_u32 s70, s93, 0x40008
    s_mul_i32 s70, s70, 524288
    buffer_load_dwordx4 v78, s[24:27], s70 offen lds
    buffer_load_dwordx4 v79, s[24:27], s70 offen offset:1024 lds
    buffer_load_dwordx4 v80, s[24:27], s70 offen offset:2048 lds
    buffer_load_dwordx4 v81, s[24:27], s70 offen offset:3072 lds
    s_waitcnt vmcnt(13)
    s_barrier
    s_bfe_u32 s68, s93, 0x40000
L_UA8:
    s_lshr_b32 s66, s72, s68
    s_and_b32 s66, s66, 4097
    s_cmp_lg_u32 s66, 4097
    s_cbranch_scc1 L_UA8_again
L_UA8_ok:
    s_add_u32 m0, s77, 102400
    s_bfe_u32 s70, s93, 0x40000
    s_mul_i32 s70, s70, 20480
    buffer_load_dwordx4 v32, s[28:31], s70 offen sc1 lds
    buffer_load_dwordx4 v32, s[28:31], s70 offen offset:1024 sc1 lds
    buffer_load_dwordx4 v32, s[28:31], s70 offen offset:2048 sc1 lds
    buffer_load_dwordx4 v32, s[28:31], s70 offen offset:3072 sc1 lds
    s_add_u32 m0, m0, 4096
    s_nop 0
    buffer_load_dwordx4 v33, s[28:31], s70 offen sc1 lds
    s_add_u32 m0, s76, 53248
    s_bfe_u32 s70, s93, 0x4000c
    s_mul_i32 s70, s70, 524288
    buffer_load_dwordx4 v78, s[24:27], s70 offen lds
    buffer_load_dwordx4 v79, s[24:27], s70 offen offset:1024 lds
    buffer_load_dwordx4 v80, s[24:27], s70 offen offset:2048 lds
    buffer_load_dwordx4 v81, s[24:27], s70 offen offset:3072 lds
    s_waitcnt vmcnt(13)
    s_barrier
    s_bfe_u32 s68, s93, 0x40004
L_UA9:
    s_lshr_b32 s66, s72, s68
    s_and_b32 s66, s66, 4097
    s_cmp_lg_u32 s66, 4097
    s_cbranch_scc1 L_UA9_again
L_UA9_ok:
    s_add_u32 m0, s77, 0
    s_bfe_u32 s70, s93, 0x40004
    s_mul_i32 s70, s70, 20480
    buffer_load_dwordx4 v32, s[28:31], s70 offen sc1 lds
    buffer_load_dwordx4 v32, s[28:31], s70 offen offset:1024 sc1 lds
    buffer_load_dwordx4 v32, s[28:31], s70 offen offset:2048 sc1 lds
    buffer_load_dwordx4 v32, s[28:31], s70 offen offset:3072 sc1 lds
    s_add_u32 m0, m0, 4096
    s_nop 0
    buffer_load_dwordx4 v33, s[28:31], s70 offen sc1 lds
    s_waitcnt vmcnt(9)
    s_barrier
    s_bfe_u32 s68, s93, 0x40008
L_UA10:
    s_lshr_b32 s66, s72, s68
    s_and_b32 s66, s66, 4097
    s_cmp_lg_u32 s66, 4097
    s_cbranch_scc1 L_UA10_again
L_UA10_ok:
    s_add_u32 m0, s77, 122880
    s_bfe_u32 s70, s93, 0x40008
    s_mul_i32 s70, s70, 20480
    buffer_load_dwordx4 v32, s[28:31], s70 offen sc1 lds
    buffer_load_dwordx4 v32, s[28:31], s70 offen offset:1024 sc1 lds
    buffer_load_dwordx4 v32, s[28:31], s70 offen offset:2048 sc1 lds
    buffer_load_dwordx4 v32, s[28:31], s70 offen offset:3072 sc1 lds
    s_add_u32 m0, m0, 4096
    s_nop 0
    buffer_load_dwordx4 v33, s[28:31], s70 offen sc1 lds
    s_waitcnt vmcnt(5)
    s_barrier
    s_bfe_u32 s68, s93, 0x4000c
L_UA11:
    s_lshr_b32 s66, s72, s68
    s_and_b32 s66, s66, 4097
    s_cmp_lg_u32 s66, 4097
    s_cbranch_scc1 L_UA11_again
L_UA11_ok:
    s_add_u32 m0, s77, 102400
    s_bfe_u32 s70, s93, 0x4000c
    s_mul_i32 s70, s70, 20480
    buffer_load_dwordx4 v32, s[28:31], s70 offen sc1 lds
    buffer_load_dwordx4 v32, s[28:31], s70 offen offset:1024 sc1 lds
    buffer_load_dwordx4 v32, s[28:31], s70 offen offset:2048 sc1 lds
    buffer_load_dwordx4 v32, s[28:31], s70 offen offset:3072 sc1 lds
    s_add_u32 m0, m0, 4096
    s_nop 0
    buffer_load_dwordx4 v33, s[28:31], s70 offen sc1 lds
    s_waitcnt vmcnt(5)
    s_barrier
    s_waitcnt vmcnt(0)
    s_barrier
    s_endpgm
L_poll_Ah_again:
    s_sub_u32 s67, s67, 1
    s_cbranch_scc1 L_poll_Ah_ok
    s_sleep 12
    buffer_load_dword v50, v48, s[28:31], 0 offen sc1
    buffer_load_dword v51, v48, s[28:31], s71 offen sc1
    s_waitcnt vmcnt(0)
    s_branch L_poll_Ah
L_poll_Ao_again:
    s_sub_u32 s67, s67, 1
    s_cbranch_scc1 L_poll_Ao_ok
    s_sleep 12
    buffer_load_dword v50, v48, s[28:31], 0 offen sc1
    s_waitcnt vmcnt(0)
    s_branch L_poll_Ao
L_UA0_again:
    s_sub_u32 s73, s73, 1
    s_cbranch_scc1 L_UA0_ok
    buffer_load_dword v50, v48, s[28:31], 0 offen sc1
    s_waitcnt vmcnt(0)
    v_cmp_eq_u32 vcc, v50, v29
    s_nop 1
    s_cmp_eq_u32 vcc_lo, s72
    s_mov_b32 s72, vcc_lo
    s_cbranch_scc0 L_UA0
    s_sleep 12
    s_branch L_UA0
L_UA1_again:
    s_sub_u32 s73, s73, 1
    s_cbranch_scc1 L_UA1_ok
    buffer_load_dword v50, v48, s[28:31], 0 offen sc1
    s_waitcnt vmcnt(0)
    v_cmp_eq_u32 vcc, v50, v29
    s_nop 1
    s_cmp_eq_u32 vcc_lo, s72
    s_mov_b32 s72, vcc_lo
    s_cbranch_scc0 L_UA1
    s_sleep 12
    s_branch L_UA1
L_UA2_again:
    s_sub_u32 s73, s73, 1
    s_cbranch_scc1 L_UA2_ok
    buffer_load_dword v50, v48, s[28:31], 0 offen sc1
    s_waitcnt vmcnt(0)
    v_cmp_eq_u32 vcc, v50, v29
    s_nop 1
    s_cmp_eq_u32 vcc_lo, s72
    s_mov_b32 s72, vcc_lo
    s_cbranch_scc0 L_UA2
    s_sleep 12
    s_branch L_UA2
L_UA3_again:
    s_sub_u32 s73, s73, 1
    s_cbranch_scc1 L_UA3_ok
    buffer_load_dword v50, v48, s[28:31], 0 offen sc1
    s_waitcnt vmcnt(0)
    v_cmp_eq_u32 vcc, v50, v29
    s_nop 1
    s_cmp_eq_u32 vcc_lo, s72
    s_mov_b32 s72, vcc_lo
    s_cbranch_scc0 L_UA3
    s_sleep 12
    s_branch L_UA3
L_UA4_again:
    s_sub_u32 s73, s73, 1
    s_cbranch_scc1 L_UA4_ok
    buffer_load_dword v50, v48, s[28:31], 0 offen sc1
    s_waitcnt vmcnt(0)
    v_cmp_eq_u32 vcc, v50, v29
    s_nop 1
    s_cmp_eq_u32 vcc_lo, s72
    s_mov_b32 s72, vcc_lo
    s_cbranch_scc0 L_UA4
    s_sleep 12
    s_branch L_UA4
L_UA5_again:
    s_sub_u32 s73, s73, 1
    s_cbranch_scc1 L_UA5_ok
    buffer_load_dword v50, v48, s[28:31], 0 offen sc1
    s_waitcnt vmcnt(0)
    v_cmp_eq_u32 vcc, v50, v29
    s_nop 1
    s_cmp_eq_u32 vcc_lo, s72
    s_mov_b32 s72, vcc_lo
    s_cbranch_scc0 L_UA5
    s_sleep 12
    s_branch L_UA5
L_UA6_again:
    s_sub_u32 s73, s73, 1
    s_cbranch_scc1 L_UA6_ok
    buffer_load_dword v50, v48, s[28:31], 0 offen sc1
    s_waitcnt vmcnt(0)
    v_cmp_eq_u32 vcc, v50, v29
    s_nop 1
    s_cmp_eq_u32 vcc_lo, s72
    s_mov_b32 s72, vcc_lo
    s_cbranch_scc0 L_UA6
    s_sleep 12
    s_branch L_UA6
L_UA7_again:
    s_sub_u32 s73, s73, 1
    s_cbranch_scc1 L_UA7_ok
    buffer_load_dword v50, v48, s[28:31], 0 offen sc1
    s_waitcnt vmcnt(0)
    v_cmp_eq_u32 vcc, v50, v29
    s_nop 1
    s_cmp_eq_u32 vcc_lo, s72
    s_mov_b32 s72, vcc_lo
    s_cbranch_scc0 L_UA7
    s_sleep 12
    s_branch L_UA7
L_UA8_again:
    s_sub_u32 s73, s73, 1
    s_cbranch_scc1 L_UA8_ok
    buffer_load_dword v50, v48, s[28:31], 0 offen sc1
    s_waitcnt vmcnt(0)
    v_cmp_eq_u32 vcc, v50, v29
    s_nop 1
    s_cmp_eq_u32 vcc_lo, s72
    s_mov_b32 s72, vcc_lo
    s_cbranch_scc0 L_UA8
    s_sleep 12
    s_branch L_UA8
L_UA9_again:
    s_sub_u32 s73, s73, 1
    s_cbranch_scc1 L_UA9_ok
    buffer_load_dword v50, v48, s[28:31], 0 offen sc1
    s_waitcnt vmcnt(0)
    v_cmp_eq_u32 vcc, v50, v29
    s_nop 1
    s_cmp_eq_u32 vcc_lo, s72
    s_mov_b32 s72, vcc_lo
    s_cbranch_scc0 L_UA9
    s_sleep 12
    s_branch L_UA9
L_UA10_again:
    s_sub_u32 s73, s73, 1
    s_cbranch_scc1 L_UA10_ok
    buffer_load_dword v50, v48, s[28:31], 0 offen sc1
    s_waitcnt vmcnt(0)
    v_cmp_eq_u32 vcc, v50, v29
    s_nop 1
    s_cmp_eq_u32 vcc_lo, s72
    s_mov_b32 s72, vcc_lo
    s_cbranch_scc0 L_UA10
    s_sleep 12
    s_branch L_UA10
L_UA11_again:
    s_sub_u32 s73, s73, 1
    s_cbranch_scc1 L_UA11_ok
    buffer_load_dword v50, v48, s[28:31], 0 offen sc1
    s_waitcnt vmcnt(0)
    v_cmp_eq_u32 vcc, v50, v29
    s_nop 1
    s_cmp_eq_u32 vcc_lo, s72
    s_mov_b32 s72, vcc_lo
    s_cbranch_scc0 L_UA11
    s_sleep 12
    s_branch L_UA11
L_epoch:
    s_mov_b32 s66, 8077312
    v_lshl_add_u32 v48, v0, 7, s66
    s_movk_i32 s71, 8192
    buffer_load_dword v50, v48, s[28:31], 0 offen sc1
    buffer_load_dword v51, v48, s[28:31], s71 offen sc1
    s_waitcnt vmcnt(0)
    s_mov_b32 s67, 0x40000
L_poll_Ae:
    v_xor_b32 v50, v50, v29
    v_xor_b32 v51, v51, v29
    v_or_b32 v50, v50, v51
    v_cmp_eq_u32 vcc, 0, v50
    s_nop 1
    s_cmp_lg_u64 vcc, -1
    s_cbranch_scc1 L_poll_Ae_again
L_poll_Ae_ok:
    v_add_u32 v21, 1, v21
    s_mov_b32 s66, 8126464
    s_mov_b64 exec, 1
    buffer_store_dword v21, v28, s[28:31], s66 offen sc1
    s_mov_b64 exec, -1
    s_waitcnt vmcnt(0)
    s_branch L_epoch_done
L_poll_Ae_again:
    s_sub_u32 s67, s67, 1
    s_cbranch_scc1 L_poll_Ae_ok
    s_sleep 12
    buffer_load_dword v50, v48, s[28:31], 0 offen sc1
    buffer_load_dword v51, v48, s[28:31], s71 offen sc1
    s_waitcnt vmcnt(0)
    s_branch L_poll_Ae
L_computeA:
    s_setprio 2
    s_mov_b32 s79, 0
    s_mov_b32 s30, 12582912
    s_mov_b32 s31, 0x20000
    s_mov_b32 s3, 0xffff0000
    v_mov_b32 v28, 0
    s_mov_b32 s66, 8126464
    s_waitcnt lgkmcnt(0)
    buffer_load_dword v21, v28, s[28:31], s66 offen sc1
    v_and_b32 v1, 15, v0
    v_lshrrev_b32 v2, 4, v0
    v_lshrrev_b32 v246, 2, v1
    v_and_b32 v247, 1, v2
    v_lshl_add_u32 v246, v247, 2, v246
    v_lshrrev_b32 v247, 1, v2
    v_lshl_add_u32 v247, v247, 4, v246
    v_and_b32 v248, 3, v1
    v_lshlrev_b32 v248, 3, v248
    v_lshrrev_b32 v249, 1, v1
    v_xor_b32 v249, v249, v2
    v_lshlrev_b32 v249, 4, v249
    v_lshl_add_u32 v3, v1, 7, v249
    v_xor_b32 v4, 64, v3
    v_mul_u32_u24 v249, 1056, v246
    v_lshrrev_b32 v5, 5, v0
    v_lshl_add_u32 v249, v5, 9, v249
    s_lshl_b32 s66, s52, 6
    v_add3_u32 v5, v249, v248, s66
    v_mov_b32 v14, 163832
    ds_write_b32 v14, v28
    s_waitcnt vmcnt(0) lgkmcnt(0)
    s_mov_b32 s66, 0x9e3779b1
    v_mul_lo_u32 v29, v21, s66
    v_add_u32 v29, 0x7f4a7c15, v29
    v_add_u32 v14, 0, v3
    v_add_u32 v15, 0, v4
    v_add_u32 v16, 34816, v5
    s_barrier
    ds_read_b64_tr_b16 v[168:169], v16 offset:0
    ds_read_b64_tr_b16 v[170:171], v16 offset:256
    ds_read_b64_tr_b16 v[172:173], v16 offset:32
    ds_read_b64_tr_b16 v[174:175], v16 offset:288
    ds_read_b128 v[184:187], v14 offset:0
    ds_read_b128 v[188:191], v14 offset:2048
    ds_read_b128 v[192:195], v14 offset:4096
    ds_read_b128 v[196:199], v14 offset:6144
    ds_read_b128 v[200:203], v14 offset:8192
    s_lshl4_add_u32 s66, s53, s54
    s_lshl_b32 s66, s66, 7
    s_add_u32 s66, s66, 8077312
    s_cmp_eq_u32 s52, 0
    s_cselect_b32 s66, s66, 12582912
    s_mov_b32 exec_lo, -1
    s_mov_b32 exec_hi, 0
    v_lshlrev_b32 v9, 2, v0
    buffer_store_dword v29, v9, s[28:31], s66 offen sc1
    s_mov_b64 exec, -1
    s_waitcnt lgkmcnt(4)
    v_mfma_f32_16x16x32_bf16 v[32:35], v[168:171], v[184:187], 0
    ds_read_b128 v[204:207], v14 offset:10240
    ds_read_b128 v[208:211], v14 offset:12288
    v_mfma_f32_16x16x32_bf16 v[100:103], v[172:175], v[184:187], 0
    s_waitcnt lgkmcnt(5)
    v_mfma_f32_16x16x32_bf16 v[36:39], v[168:171], v[188:191], 0
    ds_read_b128 v[212:215], v14 offset:14336
    v_mfma_f32_16x16x32_bf16 v[104:107], v[172:175], v[188:191], 0
    s_waitcnt lgkmcnt(5)
    v_mfma_f32_16x16x32_bf16 v[40:43], v[168:171], v[192:195], 0
    ds_read_b128 v[184:187], v14 offset:16384
    v_mfma_f32_16x16x32_bf16 v[108:111], v[172:175], v[192:195], 0
    ds_read_b128 v[188:191], v14 offset:18432
    s_waitcnt lgkmcnt(6)
    v_mfma_f32_16x16x32_bf16 v[44:47], v[168:171], v[196:199], 0
    v_mfma_f32_16x16x32_bf16 v[112:115], v[172:175], v[196:199], 0
    ds_read_b128 v[192:195], v14 offset:20480
    s_waitcnt lgkmcnt(6)
    v_mfma_f32_16x16x32_bf16 v[48:51], v[168:171], v[200:203], 0
    v_mfma_f32_16x16x32_bf16 v[116:119], v[172:175], v[200:203], 0
    ds_read_b128 v[196:199], v14 offset:22528
    s_waitcnt lgkmcnt(6)
    v_mfma_f32_16x16x32_bf16 v[52:55], v[168:171], v[204:207], 0
    ds_read_b128 v[200:203], v14 offset:24576
    v_mfma_f32_16x16x32_bf16 v[120:123], v[172:175], v[204:207], 0
    s_waitcnt lgkmcnt(6)
    v_mfma_f32_16x16x32_bf16 v[56:59], v[168:171], v[208:211], 0
    ds_read_b128 v[204:207], v14 offset:26624
    v_mfma_f32_16x16x32_bf16 v[124:127], v[172:175], v[208:211], 0
    s_waitcnt lgkmcnt(6)
    v_mfma_f32_16x16x32_bf16 v[60:63], v[168:171], v[212:215], 0
    ds_read_b128 v[208:211], v14 offset:28672
    v_mfma_f32_16x16x32_bf16 v[128:131], v[172:175], v[212:215], 0
    s_waitcnt lgkmcnt(6)
    v_mfma_f32_16x16x32_bf16 v[64:67], v[168:171], v[184:187], 0
    ds_read_b128 v[212:215], v14 offset:30720
    v_mfma_f32_16x16x32_bf16 v[132:135], v[172:175], v[184:187], 0
    ds_read_b128 v[184:187], v14 offset:32768
    s_waitcnt lgkmcnt(7)
    v_mfma_f32_16x16x32_bf16 v[68:71], v[168:171], v[188:191], 0
    v_mfma_f32_16x16x32_bf16 v[136:139], v[172:175], v[188:191], 0
    ds_read_b64_tr_b16 v[176:177], v16 offset:8448
    s_waitcnt lgkmcnt(7)
    v_mfma_f32_16x16x32_bf16 v[72:75], v[168:171], v[192:195], 0
    ds_read_b64_tr_b16 v[178:179], v16 offset:8704
    v_mfma_f32_16x16x32_bf16 v[140:143], v[172:175], v[192:195], 0
    ds_read_b64_tr_b16 v[180:181], v16 offset:8480
    s_waitcnt lgkmcnt(8)
    v_mfma_f32_16x16x32_bf16 v[76:79], v[168:171], v[196:199], 0
    ds_read_b64_tr_b16 v[182:183], v16 offset:8736
    ds_read_b128 v[188:191], v15 offset:0
    v_mfma_f32_16x16x32_bf16 v[144:147], v[172:175], v[196:199], 0
    s_waitcnt lgkmcnt(9)
    v_mfma_f32_16x16x32_bf16 v[80:83], v[168:171], v[200:203], 0
    ds_read_b128 v[192:195], v15 offset:2048
    v_mfma_f32_16x16x32_bf16 v[148:151], v[172:175], v[200:203], 0
    s_waitcnt lgkmcnt(9)
    v_mfma_f32_16x16x32_bf16 v[84:87], v[168:171], v[204:207], 0
    ds_read_b128 v[196:199], v15 offset:4096
    v_mfma_f32_16x16x32_bf16 v[152:155], v[172:175], v[204:207], 0
    s_waitcnt lgkmcnt(9)
    v_mfma_f32_16x16x32_bf16 v[88:91], v[168:171], v[208:211], 0
    ds_read_b128 v[200:203], v15 offset:6144
    v_mfma_f32_16x16x32_bf16 v[156:159], v[172:175], v[208:211], 0
    ds_read_b128 v[204:207], v15 offset:8192
    s_waitcnt lgkmcnt(10)
    v_mfma_f32_16x16x32_bf16 v[92:95], v[168:171], v[212:215], 0
    v_mfma_f32_16x16x32_bf16 v[160:163], v[172:175], v[212:215], 0
    ds_read_b128 v[208:211], v15 offset:10240
    s_waitcnt lgkmcnt(10)
    v_mfma_f32_16x16x32_bf16 v[96:99], v[168:171], v[184:187], 0
    v_mfma_f32_16x16x32_bf16 v[164:167], v[172:175], v[184:187], 0
    ds_read_b128 v[212:215], v15 offset:12288
    s_waitcnt lgkmcnt(6)
    v_mfma_f32_16x16x32_bf16 v[32:35], v[176:179], v[188:191], v[32:35]
    ds_read_b128 v[184:187], v15 offset:14336
    v_mfma_f32_16x16x32_bf16 v[100:103], v[180:183], v[188:191], v[100:103]
    s_waitcnt lgkmcnt(6)
    v_mfma_f32_16x16x32_bf16 v[36:39], v[176:179], v[192:195], v[36:39]
    ds_read_b128 v[188:191], v15 offset:16384
    v_mfma_f32_16x16x32_bf16 v[104:107], v[180:183], v[192:195], v[104:107]
    s_waitcnt lgkmcnt(6)
    v_mfma_f32_16x16x32_bf16 v[40:43], v[176:179], v[196:199], v[40:43]
    ds_read_b128 v[192:195], v15 offset:18432
    v_mfma_f32_16x16x32_bf16 v[108:111], v[180:183], v[196:199], v[108:111]
    s_waitcnt lgkmcnt(6)
    v_mfma_f32_16x16x32_bf16 v[44:47], v[176:179], v[200:203], v[44:47]
    ds_read_b128 v[196:199], v15 offset:20480
    v_mfma_f32_16x16x32_bf16 v[112:115], v[180:183], v[200:203], v[112:115]
    ds_read_b128 v[200:203], v15 offset:22528
    s_waitcnt lgkmcnt(7)
    v_mfma_f32_16x16x32_bf16 v[48:51], v[176:179], v[204:207], v[48:51]
    v_mfma_f32_16x16x32_bf16 v[116:119], v[180:183], v[204:207], v[116:119]
    ds_read_b128 v[204:207], v15 offset:24576
    s_waitcnt lgkmcnt(7)
    v_mfma_f32_16x16x32_bf16 v[52:55], v[176:179], v[208:211], v[52:55]
    v_mfma_f32_16x16x32_bf16 v[120:123], v[180:183], v[208:211], v[120:123]
    ds_read_b128 v[208:211], v15 offset:26624
    s_waitcnt lgkmcnt(7)
    v_mfma_f32_16x16x32_bf16 v[56:59], v[176:179], v[212:215], v[56:59]
    v_mfma_f32_16x16x32_bf16 v[124:127], v[180:183], v[212:215], v[124:127]
    ds_read_b128 v[212:215], v15 offset:28672
    s_waitcnt lgkmcnt(7)
    v_mfma_f32_16x16x32_bf16 v[60:63], v[176:179], v[184:187], v[60:63]
    v_mfma_f32_16x16x32_bf16 v[128:131], v[180:183], v[184:187], v[128:131]
    ds_read_b128 v[184:187], v15 offset:30720
    s_waitcnt lgkmcnt(7)
    v_mfma_f32_16x16x32_bf16 v[64:67], v[176:179], v[188:191], v[64:67]
    v_mfma_f32_16x16x32_bf16 v[132:135], v[180:183], v[188:191], v[132:135]
    ds_read_b128 v[188:191], v15 offset:32768
    s_waitcnt lgkmcnt(7)
    v_mfma_f32_16x16x32_bf16 v[68:71], v[176:179], v[192:195], v[68:71]
    v_mfma_f32_16x16x32_bf16 v[136:139], v[180:183], v[192:195], v[136:139]
    s_waitcnt lgkmcnt(6)
    v_mfma_f32_16x16x32_bf16 v[72:75], v[176:179], v[196:199], v[72:75]
    v_mfma_f32_16x16x32_bf16 v[140:143], v[180:183], v[196:199], v[140:143]
    s_waitcnt lgkmcnt(5)
    v_mfma_f32_16x16x32_bf16 v[76:79], v[176:179], v[200:203], v[76:79]
    v_mfma_f32_16x16x32_bf16 v[144:147], v[180:183], v[200:203], v[144:147]
    s_waitcnt lgkmcnt(0)
    v_add_u32 v14, 51712, v3
    v_add_u32 v15, 51712, v4
    v_add_u32 v16, 86528, v5
    s_barrier
    ds_read_b64_tr_b16 v[168:169], v16 offset:0
    ds_read_b64_tr_b16 v[170:171], v16 offset:256
    v_mfma_f32_16x16x32_bf16 v[80:83], v[176:179], v[204:207], v[80:83]
    ds_read_b64_tr_b16 v[172:173], v16 offset:32
    s_and_b32 s66, s53, 6
    v_mfma_f32_16x16x32_bf16 v[148:151], v[180:183], v[204:207], v[148:151]
    ds_read_b64_tr_b16 v[174:175], v16 offset:288
    s_lshr_b32 s68, s54, 3
    v_mfma_f32_16x16x32_bf16 v[84:87], v[176:179], v[208:211], v[84:87]
    ds_read_b128 v[192:195], v14 offset:0
    s_add_u32 s55, s66, s68
    v_mfma_f32_16x16x32_bf16 v[152:155], v[180:183], v[208:211], v[152:155]
    ds_read_b128 v[196:199], v14 offset:2048
    s_and_b32 s67, s53, 1
    v_mfma_f32_16x16x32_bf16 v[88:91], v[176:179], v[212:215], v[88:91]
    s_and_b32 s68, s54, 7
    v_mfma_f32_16x16x32_bf16 v[156:159], v[180:183], v[212:215], v[156:159]
    ds_read_b128 v[200:203], v14 offset:4096
    s_lshl3_add_u32 s56, s67, s68
    v_mfma_f32_16x16x32_bf16 v[92:95], v[176:179], v[184:187], v[92:95]
    s_lshl_b32 s66, s55, 4
    v_mfma_f32_16x16x32_bf16 v[160:163], v[180:183], v[184:187], v[160:163]
    ds_read_b128 v[204:207], v14 offset:6144
    s_add_u32 s66, s66, s56
    v_mfma_f32_16x16x32_bf16 v[96:99], v[176:179], v[188:191], v[96:99]
    ds_read_b128 v[208:211], v14 offset:8192
    s_lshl_b32 s66, s66, 7
    v_mfma_f32_16x16x32_bf16 v[164:167], v[180:183], v[188:191], v[164:167]
    s_add_u32 s64, s66, 7929856
    s_waitcnt lgkmcnt(4)
    v_mfma_f32_16x16x32_bf16 v[32:35], v[168:171], v[192:195], v[32:35]
    ds_read_b128 v[212:215], v14 offset:10240
    s_mov_b32 s46, 4096
    v_mfma_f32_16x16x32_bf16 v[100:103], v[172:175], v[192:195], v[100:103]
    s_mov_b32 s47, 0x20000
    s_waitcnt lgkmcnt(4)
    v_mfma_f32_16x16x32_bf16 v[36:39], v[168:171], v[196:199], v[36:39]
    ds_read_b128 v[184:187], v14 offset:12288
    s_mov_b32 s38, 2621440
    v_mfma_f32_16x16x32_bf16 v[104:107], v[172:175], v[196:199], v[104:107]
    ds_read_b128 v[188:191], v14 offset:14336
    s_mov_b32 s39, 0x20000
    s_waitcnt lgkmcnt(5)
    v_mfma_f32_16x16x32_bf16 v[40:43], v[168:171], v[200:203], v[40:43]
    s_lshr_b32 s66, s53, 1
    v_mfma_f32_16x16x32_bf16 v[108:111], v[172:175], v[200:203], v[108:111]
    ds_read_b128 v[192:195], v14 offset:16384
    s_and_b32 s67, s53, 1
    s_waitcnt lgkmcnt(5)
    v_mfma_f32_16x16x32_bf16 v[44:47], v[168:171], v[204:207], v[44:47]
    s_lshr_b32 s68, s54, 2
    v_mfma_f32_16x16x32_bf16 v[112:115], v[172:175], v[204:207], v[112:115]
    ds_read_b128 v[196:199], v14 offset:18432
    s_lshl3_add_u32 s60, s66, s68
    s_waitcnt lgkmcnt(5)
    v_mfma_f32_16x16x32_bf16 v[48:51], v[168:171], v[208:211], v[48:51]
    ds_read_b128 v[200:203], v14 offset:20480
    s_and_b32 s68, s54, 3
    v_mfma_f32_16x16x32_bf16 v[116:119], v[172:175], v[208:211], v[116:119]
    s_lshl2_add_u32 s61, s67, s68
    s_waitcnt lgkmcnt(5)
    v_mfma_f32_16x16x32_bf16 v[52:55], v[168:171], v[212:215], v[52:55]
    ds_read_b128 v[204:207], v14 offset:22528
    v_lshrrev_b32 v246, 1, v246
    v_mfma_f32_16x16x32_bf16 v[120:123], v[172:175], v[212:215], v[120:123]
    v_mul_u32_u24 v249, 160, v247
    s_waitcnt lgkmcnt(5)
    v_mfma_f32_16x16x32_bf16 v[56:59], v[168:171], v[184:187], v[56:59]
    ds_read_b128 v[208:211], v14 offset:24576
    v_add_u32 v12, v249, v248
    v_mfma_f32_16x16x32_bf16 v[124:127], v[172:175], v[184:187], v[124:127]
    ds_read_b128 v[212:215], v14 offset:26624
    v_xor_b32 v249, s52, v246
    s_waitcnt lgkmcnt(6)
    v_mfma_f32_16x16x32_bf16 v[60:63], v[168:171], v[188:191], v[60:63]
    v_lshl_add_u32 v249, v249, 5, v248
    v_mfma_f32_16x16x32_bf16 v[128:131], v[172:175], v[188:191], v[128:131]
    ds_read_b128 v[184:187], v14 offset:28672
    v_lshrrev_b32 v247, 2, v0
    s_waitcnt lgkmcnt(6)
    v_mfma_f32_16x16x32_bf16 v[64:67], v[168:171], v[192:195], v[64:67]
    v_lshl_add_u32 v10, v247, 7, v249
    v_mfma_f32_16x16x32_bf16 v[132:135], v[172:175], v[192:195], v[132:135]
    ds_read_b128 v[188:191], v14 offset:30720
    v_lshlrev_b32 v11, 4, v0
    s_waitcnt lgkmcnt(6)
    v_mfma_f32_16x16x32_bf16 v[68:71], v[168:171], v[196:199], v[68:71]
    ds_read_b128 v[192:195], v14 offset:32768
    s_lshl_b32 s66, s52, 10
    v_mfma_f32_16x16x32_bf16 v[136:139], v[172:175], v[196:199], v[136:139]
    s_add_u32 s66, s66, 20480
    s_waitcnt lgkmcnt(6)
    v_mfma_f32_16x16x32_bf16 v[72:75], v[168:171], v[200:203], v[72:75]
    ds_read_b64_tr_b16 v[176:177], v16 offset:8448
    v_add_u32 v13, s66, v11
    v_mfma_f32_16x16x32_bf16 v[140:143], v[172:175], v[200:203], v[140:143]
    ds_read_b64_tr_b16 v[178:179], v16 offset:8704
    s_lshl_b32 s66, s60, 2
    s_waitcnt lgkmcnt(7)
    v_mfma_f32_16x16x32_bf16 v[76:79], v[168:171], v[204:207], v[76:79]
    ds_read_b64_tr_b16 v[180:181], v16 offset:8480
    ds_read_b64_tr_b16 v[182:183], v16 offset:8736
    s_add_u32 s66, s66, s52
    v_mfma_f32_16x16x32_bf16 v[144:147], v[172:175], v[204:207], v[144:147]
    ds_read_b128 v[196:199], v15 offset:0
    s_lshl_b32 s66, s66, 4
    s_waitcnt lgkmcnt(9)
    v_mfma_f32_16x16x32_bf16 v[80:83], v[168:171], v[208:211], v[80:83]
    v_mfma_f32_16x16x32_bf16 v[148:151], v[172:175], v[208:211], v[148:151]
    ds_read_b128 v[200:203], v15 offset:2048
    s_waitcnt lgkmcnt(9)
    v_mfma_f32_16x16x32_bf16 v[84:87], v[168:171], v[212:215], v[84:87]
    v_mfma_f32_16x16x32_bf16 v[152:155], v[172:175], v[212:215], v[152:155]
    ds_read_b128 v[204:207], v15 offset:4096
    s_waitcnt lgkmcnt(9)
    v_mfma_f32_16x16x32_bf16 v[88:91], v[168:171], v[184:187], v[88:91]
    ds_read_b128 v[208:211], v15 offset:6144
    v_mfma_f32_16x16x32_bf16 v[156:159], v[172:175], v[184:187], v[156:159]
    s_waitcnt lgkmcnt(9)
    v_mfma_f32_16x16x32_bf16 v[92:95], v[168:171], v[188:191], v[92:95]
    ds_read_b128 v[212:215], v15 offset:8192
    v_mfma_f32_16x16x32_bf16 v[160:163], v[172:175], v[188:191], v[160:163]
    s_waitcnt lgkmcnt(9)
    v_mfma_f32_16x16x32_bf16 v[96:99], v[168:171], v[192:195], v[96:99]
    ds_read_b128 v[184:187], v15 offset:10240
    v_mfma_f32_16x16x32_bf16 v[164:167], v[172:175], v[192:195], v[164:167]
    ds_read_b128 v[188:191], v15 offset:12288
    s_waitcnt lgkmcnt(6)
    v_mfma_f32_16x16x32_bf16 v[32:35], v[176:179], v[196:199], v[32:35]
    v_mfma_f32_16x16x32_bf16 v[100:103], v[180:183], v[196:199], v[100:103]
    ds_read_b128 v[192:195], v15 offset:14336
    s_waitcnt lgkmcnt(6)
    v_mfma_f32_16x16x32_bf16 v[36:39], v[176:179], v[200:203], v[36:39]
    v_mfma_f32_16x16x32_bf16 v[104:107], v[180:183], v[200:203], v[104:107]
    ds_read_b128 v[196:199], v15 offset:16384
    s_waitcnt lgkmcnt(6)
    v_mfma_f32_16x16x32_bf16 v[40:43], v[176:179], v[204:207], v[40:43]
    ds_read_b128 v[200:203], v15 offset:18432
    v_mfma_f32_16x16x32_bf16 v[108:111], v[180:183], v[204:207], v[108:111]
    s_waitcnt lgkmcnt(6)
    v_mfma_f32_16x16x32_bf16 v[44:47], v[176:179], v[208:211], v[44:47]
    ds_read_b128 v[204:207], v15 offset:20480
    v_mfma_f32_16x16x32_bf16 v[112:115], v[180:183], v[208:211], v[112:115]
    s_waitcnt lgkmcnt(6)
    v_mfma_f32_16x16x32_bf16 v[48:51], v[176:179], v[212:215], v[48:51]
    ds_read_b128 v[208:211], v15 offset:22528
    v_mfma_f32_16x16x32_bf16 v[116:119], v[180:183], v[212:215], v[116:119]
    ds_read_b128 v[212:215], v15 offset:24576
    s_waitcnt lgkmcnt(7)
    v_mfma_f32_16x16x32_bf16 v[52:55], v[176:179], v[184:187], v[52:55]
    v_mfma_f32_16x16x32_bf16 v[120:123], v[180:183], v[184:187], v[120:123]
    ds_read_b128 v[184:187], v15 offset:26624
    s_waitcnt lgkmcnt(7)
    v_mfma_f32_16x16x32_bf16 v[56:59], v[176:179], v[188:191], v[56:59]
    v_mfma_f32_16x16x32_bf16 v[124:127], v[180:183], v[188:191], v[124:127]
    ds_read_b128 v[188:191], v15 offset:28672
    s_waitcnt lgkmcnt(7)
    v_mfma_f32_16x16x32_bf16 v[60:63], v[176:179], v[192:195], v[60:63]
    v_mfma_f32_16x16x32_bf16 v[128:131], v[180:183], v[192:195], v[128:131]
    ds_read_b128 v[192:195], v15 offset:30720
    s_waitcnt lgkmcnt(7)
    v_mfma_f32_16x16x32_bf16 v[64:67], v[176:179], v[196:199], v[64:67]
    v_mfma_f32_16x16x32_bf16 v[132:135], v[180:183], v[196:199], v[132:135]
    ds_read_b128 v[196:199], v15 offset:32768
    s_waitcnt lgkmcnt(7)
    v_mfma_f32_16x16x32_bf16 v[68:71], v[176:179], v[200:203], v[68:71]
    v_mfma_f32_16x16x32_bf16 v[136:139], v[180:183], v[200:203], v[136:139]
    s_waitcnt lgkmcnt(6)
    v_mfma_f32_16x16x32_bf16 v[72:75], v[176:179], v[204:207], v[72:75]
    v_mfma_f32_16x16x32_bf16 v[140:143], v[180:183], v[204:207], v[140:143]
    s_waitcnt lgkmcnt(5)
    v_mfma_f32_16x16x32_bf16 v[76:79], v[176:179], v[208:211], v[76:79]
    v_mfma_f32_16x16x32_bf16 v[144:147], v[180:183], v[208:211], v[144:147]
    s_waitcnt lgkmcnt(0)
    v_add_u32 v14, 103424, v3
    v_add_u32 v15, 103424, v4
    v_add_u32 v16, 138240, v5
    s_barrier
    ds_read_b64_tr_b16 v[168:169], v16 offset:0
    ds_read_b64_tr_b16 v[170:171], v16 offset:256
    v_mfma_f32_16x16x32_bf16 v[80:83], v[176:179], v[212:215], v[80:83]
    ds_read_b64_tr_b16 v[172:173], v16 offset:32
    v_add_u32 v20, s66, v1
    v_mfma_f32_16x16x32_bf16 v[148:151], v[180:183], v[212:215], v[148:151]
    ds_read_b64_tr_b16 v[174:175], v16 offset:288
    s_lshl_b32 s66, s52, 5
    v_mfma_f32_16x16x32_bf16 v[84:87], v[176:179], v[184:187], v[84:87]
    ds_read_b128 v[200:203], v14 offset:0
    v_add_u32 v244, s66, v1
    v_mfma_f32_16x16x32_bf16 v[152:155], v[180:183], v[184:187], v[152:155]
    ds_read_b128 v[204:207], v14 offset:2048
    v_lshrrev_b32 v245, 2, v0
    v_mfma_f32_16x16x32_bf16 v[88:91], v[176:179], v[188:191], v[88:91]
    v_add_u32 v245, s66, v245
    v_mfma_f32_16x16x32_bf16 v[156:159], v[180:183], v[188:191], v[156:159]
    ds_read_b128 v[208:211], v14 offset:4096
    v_mul_u32_u24 v244, 336, v244
    v_mfma_f32_16x16x32_bf16 v[92:95], v[176:179], v[192:195], v[92:95]
    v_lshl_add_u32 v244, v2, 4, v244
    v_mfma_f32_16x16x32_bf16 v[160:163], v[180:183], v[192:195], v[160:163]
    ds_read_b128 v[212:215], v14 offset:6144
    v_add_u32 v234, 51712, v244
    v_mfma_f32_16x16x32_bf16 v[96:99], v[176:179], v[196:199], v[96:99]
    ds_read_b128 v[184:187], v14 offset:8192
    v_mul_u32_u24 v245, 336, v245
    v_mfma_f32_16x16x32_bf16 v[164:167], v[180:183], v[196:199], v[164:167]
    v_and_b32 v244, 3, v0
    s_waitcnt lgkmcnt(4)
    v_mfma_f32_16x16x32_bf16 v[32:35], v[168:171], v[200:203], v[32:35]
    ds_read_b128 v[188:191], v14 offset:10240
    v_lshl_add_u32 v245, v244, 3, v245
    v_mfma_f32_16x16x32_bf16 v[100:103], v[172:175], v[200:203], v[100:103]
    v_add_u32 v237, 51792, v245
    s_waitcnt lgkmcnt(4)
    v_mfma_f32_16x16x32_bf16 v[36:39], v[168:171], v[204:207], v[36:39]
    ds_read_b128 v[192:195], v14 offset:12288
    s_add_u32 s66, s66, 16
    v_mfma_f32_16x16x32_bf16 v[104:107], v[172:175], v[204:207], v[104:107]
    ds_read_b128 v[196:199], v14 offset:14336
    v_add_u32 v244, s66, v1
    s_waitcnt lgkmcnt(5)
    v_mfma_f32_16x16x32_bf16 v[40:43], v[168:171], v[208:211], v[40:43]
    v_lshrrev_b32 v245, 2, v0
    v_mfma_f32_16x16x32_bf16 v[108:111], v[172:175], v[208:211], v[108:111]
    ds_read_b128 v[200:203], v14 offset:16384
    v_add_u32 v245, s66, v245
    s_waitcnt lgkmcnt(5)
    v_mfma_f32_16x16x32_bf16 v[44:47], v[168:171], v[212:215], v[44:47]
    v_mul_u32_u24 v244, 336, v244
    v_mfma_f32_16x16x32_bf16 v[112:115], v[172:175], v[212:215], v[112:115]
    ds_read_b128 v[204:207], v14 offset:18432
    v_lshl_add_u32 v244, v2, 4, v244
    s_waitcnt lgkmcnt(5)
    v_mfma_f32_16x16x32_bf16 v[48:51], v[168:171], v[184:187], v[48:51]
    ds_read_b128 v[208:211], v14 offset:20480
    v_add_u32 v235, 51712, v244
    v_mfma_f32_16x16x32_bf16 v[116:119], v[172:175], v[184:187], v[116:119]
    v_mul_u32_u24 v245, 336, v245
    s_waitcnt lgkmcnt(5)
    v_mfma_f32_16x16x32_bf16 v[52:55], v[168:171], v[188:191], v[52:55]
    ds_read_b128 v[212:215], v14 offset:22528
    v_and_b32 v244, 3, v0
    v_mfma_f32_16x16x32_bf16 v[120:123], v[172:175], v[188:191], v[120:123]
    v_lshl_add_u32 v245, v244, 3, v245
    s_waitcnt lgkmcnt(5)
    v_mfma_f32_16x16x32_bf16 v[56:59], v[168:171], v[192:195], v[56:59]
    ds_read_b128 v[184:187], v14 offset:24576
    v_add_u32 v238, 51792, v245
    v_mfma_f32_16x16x32_bf16 v[124:127], v[172:175], v[192:195], v[124:127]
    ds_read_b128 v[188:191], v14 offset:26624
    s_add_u32 s66, s66, 16
    s_waitcnt lgkmcnt(6)
    v_mfma_f32_16x16x32_bf16 v[60:63], v[168:171], v[196:199], v[60:63]
    s_lshl_b32 s66, s52, 5
    v_mfma_f32_16x16x32_bf16 v[128:131], v[172:175], v[196:199], v[128:131]
    ds_read_b128 v[192:195], v14 offset:28672
    v_add_u32 v244, s66, v1
    s_waitcnt lgkmcnt(6)
    v_mfma_f32_16x16x32_bf16 v[64:67], v[168:171], v[200:203], v[64:67]
    v_mul_u32_u24 v244, 208, v244
    v_mfma_f32_16x16x32_bf16 v[132:135], v[172:175], v[200:203], v[132:135]
    ds_read_b128 v[196:199], v14 offset:30720
    v_lshl_add_u32 v244, v2, 4, v244
    s_waitcnt lgkmcnt(6)
    v_mfma_f32_16x16x32_bf16 v[68:71], v[168:171], v[204:207], v[68:71]
    ds_read_b128 v[200:203], v14 offset:32768
    v_add_u32 v240, 99072, v244
    v_mfma_f32_16x16x32_bf16 v[136:139], v[172:175], v[204:207], v[136:139]
    v_cmp_gt_u32 vcc, 3, v2
    v_nop
    v_nop
    v_cndmask_b32 v232, 0, -1, vcc
    s_waitcnt lgkmcnt(6)
    v_mfma_f32_16x16x32_bf16 v[72:75], v[168:171], v[208:211], v[72:75]
    ds_read_b64_tr_b16 v[176:177], v16 offset:8448
    v_cmp_gt_u32 vcc, 2, v2
    v_nop
    v_nop
    v_cndmask_b32 v233, 0, -1, vcc
    v_mfma_f32_16x16x32_bf16 v[140:143], v[172:175], v[208:211], v[140:143]
    ds_read_b64_tr_b16 v[178:179], v16 offset:8704
    s_or_b32 s66, s55, s52
    s_cselect_b32 s66, 0, 8
    s_waitcnt lgkmcnt(7)
    v_mfma_f32_16x16x32_bf16 v[76:79], v[168:171], v[212:215], v[76:79]
    ds_read_b64_tr_b16 v[180:181], v16 offset:8480
    ds_read_b64_tr_b16 v[182:183], v16 offset:8736
    v_add_u32 v244, 1, v1
    v_mfma_f32_16x16x32_bf16 v[144:147], v[172:175], v[212:215], v[144:147]
    ds_read_b128 v[204:207], v15 offset:0
    v_max_u32 v244, s66, v244
    s_waitcnt lgkmcnt(9)
    v_mfma_f32_16x16x32_bf16 v[80:83], v[168:171], v[184:187], v[80:83]
    v_mfma_f32_16x16x32_bf16 v[148:151], v[172:175], v[184:187], v[148:151]
    ds_read_b128 v[208:211], v15 offset:2048
    s_waitcnt lgkmcnt(9)
    v_mfma_f32_16x16x32_bf16 v[84:87], v[168:171], v[188:191], v[84:87]
    v_mfma_f32_16x16x32_bf16 v[152:155], v[172:175], v[188:191], v[152:155]
    ds_read_b128 v[212:215], v15 offset:4096
    s_waitcnt lgkmcnt(9)
    v_mfma_f32_16x16x32_bf16 v[88:91], v[168:171], v[192:195], v[88:91]
    ds_read_b128 v[184:187], v15 offset:6144
    v_mfma_f32_16x16x32_bf16 v[156:159], v[172:175], v[192:195], v[156:159]
    s_waitcnt lgkmcnt(9)
    v_mfma_f32_16x16x32_bf16 v[92:95], v[168:171], v[196:199], v[92:95]
    ds_read_b128 v[188:191], v15 offset:8192
    v_mfma_f32_16x16x32_bf16 v[160:163], v[172:175], v[196:199], v[160:163]
    s_waitcnt lgkmcnt(9)
    v_mfma_f32_16x16x32_bf16 v[96:99], v[168:171], v[200:203], v[96:99]
    ds_read_b128 v[192:195], v15 offset:10240
    v_mfma_f32_16x16x32_bf16 v[164:167], v[172:175], v[200:203], v[164:167]
    ds_read_b128 v[196:199], v15 offset:12288
    s_waitcnt lgkmcnt(6)
    v_mfma_f32_16x16x32_bf16 v[32:35], v[176:179], v[204:207], v[32:35]
    v_mfma_f32_16x16x32_bf16 v[100:103], v[180:183], v[204:207], v[100:103]
    ds_read_b128 v[200:203], v15 offset:14336
    s_waitcnt lgkmcnt(6)
    v_mfma_f32_16x16x32_bf16 v[36:39], v[176:179], v[208:211], v[36:39]
    v_mfma_f32_16x16x32_bf16 v[104:107], v[180:183], v[208:211], v[104:107]
    ds_read_b128 v[204:207], v15 offset:16384
    s_waitcnt lgkmcnt(6)
    v_mfma_f32_16x16x32_bf16 v[40:43], v[176:179], v[212:215], v[40:43]
    ds_read_b128 v[208:211], v15 offset:18432
    v_mfma_f32_16x16x32_bf16 v[108:111], v[180:183], v[212:215], v[108:111]
    s_waitcnt lgkmcnt(6)
    v_mfma_f32_16x16x32_bf16 v[44:47], v[176:179], v[184:187], v[44:47]
    ds_read_b128 v[212:215], v15 offset:20480
    v_mfma_f32_16x16x32_bf16 v[112:115], v[180:183], v[184:187], v[112:115]
    s_waitcnt lgkmcnt(6)
    v_mfma_f32_16x16x32_bf16 v[48:51], v[176:179], v[188:191], v[48:51]
    ds_read_b128 v[184:187], v15 offset:22528
    v_mfma_f32_16x16x32_bf16 v[116:119], v[180:183], v[188:191], v[116:119]
    ds_read_b128 v[188:191], v15 offset:24576
    s_waitcnt lgkmcnt(7)
    v_mfma_f32_16x16x32_bf16 v[52:55], v[176:179], v[192:195], v[52:55]
    v_mfma_f32_16x16x32_bf16 v[120:123], v[180:183], v[192:195], v[120:123]
    ds_read_b128 v[192:195], v15 offset:26624
    s_waitcnt lgkmcnt(7)
    v_mfma_f32_16x16x32_bf16 v[56:59], v[176:179], v[196:199], v[56:59]
    v_mfma_f32_16x16x32_bf16 v[124:127], v[180:183], v[196:199], v[124:127]
    ds_read_b128 v[196:199], v15 offset:28672
    s_waitcnt lgkmcnt(7)
    v_mfma_f32_16x16x32_bf16 v[60:63], v[176:179], v[200:203], v[60:63]
    v_mfma_f32_16x16x32_bf16 v[128:131], v[180:183], v[200:203], v[128:131]
    ds_read_b128 v[200:203], v15 offset:30720
    s_waitcnt lgkmcnt(7)
    v_mfma_f32_16x16x32_bf16 v[64:67], v[176:179], v[204:207], v[64:67]
    v_mfma_f32_16x16x32_bf16 v[132:135], v[180:183], v[204:207], v[132:135]
    ds_read_b128 v[204:207], v15 offset:32768
    s_waitcnt lgkmcnt(7)
    v_mfma_f32_16x16x32_bf16 v[68:71], v[176:179], v[208:211], v[68:71]
    v_mfma_f32_16x16x32_bf16 v[136:139], v[180:183], v[208:211], v[136:139]
    s_waitcnt lgkmcnt(6)
    v_mfma_f32_16x16x32_bf16 v[72:75], v[176:179], v[212:215], v[72:75]
    v_mfma_f32_16x16x32_bf16 v[140:143], v[180:183], v[212:215], v[140:143]
    s_waitcnt lgkmcnt(5)
    v_mfma_f32_16x16x32_bf16 v[76:79], v[176:179], v[184:187], v[76:79]
    v_mfma_f32_16x16x32_bf16 v[144:147], v[180:183], v[184:187], v[144:147]
    s_waitcnt lgkmcnt(0)
    v_add_u32 v14, 0, v3
    v_add_u32 v15, 0, v4
    v_add_u32 v16, 34816, v5
    s_barrier
    ds_read_b64_tr_b16 v[168:169], v16 offset:0
    ds_read_b64_tr_b16 v[170:171], v16 offset:256
    v_mfma_f32_16x16x32_bf16 v[80:83], v[176:179], v[188:191], v[80:83]
    ds_read_b64_tr_b16 v[172:173], v16 offset:32
    v_add_u32 v245, 8, v1
    v_mfma_f32_16x16x32_bf16 v[148:151], v[180:183], v[188:191], v[148:151]
    ds_read_b64_tr_b16 v[174:175], v16 offset:288
    v_mov_b32 v250, 1.0
    v_mfma_f32_16x16x32_bf16 v[84:87], v[176:179], v[192:195], v[84:87]
    ds_read_b128 v[208:211], v14 offset:0
    v_mov_b32 v251, 0xce6e6b28
    v_mfma_f32_16x16x32_bf16 v[152:155], v[180:183], v[192:195], v[152:155]
    ds_read_b128 v[212:215], v14 offset:2048
    v_lshl_add_u32 v246, v2, 2, 0
    v_mfma_f32_16x16x32_bf16 v[88:91], v[176:179], v[196:199], v[88:91]
    v_cmp_ge_u32 s[80:81], v246, v244
    v_mfma_f32_16x16x32_bf16 v[156:159], v[180:183], v[196:199], v[156:159]
    ds_read_b128 v[184:187], v14 offset:4096
    v_cmp_le_u32 vcc, v246, v245
    v_mfma_f32_16x16x32_bf16 v[92:95], v[176:179], v[200:203], v[92:95]
    v_add_u32 v246, 16, v246
    v_mfma_f32_16x16x32_bf16 v[160:163], v[180:183], v[200:203], v[160:163]
    ds_read_b128 v[188:191], v14 offset:6144
    s_and_b64 s[80:81], s[80:81], vcc
    v_mfma_f32_16x16x32_bf16 v[96:99], v[176:179], v[204:207], v[96:99]
    ds_read_b128 v[192:195], v14 offset:8192
    v_cmp_le_u32 s[82:83], v246, v245
    v_mfma_f32_16x16x32_bf16 v[164:167], v[180:183], v[204:207], v[164:167]
    v_cndmask_b32 v216, 0, v250, s[80:81]
    s_waitcnt lgkmcnt(4)
    v_mfma_f32_16x16x32_bf16 v[32:35], v[168:171], v[208:211], v[32:35]
    ds_read_b128 v[196:199], v14 offset:10240
    v_mov_b32 v246, 0xffff
    v_mfma_f32_16x16x32_bf16 v[100:103], v[172:175], v[208:211], v[100:103]
    v_cndmask_b32 v220, 0, v250, s[82:83]
    s_waitcnt lgkmcnt(4)
    v_mfma_f32_16x16x32_bf16 v[36:39], v[168:171], v[212:215], v[36:39]
    ds_read_b128 v[200:203], v14 offset:12288
    v_cndmask_b32 v247, 0, v246, s[82:83]
    v_mfma_f32_16x16x32_bf16 v[104:107], v[172:175], v[212:215], v[104:107]
    ds_read_b128 v[204:207], v14 offset:14336
    s_or_b64 s[80:81], s[80:81], s[82:83]
    s_waitcnt lgkmcnt(5)
    v_mfma_f32_16x16x32_bf16 v[40:43], v[168:171], v[184:187], v[40:43]
    v_cndmask_b32 v224, v251, 0, s[80:81]
    v_mfma_f32_16x16x32_bf16 v[108:111], v[172:175], v[184:187], v[108:111]
    ds_read_b128 v[208:211], v14 offset:16384
    v_mov_b32 v230, v247
    s_waitcnt lgkmcnt(5)
    v_mfma_f32_16x16x32_bf16 v[44:47], v[168:171], v[188:191], v[44:47]
    v_lshl_add_u32 v246, v2, 2, 1
    v_mfma_f32_16x16x32_bf16 v[112:115], v[172:175], v[188:191], v[112:115]
    ds_read_b128 v[212:215], v14 offset:18432
    v_cmp_ge_u32 s[80:81], v246, v244
    s_waitcnt lgkmcnt(5)
    v_mfma_f32_16x16x32_bf16 v[48:51], v[168:171], v[192:195], v[48:51]
    ds_read_b128 v[184:187], v14 offset:20480
    v_cmp_le_u32 vcc, v246, v245
    v_mfma_f32_16x16x32_bf16 v[116:119], v[172:175], v[192:195], v[116:119]
    v_add_u32 v246, 16, v246
    s_waitcnt lgkmcnt(5)
    v_mfma_f32_16x16x32_bf16 v[52:55], v[168:171], v[196:199], v[52:55]
    ds_read_b128 v[188:191], v14 offset:22528
    s_and_b64 s[80:81], s[80:81], vcc
    v_mfma_f32_16x16x32_bf16 v[120:123], v[172:175], v[196:199], v[120:123]
    v_cmp_le_u32 s[82:83], v246, v245
    s_waitcnt lgkmcnt(5)
    v_mfma_f32_16x16x32_bf16 v[56:59], v[168:171], v[200:203], v[56:59]
    ds_read_b128 v[192:195], v14 offset:24576
    v_cndmask_b32 v217, 0, v250, s[80:81]
    v_mfma_f32_16x16x32_bf16 v[124:127], v[172:175], v[200:203], v[124:127]
    ds_read_b128 v[196:199], v14 offset:26624
    v_mov_b32 v246, 0xffff0000
    s_waitcnt lgkmcnt(6)
    v_mfma_f32_16x16x32_bf16 v[60:63], v[168:171], v[204:207], v[60:63]
    v_cndmask_b32 v221, 0, v250, s[82:83]
    v_mfma_f32_16x16x32_bf16 v[128:131], v[172:175], v[204:207], v[128:131]
    ds_read_b128 v[200:203], v14 offset:28672
    v_cndmask_b32 v247, 0, v246, s[82:83]
    s_waitcnt lgkmcnt(6)
    v_mfma_f32_16x16x32_bf16 v[64:67], v[168:171], v[208:211], v[64:67]
    s_or_b64 s[80:81], s[80:81], s[82:83]
    v_mfma_f32_16x16x32_bf16 v[132:135], v[172:175], v[208:211], v[132:135]
    ds_read_b128 v[204:207], v14 offset:30720
    v_cndmask_b32 v225, v251, 0, s[80:81]
    s_waitcnt lgkmcnt(6)
    v_mfma_f32_16x16x32_bf16 v[68:71], v[168:171], v[212:215], v[68:71]
    ds_read_b128 v[208:211], v14 offset:32768
    v_or_b32 v230, v230, v247
    v_mfma_f32_16x16x32_bf16 v[136:139], v[172:175], v[212:215], v[136:139]
    v_not_b32 v228, v230
    s_waitcnt lgkmcnt(6)
    v_mfma_f32_16x16x32_bf16 v[72:75], v[168:171], v[184:187], v[72:75]
    ds_read_b64_tr_b16 v[176:177], v16 offset:8448
    v_lshl_add_u32 v246, v2, 2, 2
    v_mfma_f32_16x16x32_bf16 v[140:143], v[172:175], v[184:187], v[140:143]
    ds_read_b64_tr_b16 v[178:179], v16 offset:8704
    v_cmp_ge_u32 s[80:81], v246, v244
    s_waitcnt lgkmcnt(7)
    v_mfma_f32_16x16x32_bf16 v[76:79], v[168:171], v[188:191], v[76:79]
    ds_read_b64_tr_b16 v[180:181], v16 offset:8480
    ds_read_b64_tr_b16 v[182:183], v16 offset:8736
    v_cmp_le_u32 vcc, v246, v245
    v_mfma_f32_16x16x32_bf16 v[144:147], v[172:175], v[188:191], v[144:147]
    ds_read_b128 v[212:215], v15 offset:0
    v_add_u32 v246, 16, v246
    s_waitcnt lgkmcnt(9)
    v_mfma_f32_16x16x32_bf16 v[80:83], v[168:171], v[192:195], v[80:83]
    v_mfma_f32_16x16x32_bf16 v[148:151], v[172:175], v[192:195], v[148:151]
    ds_read_b128 v[184:187], v15 offset:2048
    s_waitcnt lgkmcnt(9)
    v_mfma_f32_16x16x32_bf16 v[84:87], v[168:171], v[196:199], v[84:87]
    v_mfma_f32_16x16x32_bf16 v[152:155], v[172:175], v[196:199], v[152:155]
    ds_read_b128 v[188:191], v15 offset:4096
    s_waitcnt lgkmcnt(9)
    v_mfma_f32_16x16x32_bf16 v[88:91], v[168:171], v[200:203], v[88:91]
    ds_read_b128 v[192:195], v15 offset:6144
    v_mfma_f32_16x16x32_bf16 v[156:159], v[172:175], v[200:203], v[156:159]
    s_waitcnt lgkmcnt(9)
    v_mfma_f32_16x16x32_bf16 v[92:95], v[168:171], v[204:207], v[92:95]
    ds_read_b128 v[196:199], v15 offset:8192
    v_mfma_f32_16x16x32_bf16 v[160:163], v[172:175], v[204:207], v[160:163]
    s_waitcnt lgkmcnt(9)
    v_mfma_f32_16x16x32_bf16 v[96:99], v[168:171], v[208:211], v[96:99]
    ds_read_b128 v[200:203], v15 offset:10240
    v_mfma_f32_16x16x32_bf16 v[164:167], v[172:175], v[208:211], v[164:167]
    ds_read_b128 v[204:207], v15 offset:12288
    s_waitcnt lgkmcnt(6)
    v_mfma_f32_16x16x32_bf16 v[32:35], v[176:179], v[212:215], v[32:35]
    v_mfma_f32_16x16x32_bf16 v[100:103], v[180:183], v[212:215], v[100:103]
    ds_read_b128 v[208:211], v15 offset:14336
    s_waitcnt lgkmcnt(6)
    v_mfma_f32_16x16x32_bf16 v[36:39], v[176:179], v[184:187], v[36:39]
    v_mfma_f32_16x16x32_bf16 v[104:107], v[180:183], v[184:187], v[104:107]
    ds_read_b128 v[212:215], v15 offset:16384
    s_waitcnt lgkmcnt(6)
    v_mfma_f32_16x16x32_bf16 v[40:43], v[176:179], v[188:191], v[40:43]
    ds_read_b128 v[184:187], v15 offset:18432
    v_mfma_f32_16x16x32_bf16 v[108:111], v[180:183], v[188:191], v[108:111]
    s_waitcnt lgkmcnt(6)
    v_mfma_f32_16x16x32_bf16 v[44:47], v[176:179], v[192:195], v[44:47]
    ds_read_b128 v[188:191], v15 offset:20480
    v_mfma_f32_16x16x32_bf16 v[112:115], v[180:183], v[192:195], v[112:115]
    s_waitcnt lgkmcnt(6)
    v_mfma_f32_16x16x32_bf16 v[48:51], v[176:179], v[196:199], v[48:51]
    ds_read_b128 v[192:195], v15 offset:22528
    v_mfma_f32_16x16x32_bf16 v[116:119], v[180:183], v[196:199], v[116:119]
    ds_read_b128 v[196:199], v15 offset:24576
    s_waitcnt lgkmcnt(7)
    v_mfma_f32_16x16x32_bf16 v[52:55], v[176:179], v[200:203], v[52:55]
    v_mfma_f32_16x16x32_bf16 v[120:123], v[180:183], v[200:203], v[120:123]
    ds_read_b128 v[200:203], v15 offset:26624
    s_waitcnt lgkmcnt(7)
    v_mfma_f32_16x16x32_bf16 v[56:59], v[176:179], v[204:207], v[56:59]
    v_mfma_f32_16x16x32_bf16 v[124:127], v[180:183], v[204:207], v[124:127]
    ds_read_b128 v[204:207], v15 offset:28672
    s_waitcnt lgkmcnt(7)
    v_mfma_f32_16x16x32_bf16 v[60:63], v[176:179], v[208:211], v[60:63]
    v_mfma_f32_16x16x32_bf16 v[128:131], v[180:183], v[208:211], v[128:131]
    ds_read_b128 v[208:211], v15 offset:30720
    s_waitcnt lgkmcnt(7)
    v_mfma_f32_16x16x32_bf16 v[64:67], v[176:179], v[212:215], v[64:67]
    v_mfma_f32_16x16x32_bf16 v[132:135], v[180:183], v[212:215], v[132:135]
    ds_read_b128 v[212:215], v15 offset:32768
    s_waitcnt lgkmcnt(7)
    v_mfma_f32_16x16x32_bf16 v[68:71], v[176:179], v[184:187], v[68:71]
    v_mfma_f32_16x16x32_bf16 v[136:139], v[180:183], v[184:187], v[136:139]
    s_waitcnt lgkmcnt(6)
    v_mfma_f32_16x16x32_bf16 v[72:75], v[176:179], v[188:191], v[72:75]
    v_mfma_f32_16x16x32_bf16 v[140:143], v[180:183], v[188:191], v[140:143]
    s_waitcnt lgkmcnt(5)
    v_mfma_f32_16x16x32_bf16 v[76:79], v[176:179], v[192:195], v[76:79]
    v_mfma_f32_16x16x32_bf16 v[144:147], v[180:183], v[192:195], v[144:147]
    s_waitcnt lgkmcnt(0)
    v_add_u32 v14, 51712, v3
    v_add_u32 v15, 51712, v4
    v_add_u32 v16, 86528, v5
    s_barrier
    ds_read_b64_tr_b16 v[168:169], v16 offset:0
    ds_read_b64_tr_b16 v[170:171], v16 offset:256
    v_mfma_f32_16x16x32_bf16 v[80:83], v[176:179], v[196:199], v[80:83]
    ds_read_b64_tr_b16 v[172:173], v16 offset:32
    s_and_b64 s[80:81], s[80:81], vcc
    v_mfma_f32_16x16x32_bf16 v[148:151], v[180:183], v[196:199], v[148:151]
    ds_read_b64_tr_b16 v[174:175], v16 offset:288
    v_cmp_le_u32 s[82:83], v246, v245
    v_mfma_f32_16x16x32_bf16 v[84:87], v[176:179], v[200:203], v[84:87]
    ds_read_b128 v[184:187], v14 offset:0
    v_cndmask_b32 v218, 0, v250, s[80:81]
    v_mfma_f32_16x16x32_bf16 v[152:155], v[180:183], v[200:203], v[152:155]
    ds_read_b128 v[188:191], v14 offset:2048
    v_mov_b32 v246, 0xffff
    v_mfma_f32_16x16x32_bf16 v[88:91], v[176:179], v[204:207], v[88:91]
    v_cndmask_b32 v222, 0, v250, s[82:83]
    v_mfma_f32_16x16x32_bf16 v[156:159], v[180:183], v[204:207], v[156:159]
    ds_read_b128 v[192:195], v14 offset:4096
    v_cndmask_b32 v247, 0, v246, s[82:83]
    v_mfma_f32_16x16x32_bf16 v[92:95], v[176:179], v[208:211], v[92:95]
    s_or_b64 s[80:81], s[80:81], s[82:83]
    v_mfma_f32_16x16x32_bf16 v[160:163], v[180:183], v[208:211], v[160:163]
    ds_read_b128 v[196:199], v14 offset:6144
    v_cndmask_b32 v226, v251, 0, s[80:81]
    v_mfma_f32_16x16x32_bf16 v[96:99], v[176:179], v[212:215], v[96:99]
    ds_read_b128 v[200:203], v14 offset:8192
    v_mov_b32 v231, v247
    v_mfma_f32_16x16x32_bf16 v[164:167], v[180:183], v[212:215], v[164:167]
    v_lshl_add_u32 v246, v2, 2, 3
    s_waitcnt lgkmcnt(4)
    v_mfma_f32_16x16x32_bf16 v[32:35], v[168:171], v[184:187], v[32:35]
    ds_read_b128 v[204:207], v14 offset:10240
    v_cmp_ge_u32 s[80:81], v246, v244
    v_mfma_f32_16x16x32_bf16 v[100:103], v[172:175], v[184:187], v[100:103]
    v_cmp_le_u32 vcc, v246, v245
    s_waitcnt lgkmcnt(4)
    v_mfma_f32_16x16x32_bf16 v[36:39], v[168:171], v[188:191], v[36:39]
    ds_read_b128 v[208:211], v14 offset:12288
    v_add_u32 v246, 16, v246
    v_mfma_f32_16x16x32_bf16 v[104:107], v[172:175], v[188:191], v[104:107]
    ds_read_b128 v[212:215], v14 offset:14336
    s_and_b64 s[80:81], s[80:81], vcc
    s_waitcnt lgkmcnt(5)
    v_mfma_f32_16x16x32_bf16 v[40:43], v[168:171], v[192:195], v[40:43]
    v_cmp_le_u32 s[82:83], v246, v245
    v_mfma_f32_16x16x32_bf16 v[108:111], v[172:175], v[192:195], v[108:111]
    ds_read_b128 v[184:187], v14 offset:16384
    v_cndmask_b32 v219, 0, v250, s[80:81]
    s_waitcnt lgkmcnt(5)
    v_mfma_f32_16x16x32_bf16 v[44:47], v[168:171], v[196:199], v[44:47]
    v_mov_b32 v246, 0xffff0000
    v_mfma_f32_16x16x32_bf16 v[112:115], v[172:175], v[196:199], v[112:115]
    ds_read_b128 v[188:191], v14 offset:18432
    v_cndmask_b32 v223, 0, v250, s[82:83]
    s_waitcnt lgkmcnt(5)
    v_mfma_f32_16x16x32_bf16 v[48:51], v[168:171], v[200:203], v[48:51]
    ds_read_b128 v[192:195], v14 offset:20480
    v_cndmask_b32 v247, 0, v246, s[82:83]
    v_mfma_f32_16x16x32_bf16 v[116:119], v[172:175], v[200:203], v[116:119]
    s_or_b64 s[80:81], s[80:81], s[82:83]
    s_waitcnt lgkmcnt(5)
    v_mfma_f32_16x16x32_bf16 v[52:55], v[168:171], v[204:207], v[52:55]
    ds_read_b128 v[196:199], v14 offset:22528
    v_cndmask_b32 v227, v251, 0, s[80:81]
    v_mfma_f32_16x16x32_bf16 v[120:123], v[172:175], v[204:207], v[120:123]
    v_or_b32 v231, v231, v247
    s_waitcnt lgkmcnt(5)
    v_mfma_f32_16x16x32_bf16 v[56:59], v[168:171], v[208:211], v[56:59]
    ds_read_b128 v[200:203], v14 offset:24576
    v_not_b32 v229, v231
    v_mfma_f32_16x16x32_bf16 v[124:127], v[172:175], v[208:211], v[124:127]
    ds_read_b128 v[204:207], v14 offset:26624
    v_and_b32 v244, 1, v2
    s_waitcnt lgkmcnt(6)
    v_mfma_f32_16x16x32_bf16 v[60:63], v[168:171], v[212:215], v[60:63]
    v_lshl_add_u32 v244, v1, 1, v244
    v_mfma_f32_16x16x32_bf16 v[128:131], v[172:175], v[212:215], v[128:131]
    ds_read_b128 v[208:211], v14 offset:28672
    v_lshrrev_b32 v243, 4, v244
    s_waitcnt lgkmcnt(6)
    v_mfma_f32_16x16x32_bf16 v[64:67], v[168:171], v[184:187], v[64:67]
    v_lshlrev_b32 v243, 10, v243
    v_mfma_f32_16x16x32_bf16 v[132:135], v[172:175], v[184:187], v[132:135]
    ds_read_b128 v[212:215], v14 offset:30720
    v_and_b32 v244, 15, v244
    s_waitcnt lgkmcnt(6)
    v_mfma_f32_16x16x32_bf16 v[68:71], v[168:171], v[188:191], v[68:71]
    ds_read_b128 v[184:187], v14 offset:32768
    v_lshl_add_u32 v243, v244, 4, v243
    v_mfma_f32_16x16x32_bf16 v[136:139], v[172:175], v[188:191], v[136:139]
    s_lshl2_add_u32 s66, s55, s52
    s_waitcnt lgkmcnt(6)
    v_mfma_f32_16x16x32_bf16 v[72:75], v[168:171], v[192:195], v[72:75]
    ds_read_b64_tr_b16 v[176:177], v16 offset:8448
    s_mul_i32 s66, s66, 81920
    v_mfma_f32_16x16x32_bf16 v[140:143], v[172:175], v[192:195], v[140:143]
    ds_read_b64_tr_b16 v[178:179], v16 offset:8704
    s_add_u32 s66, s66, 5242880
    s_waitcnt lgkmcnt(7)
    v_mfma_f32_16x16x32_bf16 v[76:79], v[168:171], v[196:199], v[76:79]
    ds_read_b64_tr_b16 v[180:181], v16 offset:8480
    ds_read_b64_tr_b16 v[182:183], v16 offset:8736
    v_add_u32 v243, s66, v243
    v_mfma_f32_16x16x32_bf16 v[144:147], v[172:175], v[196:199], v[144:147]
    ds_read_b128 v[188:191], v15 offset:0
    s_mul_i32 s66, s56, 5
    s_waitcnt lgkmcnt(9)
    v_mfma_f32_16x16x32_bf16 v[80:83], v[168:171], v[200:203], v[80:83]
    v_mfma_f32_16x16x32_bf16 v[148:151], v[172:175], v[200:203], v[148:151]
    ds_read_b128 v[192:195], v15 offset:2048
    s_waitcnt lgkmcnt(9)
    v_mfma_f32_16x16x32_bf16 v[84:87], v[168:171], v[204:207], v[84:87]
    v_mfma_f32_16x16x32_bf16 v[152:155], v[172:175], v[204:207], v[152:155]
    ds_read_b128 v[196:199], v15 offset:4096
    s_waitcnt lgkmcnt(9)
    v_mfma_f32_16x16x32_bf16 v[88:91], v[168:171], v[208:211], v[88:91]
    ds_read_b128 v[200:203], v15 offset:6144
    v_mfma_f32_16x16x32_bf16 v[156:159], v[172:175], v[208:211], v[156:159]
    s_waitcnt lgkmcnt(9)
    v_mfma_f32_16x16x32_bf16 v[92:95], v[168:171], v[212:215], v[92:95]
    ds_read_b128 v[204:207], v15 offset:8192
    v_mfma_f32_16x16x32_bf16 v[160:163], v[172:175], v[212:215], v[160:163]
    s_waitcnt lgkmcnt(9)
    v_mfma_f32_16x16x32_bf16 v[96:99], v[168:171], v[184:187], v[96:99]
    ds_read_b128 v[208:211], v15 offset:10240
    v_mfma_f32_16x16x32_bf16 v[164:167], v[172:175], v[184:187], v[164:167]
    ds_read_b128 v[212:215], v15 offset:12288
    s_waitcnt lgkmcnt(6)
    v_mfma_f32_16x16x32_bf16 v[32:35], v[176:179], v[188:191], v[32:35]
    v_mfma_f32_16x16x32_bf16 v[100:103], v[180:183], v[188:191], v[100:103]
    ds_read_b128 v[184:187], v15 offset:14336
    s_waitcnt lgkmcnt(6)
    v_mfma_f32_16x16x32_bf16 v[36:39], v[176:179], v[192:195], v[36:39]
    v_mfma_f32_16x16x32_bf16 v[104:107], v[180:183], v[192:195], v[104:107]
    ds_read_b128 v[188:191], v15 offset:16384
    s_waitcnt lgkmcnt(6)
    v_mfma_f32_16x16x32_bf16 v[40:43], v[176:179], v[196:199], v[40:43]
    ds_read_b128 v[192:195], v15 offset:18432
    v_mfma_f32_16x16x32_bf16 v[108:111], v[180:183], v[196:199], v[108:111]
    s_waitcnt lgkmcnt(6)
    v_mfma_f32_16x16x32_bf16 v[44:47], v[176:179], v[200:203], v[44:47]
    ds_read_b128 v[196:199], v15 offset:20480
    v_mfma_f32_16x16x32_bf16 v[112:115], v[180:183], v[200:203], v[112:115]
    s_waitcnt lgkmcnt(6)
    v_mfma_f32_16x16x32_bf16 v[48:51], v[176:179], v[204:207], v[48:51]
    ds_read_b128 v[200:203], v15 offset:22528
    v_mfma_f32_16x16x32_bf16 v[116:119], v[180:183], v[204:207], v[116:119]
    ds_read_b128 v[204:207], v15 offset:24576
    s_waitcnt lgkmcnt(7)
    v_mfma_f32_16x16x32_bf16 v[52:55], v[176:179], v[208:211], v[52:55]
    v_mfma_f32_16x16x32_bf16 v[120:123], v[180:183], v[208:211], v[120:123]
    ds_read_b128 v[208:211], v15 offset:26624
    s_waitcnt lgkmcnt(7)
    v_mfma_f32_16x16x32_bf16 v[56:59], v[176:179], v[212:215], v[56:59]
    v_mfma_f32_16x16x32_bf16 v[124:127], v[180:183], v[212:215], v[124:127]
    ds_read_b128 v[212:215], v15 offset:28672
    s_waitcnt lgkmcnt(7)
    v_mfma_f32_16x16x32_bf16 v[60:63], v[176:179], v[184:187], v[60:63]
    v_mfma_f32_16x16x32_bf16 v[128:131], v[180:183], v[184:187], v[128:131]
    ds_read_b128 v[184:187], v15 offset:30720
    s_waitcnt lgkmcnt(7)
    v_mfma_f32_16x16x32_bf16 v[64:67], v[176:179], v[188:191], v[64:67]
    v_mfma_f32_16x16x32_bf16 v[132:135], v[180:183], v[188:191], v[132:135]
    ds_read_b128 v[188:191], v15 offset:32768
    s_waitcnt lgkmcnt(7)
    v_mfma_f32_16x16x32_bf16 v[68:71], v[176:179], v[192:195], v[68:71]
    v_mfma_f32_16x16x32_bf16 v[136:139], v[180:183], v[192:195], v[136:139]
    s_waitcnt lgkmcnt(6)
    v_mfma_f32_16x16x32_bf16 v[72:75], v[176:179], v[196:199], v[72:75]
    v_mfma_f32_16x16x32_bf16 v[140:143], v[180:183], v[196:199], v[140:143]
    s_waitcnt lgkmcnt(5)
    v_mfma_f32_16x16x32_bf16 v[76:79], v[176:179], v[200:203], v[76:79]
    v_mfma_f32_16x16x32_bf16 v[144:147], v[180:183], v[200:203], v[144:147]
    s_waitcnt lgkmcnt(0)
    v_add_u32 v14, 103424, v3
    v_add_u32 v15, 103424, v4
    v_add_u32 v16, 138240, v5
    s_barrier
    ds_read_b64_tr_b16 v[168:169], v16 offset:0
    ds_read_b64_tr_b16 v[170:171], v16 offset:256
    v_mfma_f32_16x16x32_bf16 v[80:83], v[176:179], v[204:207], v[80:83]
    ds_read_b64_tr_b16 v[172:173], v16 offset:32
    v_lshrrev_b32 v245, 5, v0
    v_mfma_f32_16x16x32_bf16 v[148:151], v[180:183], v[204:207], v[148:151]
    ds_read_b64_tr_b16 v[174:175], v16 offset:288
    v_add_u32 v244, s66, v245
    v_mfma_f32_16x16x32_bf16 v[84:87], v[176:179], v[208:211], v[84:87]
    ds_read_b128 v[192:195], v14 offset:0
    v_lshrrev_b32 v241, 2, v244
    v_mfma_f32_16x16x32_bf16 v[152:155], v[180:183], v[208:211], v[152:155]
    ds_read_b128 v[196:199], v14 offset:2048
    v_lshl_add_u32 v241, v241, 12, v243
    v_mfma_f32_16x16x32_bf16 v[88:91], v[176:179], v[212:215], v[88:91]
    v_and_b32 v246, 3, v244
    v_mfma_f32_16x16x32_bf16 v[156:159], v[180:183], v[212:215], v[156:159]
    ds_read_b128 v[200:203], v14 offset:4096
    v_lshl_add_u32 v241, v246, 8, v241
    v_mfma_f32_16x16x32_bf16 v[92:95], v[176:179], v[184:187], v[92:95]
    v_add_u32 v244, 3, v244
    v_mfma_f32_16x16x32_bf16 v[160:163], v[180:183], v[184:187], v[160:163]
    ds_read_b128 v[204:207], v14 offset:6144
    v_lshrrev_b32 v242, 2, v244
    v_mfma_f32_16x16x32_bf16 v[96:99], v[176:179], v[188:191], v[96:99]
    ds_read_b128 v[208:211], v14 offset:8192
    v_lshl_add_u32 v242, v242, 12, v243
    v_mfma_f32_16x16x32_bf16 v[164:167], v[180:183], v[188:191], v[164:167]
    v_and_b32 v246, 3, v244
    s_waitcnt lgkmcnt(4)
    v_mfma_f32_16x16x32_bf16 v[32:35], v[168:171], v[192:195], v[32:35]
    ds_read_b128 v[212:215], v14 offset:10240
    v_lshl_add_u32 v242, v246, 8, v242
    v_mfma_f32_16x16x32_bf16 v[100:103], v[172:175], v[192:195], v[100:103]
    v_add_u32 v244, 3, v244
    s_waitcnt lgkmcnt(4)
    v_mfma_f32_16x16x32_bf16 v[36:39], v[168:171], v[196:199], v[36:39]
    ds_read_b128 v[184:187], v14 offset:12288
    s_add_u32 s66, s66, 2
    v_mfma_f32_16x16x32_bf16 v[104:107], v[172:175], v[196:199], v[104:107]
    ds_read_b128 v[188:191], v14 offset:14336
    s_and_b32 s67, s66, 3
    s_waitcnt lgkmcnt(5)
    v_mfma_f32_16x16x32_bf16 v[40:43], v[168:171], v[200:203], v[40:43]
    s_lshr_b32 s66, s66, 2
    v_mfma_f32_16x16x32_bf16 v[108:111], v[172:175], v[200:203], v[108:111]
    ds_read_b128 v[192:195], v14 offset:16384
    s_lshl4_add_u32 s66, s66, s67
    s_waitcnt lgkmcnt(5)
    v_mfma_f32_16x16x32_bf16 v[44:47], v[168:171], v[204:207], v[44:47]
    s_lshl_b32 s66, s66, 8
    v_mfma_f32_16x16x32_bf16 v[112:115], v[172:175], v[204:207], v[112:115]
    ds_read_b128 v[196:199], v14 offset:18432
    v_mul_u32_u24 v245, 12582912, v245
    s_waitcnt lgkmcnt(5)
    v_mfma_f32_16x16x32_bf16 v[48:51], v[168:171], v[208:211], v[48:51]
    ds_read_b128 v[200:203], v14 offset:20480
    v_add3_u32 v243, v243, v245, s66
    v_mfma_f32_16x16x32_bf16 v[116:119], v[172:175], v[208:211], v[116:119]
    s_lshl1_add_u32 s66, s52, 0
    s_waitcnt lgkmcnt(5)
    v_mfma_f32_16x16x32_bf16 v[52:55], v[168:171], v[212:215], v[52:55]
    ds_read_b128 v[204:207], v14 offset:22528
    s_lshl_b32 s67, s66, 5
    v_mfma_f32_16x16x32_bf16 v[120:123], v[172:175], v[212:215], v[120:123]
    s_mov_b32 s70, 104
    s_waitcnt lgkmcnt(5)
    v_mfma_f32_16x16x32_bf16 v[56:59], v[168:171], v[184:187], v[56:59]
    ds_read_b128 v[208:211], v14 offset:24576
    s_mov_b32 s69, 97248
    v_mfma_f32_16x16x32_bf16 v[124:127], v[172:175], v[184:187], v[124:127]
    ds_read_b128 v[212:215], v14 offset:26624
    s_cmp_lt_u32 s66, 5
    s_cselect_b32 s70, 168, s70
    s_cselect_b32 s66, 51712, s69
    s_waitcnt lgkmcnt(6)
    v_mfma_f32_16x16x32_bf16 v[60:63], v[168:171], v[188:191], v[60:63]
    s_add_u32 s66, s66, s67
    v_mfma_f32_16x16x32_bf16 v[128:131], v[172:175], v[188:191], v[128:131]
    ds_read_b128 v[184:187], v14 offset:28672
    v_mul_u32_u24 v252, s70, v1
    s_waitcnt lgkmcnt(6)
    v_mfma_f32_16x16x32_bf16 v[64:67], v[168:171], v[192:195], v[64:67]
    v_lshl_add_u32 v252, v2, 3, v252
    v_mfma_f32_16x16x32_bf16 v[132:135], v[172:175], v[192:195], v[132:135]
    ds_read_b128 v[188:191], v14 offset:30720
    v_add_u32 v252, s66, v252
    s_waitcnt lgkmcnt(6)
    v_mfma_f32_16x16x32_bf16 v[68:71], v[168:171], v[196:199], v[68:71]
    ds_read_b128 v[192:195], v14 offset:32768
    s_lshl_b32 s70, s70, 4
    v_mfma_f32_16x16x32_bf16 v[136:139], v[172:175], v[196:199], v[136:139]
    s_lshl1_add_u32 s66, s52, 1
    s_waitcnt lgkmcnt(6)
    v_mfma_f32_16x16x32_bf16 v[72:75], v[168:171], v[200:203], v[72:75]
    ds_read_b64_tr_b16 v[176:177], v16 offset:8448
    s_lshl_b32 s67, s66, 5
    v_mfma_f32_16x16x32_bf16 v[140:143], v[172:175], v[200:203], v[140:143]
    ds_read_b64_tr_b16 v[178:179], v16 offset:8704
    s_mov_b32 s71, 104
    s_waitcnt lgkmcnt(7)
    v_mfma_f32_16x16x32_bf16 v[76:79], v[168:171], v[204:207], v[76:79]
    ds_read_b64_tr_b16 v[180:181], v16 offset:8480
    ds_read_b64_tr_b16 v[182:183], v16 offset:8736
    s_mov_b32 s69, 97248
    v_mfma_f32_16x16x32_bf16 v[144:147], v[172:175], v[204:207], v[144:147]
    ds_read_b128 v[196:199], v15 offset:0
    s_cmp_lt_u32 s66, 5
    s_cselect_b32 s71, 168, s71
    s_cselect_b32 s66, 51712, s69
    s_waitcnt lgkmcnt(9)
    v_mfma_f32_16x16x32_bf16 v[80:83], v[168:171], v[208:211], v[80:83]
    v_mfma_f32_16x16x32_bf16 v[148:151], v[172:175], v[208:211], v[148:151]
    ds_read_b128 v[200:203], v15 offset:2048
    s_waitcnt lgkmcnt(9)
    v_mfma_f32_16x16x32_bf16 v[84:87], v[168:171], v[212:215], v[84:87]
    v_mfma_f32_16x16x32_bf16 v[152:155], v[172:175], v[212:215], v[152:155]
    ds_read_b128 v[204:207], v15 offset:4096
    s_waitcnt lgkmcnt(9)
    v_mfma_f32_16x16x32_bf16 v[88:91], v[168:171], v[184:187], v[88:91]
    ds_read_b128 v[208:211], v15 offset:6144
    v_mfma_f32_16x16x32_bf16 v[156:159], v[172:175], v[184:187], v[156:159]
    s_waitcnt lgkmcnt(9)
    v_mfma_f32_16x16x32_bf16 v[92:95], v[168:171], v[188:191], v[92:95]
    ds_read_b128 v[212:215], v15 offset:8192
    v_mfma_f32_16x16x32_bf16 v[160:163], v[172:175], v[188:191], v[160:163]
    s_waitcnt lgkmcnt(9)
    v_mfma_f32_16x16x32_bf16 v[96:99], v[168:171], v[192:195], v[96:99]
    ds_read_b128 v[184:187], v15 offset:10240
    v_mfma_f32_16x16x32_bf16 v[164:167], v[172:175], v[192:195], v[164:167]
    ds_read_b128 v[188:191], v15 offset:12288
    s_waitcnt lgkmcnt(6)
    v_mfma_f32_16x16x32_bf16 v[32:35], v[176:179], v[196:199], v[32:35]
    v_mfma_f32_16x16x32_bf16 v[100:103], v[180:183], v[196:199], v[100:103]
    ds_read_b128 v[192:195], v15 offset:14336
    s_waitcnt lgkmcnt(6)
    v_mfma_f32_16x16x32_bf16 v[36:39], v[176:179], v[200:203], v[36:39]
    v_mfma_f32_16x16x32_bf16 v[104:107], v[180:183], v[200:203], v[104:107]
    ds_read_b128 v[196:199], v15 offset:16384
    s_waitcnt lgkmcnt(6)
    v_mfma_f32_16x16x32_bf16 v[40:43], v[176:179], v[204:207], v[40:43]
    ds_read_b128 v[200:203], v15 offset:18432
    v_mfma_f32_16x16x32_bf16 v[108:111], v[180:183], v[204:207], v[108:111]
    s_waitcnt lgkmcnt(6)
    v_mfma_f32_16x16x32_bf16 v[44:47], v[176:179], v[208:211], v[44:47]
    ds_read_b128 v[204:207], v15 offset:20480
    v_mfma_f32_16x16x32_bf16 v[112:115], v[180:183], v[208:211], v[112:115]
    s_waitcnt lgkmcnt(6)
    v_mfma_f32_16x16x32_bf16 v[48:51], v[176:179], v[212:215], v[48:51]
    ds_read_b128 v[208:211], v15 offset:22528
    v_mfma_f32_16x16x32_bf16 v[116:119], v[180:183], v[212:215], v[116:119]
    ds_read_b128 v[212:215], v15 offset:24576
    s_waitcnt lgkmcnt(7)
    v_mfma_f32_16x16x32_bf16 v[52:55], v[176:179], v[184:187], v[52:55]
    v_mfma_f32_16x16x32_bf16 v[120:123], v[180:183], v[184:187], v[120:123]
    ds_read_b128 v[184:187], v15 offset:26624
    s_waitcnt lgkmcnt(7)
    v_mfma_f32_16x16x32_bf16 v[56:59], v[176:179], v[188:191], v[56:59]
    v_mfma_f32_16x16x32_bf16 v[124:127], v[180:183], v[188:191], v[124:127]
    ds_read_b128 v[188:191], v15 offset:28672
    s_waitcnt lgkmcnt(7)
    v_mfma_f32_16x16x32_bf16 v[60:63], v[176:179], v[192:195], v[60:63]
    v_mfma_f32_16x16x32_bf16 v[128:131], v[180:183], v[192:195], v[128:131]
    ds_read_b128 v[192:195], v15 offset:30720
    s_waitcnt lgkmcnt(7)
    v_mfma_f32_16x16x32_bf16 v[64:67], v[176:179], v[196:199], v[64:67]
    v_mfma_f32_16x16x32_bf16 v[132:135], v[180:183], v[196:199], v[132:135]
    ds_read_b128 v[196:199], v15 offset:32768
    s_waitcnt lgkmcnt(7)
    v_mfma_f32_16x16x32_bf16 v[68:71], v[176:179], v[200:203], v[68:71]
    v_mfma_f32_16x16x32_bf16 v[136:139], v[180:183], v[200:203], v[136:139]
    s_waitcnt lgkmcnt(6)
    v_mfma_f32_16x16x32_bf16 v[72:75], v[176:179], v[204:207], v[72:75]
    v_mfma_f32_16x16x32_bf16 v[140:143], v[180:183], v[204:207], v[140:143]
    s_waitcnt lgkmcnt(5)
    v_mfma_f32_16x16x32_bf16 v[76:79], v[176:179], v[208:211], v[76:79]
    v_mfma_f32_16x16x32_bf16 v[144:147], v[180:183], v[208:211], v[144:147]
    s_waitcnt lgkmcnt(0)
    v_add_u32 v14, 0, v3
    v_add_u32 v15, 0, v4
    v_add_u32 v16, 34816, v5
    s_barrier
    ds_read_b64_tr_b16 v[168:169], v16 offset:0
    ds_read_b64_tr_b16 v[170:171], v16 offset:256
    v_mfma_f32_16x16x32_bf16 v[80:83], v[176:179], v[212:215], v[80:83]
    ds_read_b64_tr_b16 v[172:173], v16 offset:32
    s_add_u32 s66, s66, s67
    v_mfma_f32_16x16x32_bf16 v[148:151], v[180:183], v[212:215], v[148:151]
    ds_read_b64_tr_b16 v[174:175], v16 offset:288
    v_mul_u32_u24 v253, s71, v1
    v_mfma_f32_16x16x32_bf16 v[84:87], v[176:179], v[184:187], v[84:87]
    ds_read_b128 v[200:203], v14 offset:0
    v_lshl_add_u32 v253, v2, 3, v253
    v_mfma_f32_16x16x32_bf16 v[152:155], v[180:183], v[184:187], v[152:155]
    ds_read_b128 v[204:207], v14 offset:2048
    v_add_u32 v253, s66, v253
    v_mfma_f32_16x16x32_bf16 v[88:91], v[176:179], v[188:191], v[88:91]
    s_lshl_b32 s71, s71, 4
    v_mfma_f32_16x16x32_bf16 v[156:159], v[180:183], v[188:191], v[156:159]
    ds_read_b128 v[208:211], v14 offset:4096
    v_mfma_f32_16x16x32_bf16 v[92:95], v[176:179], v[192:195], v[92:95]
    v_mfma_f32_16x16x32_bf16 v[160:163], v[180:183], v[192:195], v[160:163]
    ds_read_b128 v[212:215], v14 offset:6144
    v_mfma_f32_16x16x32_bf16 v[96:99], v[176:179], v[196:199], v[96:99]
    ds_read_b128 v[184:187], v14 offset:8192
    v_mfma_f32_16x16x32_bf16 v[164:167], v[180:183], v[196:199], v[164:167]
    s_waitcnt lgkmcnt(4)
    v_mfma_f32_16x16x32_bf16 v[32:35], v[168:171], v[200:203], v[32:35]
    ds_read_b128 v[188:191], v14 offset:10240
    v_mfma_f32_16x16x32_bf16 v[100:103], v[172:175], v[200:203], v[100:103]
    s_waitcnt lgkmcnt(4)
    v_mfma_f32_16x16x32_bf16 v[36:39], v[168:171], v[204:207], v[36:39]
    ds_read_b128 v[192:195], v14 offset:12288
    v_mfma_f32_16x16x32_bf16 v[104:107], v[172:175], v[204:207], v[104:107]
    ds_read_b128 v[196:199], v14 offset:14336
    s_waitcnt lgkmcnt(5)
    v_mfma_f32_16x16x32_bf16 v[40:43], v[168:171], v[208:211], v[40:43]
    v_mfma_f32_16x16x32_bf16 v[108:111], v[172:175], v[208:211], v[108:111]
    ds_read_b128 v[200:203], v14 offset:16384
    s_waitcnt lgkmcnt(5)
    v_mfma_f32_16x16x32_bf16 v[44:47], v[168:171], v[212:215], v[44:47]
    v_mfma_f32_16x16x32_bf16 v[112:115], v[172:175], v[212:215], v[112:115]
    ds_read_b128 v[204:207], v14 offset:18432
    s_waitcnt lgkmcnt(5)
    v_mfma_f32_16x16x32_bf16 v[48:51], v[168:171], v[184:187], v[48:51]
    ds_read_b128 v[208:211], v14 offset:20480
    v_mfma_f32_16x16x32_bf16 v[116:119], v[172:175], v[184:187], v[116:119]
    s_waitcnt lgkmcnt(5)
    v_mfma_f32_16x16x32_bf16 v[52:55], v[168:171], v[188:191], v[52:55]
    ds_read_b128 v[212:215], v14 offset:22528
    v_mfma_f32_16x16x32_bf16 v[120:123], v[172:175], v[188:191], v[120:123]
    s_waitcnt lgkmcnt(5)
    v_mfma_f32_16x16x32_bf16 v[56:59], v[168:171], v[192:195], v[56:59]
    ds_read_b128 v[184:187], v14 offset:24576
    v_mfma_f32_16x16x32_bf16 v[124:127], v[172:175], v[192:195], v[124:127]
    ds_read_b128 v[188:191], v14 offset:26624
    s_waitcnt lgkmcnt(6)
    v_mfma_f32_16x16x32_bf16 v[60:63], v[168:171], v[196:199], v[60:63]
    v_mfma_f32_16x16x32_bf16 v[128:131], v[172:175], v[196:199], v[128:131]
    ds_read_b128 v[192:195], v14 offset:28672
    s_waitcnt lgkmcnt(6)
    v_mfma_f32_16x16x32_bf16 v[64:67], v[168:171], v[200:203], v[64:67]
    v_mfma_f32_16x16x32_bf16 v[132:135], v[172:175], v[200:203], v[132:135]
    ds_read_b128 v[196:199], v14 offset:30720
    s_waitcnt lgkmcnt(6)
    v_mfma_f32_16x16x32_bf16 v[68:71], v[168:171], v[204:207], v[68:71]
    ds_read_b128 v[200:203], v14 offset:32768
    v_mfma_f32_16x16x32_bf16 v[136:139], v[172:175], v[204:207], v[136:139]
    s_waitcnt lgkmcnt(6)
    v_mfma_f32_16x16x32_bf16 v[72:75], v[168:171], v[208:211], v[72:75]
    ds_read_b64_tr_b16 v[176:177], v16 offset:8448
    v_mfma_f32_16x16x32_bf16 v[140:143], v[172:175], v[208:211], v[140:143]
    ds_read_b64_tr_b16 v[178:179], v16 offset:8704
    s_waitcnt lgkmcnt(7)
    v_mfma_f32_16x16x32_bf16 v[76:79], v[168:171], v[212:215], v[76:79]
    ds_read_b64_tr_b16 v[180:181], v16 offset:8480
    ds_read_b64_tr_b16 v[182:183], v16 offset:8736
    v_mfma_f32_16x16x32_bf16 v[144:147], v[172:175], v[212:215], v[144:147]
    ds_read_b128 v[204:207], v15 offset:0
    s_waitcnt lgkmcnt(9)
    v_mfma_f32_16x16x32_bf16 v[80:83], v[168:171], v[184:187], v[80:83]
    v_mfma_f32_16x16x32_bf16 v[148:151], v[172:175], v[184:187], v[148:151]
    ds_read_b128 v[208:211], v15 offset:2048
    s_waitcnt lgkmcnt(9)
    v_mfma_f32_16x16x32_bf16 v[84:87], v[168:171], v[188:191], v[84:87]
    v_mfma_f32_16x16x32_bf16 v[152:155], v[172:175], v[188:191], v[152:155]
    ds_read_b128 v[212:215], v15 offset:4096
    s_waitcnt lgkmcnt(9)
    v_mfma_f32_16x16x32_bf16 v[88:91], v[168:171], v[192:195], v[88:91]
    ds_read_b128 v[184:187], v15 offset:6144
    v_mfma_f32_16x16x32_bf16 v[156:159], v[172:175], v[192:195], v[156:159]
    s_waitcnt lgkmcnt(9)
    v_mfma_f32_16x16x32_bf16 v[92:95], v[168:171], v[196:199], v[92:95]
    ds_read_b128 v[188:191], v15 offset:8192
    v_mfma_f32_16x16x32_bf16 v[160:163], v[172:175], v[196:199], v[160:163]
    s_waitcnt lgkmcnt(9)
    v_mfma_f32_16x16x32_bf16 v[96:99], v[168:171], v[200:203], v[96:99]
    ds_read_b128 v[192:195], v15 offset:10240
    v_mfma_f32_16x16x32_bf16 v[164:167], v[172:175], v[200:203], v[164:167]
    ds_read_b128 v[196:199], v15 offset:12288
    s_waitcnt lgkmcnt(6)
    v_mfma_f32_16x16x32_bf16 v[32:35], v[176:179], v[204:207], v[32:35]
    v_mfma_f32_16x16x32_bf16 v[100:103], v[180:183], v[204:207], v[100:103]
    ds_read_b128 v[200:203], v15 offset:14336
    s_waitcnt lgkmcnt(6)
    v_mfma_f32_16x16x32_bf16 v[36:39], v[176:179], v[208:211], v[36:39]
    v_mfma_f32_16x16x32_bf16 v[104:107], v[180:183], v[208:211], v[104:107]
    ds_read_b128 v[204:207], v15 offset:16384
    s_waitcnt lgkmcnt(6)
    v_mfma_f32_16x16x32_bf16 v[40:43], v[176:179], v[212:215], v[40:43]
    ds_read_b128 v[208:211], v15 offset:18432
    v_mfma_f32_16x16x32_bf16 v[108:111], v[180:183], v[212:215], v[108:111]
    s_waitcnt lgkmcnt(6)
    v_mfma_f32_16x16x32_bf16 v[44:47], v[176:179], v[184:187], v[44:47]
    ds_read_b128 v[212:215], v15 offset:20480
    v_mfma_f32_16x16x32_bf16 v[112:115], v[180:183], v[184:187], v[112:115]
    s_waitcnt lgkmcnt(6)
    v_mfma_f32_16x16x32_bf16 v[48:51], v[176:179], v[188:191], v[48:51]
    ds_read_b128 v[184:187], v15 offset:22528
    v_mfma_f32_16x16x32_bf16 v[116:119], v[180:183], v[188:191], v[116:119]
    ds_read_b128 v[188:191], v15 offset:24576
    s_waitcnt lgkmcnt(7)
    v_mfma_f32_16x16x32_bf16 v[52:55], v[176:179], v[192:195], v[52:55]
    v_mfma_f32_16x16x32_bf16 v[120:123], v[180:183], v[192:195], v[120:123]
    ds_read_b128 v[192:195], v15 offset:26624
    s_waitcnt lgkmcnt(7)
    v_mfma_f32_16x16x32_bf16 v[56:59], v[176:179], v[196:199], v[56:59]
    v_mfma_f32_16x16x32_bf16 v[124:127], v[180:183], v[196:199], v[124:127]
    ds_read_b128 v[196:199], v15 offset:28672
    s_waitcnt lgkmcnt(7)
    v_mfma_f32_16x16x32_bf16 v[60:63], v[176:179], v[200:203], v[60:63]
    v_mfma_f32_16x16x32_bf16 v[128:131], v[180:183], v[200:203], v[128:131]
    ds_read_b128 v[200:203], v15 offset:30720
    s_waitcnt lgkmcnt(7)
    v_mfma_f32_16x16x32_bf16 v[64:67], v[176:179], v[204:207], v[64:67]
    v_mfma_f32_16x16x32_bf16 v[132:135], v[180:183], v[204:207], v[132:135]
    ds_read_b128 v[204:207], v15 offset:32768
    s_waitcnt lgkmcnt(7)
    v_mfma_f32_16x16x32_bf16 v[68:71], v[176:179], v[208:211], v[68:71]
    v_mfma_f32_16x16x32_bf16 v[136:139], v[180:183], v[208:211], v[136:139]
    s_waitcnt lgkmcnt(6)
    v_mfma_f32_16x16x32_bf16 v[72:75], v[176:179], v[212:215], v[72:75]
    v_mfma_f32_16x16x32_bf16 v[140:143], v[180:183], v[212:215], v[140:143]
    s_waitcnt lgkmcnt(5)
    v_mfma_f32_16x16x32_bf16 v[76:79], v[176:179], v[184:187], v[76:79]
    v_mfma_f32_16x16x32_bf16 v[144:147], v[180:183], v[184:187], v[144:147]
    s_waitcnt lgkmcnt(0)
    v_add_u32 v14, 51712, v3
    v_add_u32 v15, 51712, v4
    v_add_u32 v16, 86528, v5
    s_barrier
    ds_read_b64_tr_b16 v[168:169], v16 offset:0
    ds_read_b64_tr_b16 v[170:171], v16 offset:256
    v_mfma_f32_16x16x32_bf16 v[80:83], v[176:179], v[188:191], v[80:83]
    ds_read_b64_tr_b16 v[172:173], v16 offset:32
    v_mfma_f32_16x16x32_bf16 v[148:151], v[180:183], v[188:191], v[148:151]
    ds_read_b64_tr_b16 v[174:175], v16 offset:288
    v_mfma_f32_16x16x32_bf16 v[84:87], v[176:179], v[192:195], v[84:87]
    ds_read_b128 v[208:211], v14 offset:0
    v_mfma_f32_16x16x32_bf16 v[152:155], v[180:183], v[192:195], v[152:155]
    ds_read_b128 v[212:215], v14 offset:2048
    v_mfma_f32_16x16x32_bf16 v[88:91], v[176:179], v[196:199], v[88:91]
    v_mfma_f32_16x16x32_bf16 v[156:159], v[180:183], v[196:199], v[156:159]
    ds_read_b128 v[184:187], v14 offset:4096
    v_mfma_f32_16x16x32_bf16 v[92:95], v[176:179], v[200:203], v[92:95]
    v_mfma_f32_16x16x32_bf16 v[160:163], v[180:183], v[200:203], v[160:163]
    ds_read_b128 v[188:191], v14 offset:6144
    v_mfma_f32_16x16x32_bf16 v[96:99], v[176:179], v[204:207], v[96:99]
    ds_read_b128 v[192:195], v14 offset:8192
    v_mfma_f32_16x16x32_bf16 v[164:167], v[180:183], v[204:207], v[164:167]
    s_waitcnt lgkmcnt(4)
    v_mfma_f32_16x16x32_bf16 v[32:35], v[168:171], v[208:211], v[32:35]
    ds_read_b128 v[196:199], v14 offset:10240
    v_mfma_f32_16x16x32_bf16 v[100:103], v[172:175], v[208:211], v[100:103]
    s_waitcnt lgkmcnt(4)
    v_mfma_f32_16x16x32_bf16 v[36:39], v[168:171], v[212:215], v[36:39]
    ds_read_b128 v[200:203], v14 offset:12288
    v_mfma_f32_16x16x32_bf16 v[104:107], v[172:175], v[212:215], v[104:107]
    ds_read_b128 v[204:207], v14 offset:14336
    s_waitcnt lgkmcnt(5)
    v_mfma_f32_16x16x32_bf16 v[40:43], v[168:171], v[184:187], v[40:43]
    v_mfma_f32_16x16x32_bf16 v[108:111], v[172:175], v[184:187], v[108:111]
    ds_read_b128 v[208:211], v14 offset:16384
    s_waitcnt lgkmcnt(5)
    v_mfma_f32_16x16x32_bf16 v[44:47], v[168:171], v[188:191], v[44:47]
    v_mfma_f32_16x16x32_bf16 v[112:115], v[172:175], v[188:191], v[112:115]
    ds_read_b128 v[212:215], v14 offset:18432
    s_waitcnt lgkmcnt(5)
    v_mfma_f32_16x16x32_bf16 v[48:51], v[168:171], v[192:195], v[48:51]
    ds_read_b128 v[184:187], v14 offset:20480
    v_mfma_f32_16x16x32_bf16 v[116:119], v[172:175], v[192:195], v[116:119]
    s_waitcnt lgkmcnt(5)
    v_mfma_f32_16x16x32_bf16 v[52:55], v[168:171], v[196:199], v[52:55]
    ds_read_b128 v[188:191], v14 offset:22528
    v_mfma_f32_16x16x32_bf16 v[120:123], v[172:175], v[196:199], v[120:123]
    s_waitcnt lgkmcnt(5)
    v_mfma_f32_16x16x32_bf16 v[56:59], v[168:171], v[200:203], v[56:59]
    ds_read_b128 v[192:195], v14 offset:24576
    v_mfma_f32_16x16x32_bf16 v[124:127], v[172:175], v[200:203], v[124:127]
    ds_read_b128 v[196:199], v14 offset:26624
    s_waitcnt lgkmcnt(6)
    v_mfma_f32_16x16x32_bf16 v[60:63], v[168:171], v[204:207], v[60:63]
    v_mfma_f32_16x16x32_bf16 v[128:131], v[172:175], v[204:207], v[128:131]
    ds_read_b128 v[200:203], v14 offset:28672
    s_waitcnt lgkmcnt(6)
    v_mfma_f32_16x16x32_bf16 v[64:67], v[168:171], v[208:211], v[64:67]
    v_mfma_f32_16x16x32_bf16 v[132:135], v[172:175], v[208:211], v[132:135]
    ds_read_b128 v[204:207], v14 offset:30720
    s_waitcnt lgkmcnt(6)
    v_mfma_f32_16x16x32_bf16 v[68:71], v[168:171], v[212:215], v[68:71]
    ds_read_b128 v[208:211], v14 offset:32768
    v_mfma_f32_16x16x32_bf16 v[136:139], v[172:175], v[212:215], v[136:139]
    s_waitcnt lgkmcnt(6)
    v_mfma_f32_16x16x32_bf16 v[72:75], v[168:171], v[184:187], v[72:75]
    ds_read_b64_tr_b16 v[176:177], v16 offset:8448
    v_mfma_f32_16x16x32_bf16 v[140:143], v[172:175], v[184:187], v[140:143]
    ds_read_b64_tr_b16 v[178:179], v16 offset:8704
    s_waitcnt lgkmcnt(7)
    v_mfma_f32_16x16x32_bf16 v[76:79], v[168:171], v[188:191], v[76:79]
    ds_read_b64_tr_b16 v[180:181], v16 offset:8480
    ds_read_b64_tr_b16 v[182:183], v16 offset:8736
    v_mfma_f32_16x16x32_bf16 v[144:147], v[172:175], v[188:191], v[144:147]
    ds_read_b128 v[212:215], v15 offset:0
    s_waitcnt lgkmcnt(9)
    v_mfma_f32_16x16x32_bf16 v[80:83], v[168:171], v[192:195], v[80:83]
    v_mfma_f32_16x16x32_bf16 v[148:151], v[172:175], v[192:195], v[148:151]
    ds_read_b128 v[184:187], v15 offset:2048
    s_waitcnt lgkmcnt(9)
    v_mfma_f32_16x16x32_bf16 v[84:87], v[168:171], v[196:199], v[84:87]
    v_mfma_f32_16x16x32_bf16 v[152:155], v[172:175], v[196:199], v[152:155]
    ds_read_b128 v[188:191], v15 offset:4096
    s_waitcnt lgkmcnt(9)
    v_mfma_f32_16x16x32_bf16 v[88:91], v[168:171], v[200:203], v[88:91]
    ds_read_b128 v[192:195], v15 offset:6144
    v_mfma_f32_16x16x32_bf16 v[156:159], v[172:175], v[200:203], v[156:159]
    s_waitcnt lgkmcnt(9)
    v_mfma_f32_16x16x32_bf16 v[92:95], v[168:171], v[204:207], v[92:95]
    ds_read_b128 v[196:199], v15 offset:8192
    v_mfma_f32_16x16x32_bf16 v[160:163], v[172:175], v[204:207], v[160:163]
    s_waitcnt lgkmcnt(9)
    v_mfma_f32_16x16x32_bf16 v[96:99], v[168:171], v[208:211], v[96:99]
    ds_read_b128 v[200:203], v15 offset:10240
    v_mfma_f32_16x16x32_bf16 v[164:167], v[172:175], v[208:211], v[164:167]
    ds_read_b128 v[204:207], v15 offset:12288
    s_waitcnt lgkmcnt(6)
    v_mfma_f32_16x16x32_bf16 v[32:35], v[176:179], v[212:215], v[32:35]
    v_mfma_f32_16x16x32_bf16 v[100:103], v[180:183], v[212:215], v[100:103]
    ds_read_b128 v[208:211], v15 offset:14336
    s_waitcnt lgkmcnt(6)
    v_mfma_f32_16x16x32_bf16 v[36:39], v[176:179], v[184:187], v[36:39]
    v_mfma_f32_16x16x32_bf16 v[104:107], v[180:183], v[184:187], v[104:107]
    ds_read_b128 v[212:215], v15 offset:16384
    s_waitcnt lgkmcnt(6)
    v_mfma_f32_16x16x32_bf16 v[40:43], v[176:179], v[188:191], v[40:43]
    ds_read_b128 v[184:187], v15 offset:18432
    v_mfma_f32_16x16x32_bf16 v[108:111], v[180:183], v[188:191], v[108:111]
    s_waitcnt lgkmcnt(6)
    v_mfma_f32_16x16x32_bf16 v[44:47], v[176:179], v[192:195], v[44:47]
    ds_read_b128 v[188:191], v15 offset:20480
    v_mfma_f32_16x16x32_bf16 v[112:115], v[180:183], v[192:195], v[112:115]
    s_waitcnt lgkmcnt(6)
    v_mfma_f32_16x16x32_bf16 v[48:51], v[176:179], v[196:199], v[48:51]
    ds_read_b128 v[192:195], v15 offset:22528
    v_mfma_f32_16x16x32_bf16 v[116:119], v[180:183], v[196:199], v[116:119]
    ds_read_b128 v[196:199], v15 offset:24576
    s_waitcnt lgkmcnt(7)
    v_mfma_f32_16x16x32_bf16 v[52:55], v[176:179], v[200:203], v[52:55]
    v_mfma_f32_16x16x32_bf16 v[120:123], v[180:183], v[200:203], v[120:123]
    ds_read_b128 v[200:203], v15 offset:26624
    s_waitcnt lgkmcnt(7)
    v_mfma_f32_16x16x32_bf16 v[56:59], v[176:179], v[204:207], v[56:59]
    v_mfma_f32_16x16x32_bf16 v[124:127], v[180:183], v[204:207], v[124:127]
    ds_read_b128 v[204:207], v15 offset:28672
    s_waitcnt lgkmcnt(7)
    v_mfma_f32_16x16x32_bf16 v[60:63], v[176:179], v[208:211], v[60:63]
    v_mfma_f32_16x16x32_bf16 v[128:131], v[180:183], v[208:211], v[128:131]
    ds_read_b128 v[208:211], v15 offset:30720
    s_waitcnt lgkmcnt(7)
    v_mfma_f32_16x16x32_bf16 v[64:67], v[176:179], v[212:215], v[64:67]
    v_mfma_f32_16x16x32_bf16 v[132:135], v[180:183], v[212:215], v[132:135]
    ds_read_b128 v[212:215], v15 offset:32768
    s_waitcnt lgkmcnt(7)
    v_mfma_f32_16x16x32_bf16 v[68:71], v[176:179], v[184:187], v[68:71]
    v_mfma_f32_16x16x32_bf16 v[136:139], v[180:183], v[184:187], v[136:139]
    s_waitcnt lgkmcnt(6)
    v_mfma_f32_16x16x32_bf16 v[72:75], v[176:179], v[188:191], v[72:75]
    v_mfma_f32_16x16x32_bf16 v[140:143], v[180:183], v[188:191], v[140:143]
    s_waitcnt lgkmcnt(5)
    v_mfma_f32_16x16x32_bf16 v[76:79], v[176:179], v[192:195], v[76:79]
    v_mfma_f32_16x16x32_bf16 v[144:147], v[180:183], v[192:195], v[144:147]
    s_waitcnt lgkmcnt(0)
    v_add_u32 v14, 103424, v3
    v_add_u32 v15, 103424, v4
    v_add_u32 v16, 138240, v5
    s_barrier
    ds_read_b64_tr_b16 v[168:169], v16 offset:0
    ds_read_b64_tr_b16 v[170:171], v16 offset:256
    v_mfma_f32_16x16x32_bf16 v[80:83], v[176:179], v[196:199], v[80:83]
    ds_read_b64_tr_b16 v[172:173], v16 offset:32
    v_mfma_f32_16x16x32_bf16 v[148:151], v[180:183], v[196:199], v[148:151]
    ds_read_b64_tr_b16 v[174:175], v16 offset:288
    v_mfma_f32_16x16x32_bf16 v[84:87], v[176:179], v[200:203], v[84:87]
    ds_read_b128 v[184:187], v14 offset:0
    v_mfma_f32_16x16x32_bf16 v[152:155], v[180:183], v[200:203], v[152:155]
    ds_read_b128 v[188:191], v14 offset:2048
    v_mfma_f32_16x16x32_bf16 v[88:91], v[176:179], v[204:207], v[88:91]
    v_mfma_f32_16x16x32_bf16 v[156:159], v[180:183], v[204:207], v[156:159]
    ds_read_b128 v[192:195], v14 offset:4096
    v_mfma_f32_16x16x32_bf16 v[92:95], v[176:179], v[208:211], v[92:95]
    v_mfma_f32_16x16x32_bf16 v[160:163], v[180:183], v[208:211], v[160:163]
    ds_read_b128 v[196:199], v14 offset:6144
    v_mfma_f32_16x16x32_bf16 v[96:99], v[176:179], v[212:215], v[96:99]
    ds_read_b128 v[200:203], v14 offset:8192
    v_mfma_f32_16x16x32_bf16 v[164:167], v[180:183], v[212:215], v[164:167]
    s_waitcnt lgkmcnt(4)
    v_mfma_f32_16x16x32_bf16 v[32:35], v[168:171], v[184:187], v[32:35]
    ds_read_b128 v[204:207], v14 offset:10240
    v_mfma_f32_16x16x32_bf16 v[100:103], v[172:175], v[184:187], v[100:103]
    s_waitcnt lgkmcnt(4)
    v_mfma_f32_16x16x32_bf16 v[36:39], v[168:171], v[188:191], v[36:39]
    ds_read_b128 v[208:211], v14 offset:12288
    v_mfma_f32_16x16x32_bf16 v[104:107], v[172:175], v[188:191], v[104:107]
    ds_read_b128 v[212:215], v14 offset:14336
    s_waitcnt lgkmcnt(5)
    v_mfma_f32_16x16x32_bf16 v[40:43], v[168:171], v[192:195], v[40:43]
    v_mfma_f32_16x16x32_bf16 v[108:111], v[172:175], v[192:195], v[108:111]
    ds_read_b128 v[184:187], v14 offset:16384
    s_waitcnt lgkmcnt(5)
    v_mfma_f32_16x16x32_bf16 v[44:47], v[168:171], v[196:199], v[44:47]
    v_mfma_f32_16x16x32_bf16 v[112:115], v[172:175], v[196:199], v[112:115]
    ds_read_b128 v[188:191], v14 offset:18432
    s_waitcnt lgkmcnt(5)
    v_mfma_f32_16x16x32_bf16 v[48:51], v[168:171], v[200:203], v[48:51]
    ds_read_b128 v[192:195], v14 offset:20480
    v_mfma_f32_16x16x32_bf16 v[116:119], v[172:175], v[200:203], v[116:119]
    s_waitcnt lgkmcnt(5)
    v_mfma_f32_16x16x32_bf16 v[52:55], v[168:171], v[204:207], v[52:55]
    ds_read_b128 v[196:199], v14 offset:22528
    v_mfma_f32_16x16x32_bf16 v[120:123], v[172:175], v[204:207], v[120:123]
    s_waitcnt lgkmcnt(5)
    v_mfma_f32_16x16x32_bf16 v[56:59], v[168:171], v[208:211], v[56:59]
    ds_read_b128 v[200:203], v14 offset:24576
    v_mfma_f32_16x16x32_bf16 v[124:127], v[172:175], v[208:211], v[124:127]
    ds_read_b128 v[204:207], v14 offset:26624
    s_waitcnt lgkmcnt(6)
    v_mfma_f32_16x16x32_bf16 v[60:63], v[168:171], v[212:215], v[60:63]
    v_mfma_f32_16x16x32_bf16 v[128:131], v[172:175], v[212:215], v[128:131]
    ds_read_b128 v[208:211], v14 offset:28672
    s_waitcnt lgkmcnt(6)
    v_mfma_f32_16x16x32_bf16 v[64:67], v[168:171], v[184:187], v[64:67]
    v_mfma_f32_16x16x32_bf16 v[132:135], v[172:175], v[184:187], v[132:135]
    ds_read_b128 v[212:215], v14 offset:30720
    s_waitcnt lgkmcnt(6)
    v_mfma_f32_16x16x32_bf16 v[68:71], v[168:171], v[188:191], v[68:71]
    ds_read_b128 v[184:187], v14 offset:32768
    v_mfma_f32_16x16x32_bf16 v[136:139], v[172:175], v[188:191], v[136:139]
    s_waitcnt lgkmcnt(6)
    v_mfma_f32_16x16x32_bf16 v[72:75], v[168:171], v[192:195], v[72:75]
    ds_read_b64_tr_b16 v[176:177], v16 offset:8448
    v_mfma_f32_16x16x32_bf16 v[140:143], v[172:175], v[192:195], v[140:143]
    ds_read_b64_tr_b16 v[178:179], v16 offset:8704
    s_waitcnt lgkmcnt(7)
    v_mfma_f32_16x16x32_bf16 v[76:79], v[168:171], v[196:199], v[76:79]
    ds_read_b64_tr_b16 v[180:181], v16 offset:8480
    ds_read_b64_tr_b16 v[182:183], v16 offset:8736
    v_mfma_f32_16x16x32_bf16 v[144:147], v[172:175], v[196:199], v[144:147]
    ds_read_b128 v[188:191], v15 offset:0
    s_waitcnt lgkmcnt(9)
    v_mfma_f32_16x16x32_bf16 v[80:83], v[168:171], v[200:203], v[80:83]
    v_mfma_f32_16x16x32_bf16 v[148:151], v[172:175], v[200:203], v[148:151]
    ds_read_b128 v[192:195], v15 offset:2048
    s_waitcnt lgkmcnt(9)
    v_mfma_f32_16x16x32_bf16 v[84:87], v[168:171], v[204:207], v[84:87]
    v_mfma_f32_16x16x32_bf16 v[152:155], v[172:175], v[204:207], v[152:155]
    ds_read_b128 v[196:199], v15 offset:4096
    s_waitcnt lgkmcnt(9)
    v_mfma_f32_16x16x32_bf16 v[88:91], v[168:171], v[208:211], v[88:91]
    ds_read_b128 v[200:203], v15 offset:6144
    v_mfma_f32_16x16x32_bf16 v[156:159], v[172:175], v[208:211], v[156:159]
    s_waitcnt lgkmcnt(9)
    v_mfma_f32_16x16x32_bf16 v[92:95], v[168:171], v[212:215], v[92:95]
    ds_read_b128 v[204:207], v15 offset:8192
    v_mfma_f32_16x16x32_bf16 v[160:163], v[172:175], v[212:215], v[160:163]
    s_waitcnt lgkmcnt(9)
    v_mfma_f32_16x16x32_bf16 v[96:99], v[168:171], v[184:187], v[96:99]
    ds_read_b128 v[208:211], v15 offset:10240
    v_mfma_f32_16x16x32_bf16 v[164:167], v[172:175], v[184:187], v[164:167]
    ds_read_b128 v[212:215], v15 offset:12288
    s_waitcnt lgkmcnt(6)
    v_mfma_f32_16x16x32_bf16 v[32:35], v[176:179], v[188:191], v[32:35]
    v_mfma_f32_16x16x32_bf16 v[100:103], v[180:183], v[188:191], v[100:103]
    ds_read_b128 v[184:187], v15 offset:14336
    s_waitcnt lgkmcnt(6)
    v_mfma_f32_16x16x32_bf16 v[36:39], v[176:179], v[192:195], v[36:39]
    v_mfma_f32_16x16x32_bf16 v[104:107], v[180:183], v[192:195], v[104:107]
    ds_read_b128 v[188:191], v15 offset:16384
    s_waitcnt lgkmcnt(6)
    v_mfma_f32_16x16x32_bf16 v[40:43], v[176:179], v[196:199], v[40:43]
    ds_read_b128 v[192:195], v15 offset:18432
    v_mfma_f32_16x16x32_bf16 v[108:111], v[180:183], v[196:199], v[108:111]
    s_waitcnt lgkmcnt(6)
    v_mfma_f32_16x16x32_bf16 v[44:47], v[176:179], v[200:203], v[44:47]
    ds_read_b128 v[196:199], v15 offset:20480
    v_mfma_f32_16x16x32_bf16 v[112:115], v[180:183], v[200:203], v[112:115]
    s_waitcnt lgkmcnt(6)
    v_mfma_f32_16x16x32_bf16 v[48:51], v[176:179], v[204:207], v[48:51]
    ds_read_b128 v[200:203], v15 offset:22528
    v_mfma_f32_16x16x32_bf16 v[116:119], v[180:183], v[204:207], v[116:119]
    ds_read_b128 v[204:207], v15 offset:24576
    s_waitcnt lgkmcnt(7)
    v_mfma_f32_16x16x32_bf16 v[52:55], v[176:179], v[208:211], v[52:55]
    v_mfma_f32_16x16x32_bf16 v[120:123], v[180:183], v[208:211], v[120:123]
    ds_read_b128 v[208:211], v15 offset:26624
    s_waitcnt lgkmcnt(7)
    v_mfma_f32_16x16x32_bf16 v[56:59], v[176:179], v[212:215], v[56:59]
    v_mfma_f32_16x16x32_bf16 v[124:127], v[180:183], v[212:215], v[124:127]
    ds_read_b128 v[212:215], v15 offset:28672
    s_waitcnt lgkmcnt(7)
    v_mfma_f32_16x16x32_bf16 v[60:63], v[176:179], v[184:187], v[60:63]
    v_mfma_f32_16x16x32_bf16 v[128:131], v[180:183], v[184:187], v[128:131]
    ds_read_b128 v[184:187], v15 offset:30720
    s_waitcnt lgkmcnt(7)
    v_mfma_f32_16x16x32_bf16 v[64:67], v[176:179], v[188:191], v[64:67]
    v_mfma_f32_16x16x32_bf16 v[132:135], v[180:183], v[188:191], v[132:135]
    ds_read_b128 v[188:191], v15 offset:32768
    s_waitcnt lgkmcnt(7)
    v_mfma_f32_16x16x32_bf16 v[68:71], v[176:179], v[192:195], v[68:71]
    v_mfma_f32_16x16x32_bf16 v[136:139], v[180:183], v[192:195], v[136:139]
    s_waitcnt lgkmcnt(6)
    v_mfma_f32_16x16x32_bf16 v[72:75], v[176:179], v[196:199], v[72:75]
    v_mfma_f32_16x16x32_bf16 v[140:143], v[180:183], v[196:199], v[140:143]
    s_waitcnt lgkmcnt(5)
    v_mfma_f32_16x16x32_bf16 v[76:79], v[176:179], v[200:203], v[76:79]
    v_mfma_f32_16x16x32_bf16 v[144:147], v[180:183], v[200:203], v[144:147]
    s_waitcnt lgkmcnt(0)
    v_add_u32 v14, 0, v3
    v_add_u32 v15, 0, v4
    v_add_u32 v16, 34816, v5
    s_barrier
    ds_read_b64_tr_b16 v[168:169], v16 offset:0
    ds_read_b64_tr_b16 v[170:171], v16 offset:256
    v_mfma_f32_16x16x32_bf16 v[80:83], v[176:179], v[204:207], v[80:83]
    ds_read_b64_tr_b16 v[172:173], v16 offset:32
    v_mfma_f32_16x16x32_bf16 v[148:151], v[180:183], v[204:207], v[148:151]
    ds_read_b64_tr_b16 v[174:175], v16 offset:288
    v_mfma_f32_16x16x32_bf16 v[84:87], v[176:179], v[208:211], v[84:87]
    ds_read_b128 v[192:195], v14 offset:0
    v_mfma_f32_16x16x32_bf16 v[152:155], v[180:183], v[208:211], v[152:155]
    ds_read_b128 v[196:199], v14 offset:2048
    v_mfma_f32_16x16x32_bf16 v[88:91], v[176:179], v[212:215], v[88:91]
    v_mfma_f32_16x16x32_bf16 v[156:159], v[180:183], v[212:215], v[156:159]
    ds_read_b128 v[200:203], v14 offset:4096
    v_mfma_f32_16x16x32_bf16 v[92:95], v[176:179], v[184:187], v[92:95]
    v_mfma_f32_16x16x32_bf16 v[160:163], v[180:183], v[184:187], v[160:163]
    ds_read_b128 v[204:207], v14 offset:6144
    v_mfma_f32_16x16x32_bf16 v[96:99], v[176:179], v[188:191], v[96:99]
    ds_read_b128 v[208:211], v14 offset:8192
    v_mfma_f32_16x16x32_bf16 v[164:167], v[180:183], v[188:191], v[164:167]
    s_waitcnt lgkmcnt(4)
    v_mfma_f32_16x16x32_bf16 v[32:35], v[168:171], v[192:195], v[32:35]
    ds_read_b128 v[212:215], v14 offset:10240
    v_mfma_f32_16x16x32_bf16 v[100:103], v[172:175], v[192:195], v[100:103]
    s_waitcnt lgkmcnt(4)
    v_mfma_f32_16x16x32_bf16 v[36:39], v[168:171], v[196:199], v[36:39]
    ds_read_b128 v[184:187], v14 offset:12288
    v_mfma_f32_16x16x32_bf16 v[104:107], v[172:175], v[196:199], v[104:107]
    ds_read_b128 v[188:191], v14 offset:14336
    s_waitcnt lgkmcnt(5)
    v_mfma_f32_16x16x32_bf16 v[40:43], v[168:171], v[200:203], v[40:43]
    v_mfma_f32_16x16x32_bf16 v[108:111], v[172:175], v[200:203], v[108:111]
    ds_read_b128 v[192:195], v14 offset:16384
    s_waitcnt lgkmcnt(5)
    v_mfma_f32_16x16x32_bf16 v[44:47], v[168:171], v[204:207], v[44:47]
    v_mfma_f32_16x16x32_bf16 v[112:115], v[172:175], v[204:207], v[112:115]
    ds_read_b128 v[196:199], v14 offset:18432
    s_waitcnt lgkmcnt(5)
    v_mfma_f32_16x16x32_bf16 v[48:51], v[168:171], v[208:211], v[48:51]
    ds_read_b128 v[200:203], v14 offset:20480
    v_mfma_f32_16x16x32_bf16 v[116:119], v[172:175], v[208:211], v[116:119]
    s_waitcnt lgkmcnt(5)
    v_mfma_f32_16x16x32_bf16 v[52:55], v[168:171], v[212:215], v[52:55]
    ds_read_b128 v[204:207], v14 offset:22528
    v_mfma_f32_16x16x32_bf16 v[120:123], v[172:175], v[212:215], v[120:123]
    s_waitcnt lgkmcnt(5)
    v_mfma_f32_16x16x32_bf16 v[56:59], v[168:171], v[184:187], v[56:59]
    ds_read_b128 v[208:211], v14 offset:24576
    v_mfma_f32_16x16x32_bf16 v[124:127], v[172:175], v[184:187], v[124:127]
    ds_read_b128 v[212:215], v14 offset:26624
    s_waitcnt lgkmcnt(6)
    v_mfma_f32_16x16x32_bf16 v[60:63], v[168:171], v[188:191], v[60:63]
    v_mfma_f32_16x16x32_bf16 v[128:131], v[172:175], v[188:191], v[128:131]
    ds_read_b128 v[184:187], v14 offset:28672
    s_waitcnt lgkmcnt(6)
    v_mfma_f32_16x16x32_bf16 v[64:67], v[168:171], v[192:195], v[64:67]
    v_mfma_f32_16x16x32_bf16 v[132:135], v[172:175], v[192:195], v[132:135]
    ds_read_b128 v[188:191], v14 offset:30720
    s_waitcnt lgkmcnt(6)
    v_mfma_f32_16x16x32_bf16 v[68:71], v[168:171], v[196:199], v[68:71]
    ds_read_b128 v[192:195], v14 offset:32768
    v_mfma_f32_16x16x32_bf16 v[136:139], v[172:175], v[196:199], v[136:139]
    s_waitcnt lgkmcnt(6)
    v_mfma_f32_16x16x32_bf16 v[72:75], v[168:171], v[200:203], v[72:75]
    ds_read_b64_tr_b16 v[176:177], v16 offset:8448
    v_mfma_f32_16x16x32_bf16 v[140:143], v[172:175], v[200:203], v[140:143]
    ds_read_b64_tr_b16 v[178:179], v16 offset:8704
    s_waitcnt lgkmcnt(7)
    v_mfma_f32_16x16x32_bf16 v[76:79], v[168:171], v[204:207], v[76:79]
    ds_read_b64_tr_b16 v[180:181], v16 offset:8480
    ds_read_b64_tr_b16 v[182:183], v16 offset:8736
    v_mfma_f32_16x16x32_bf16 v[144:147], v[172:175], v[204:207], v[144:147]
    ds_read_b128 v[196:199], v15 offset:0
    s_waitcnt lgkmcnt(9)
    v_mfma_f32_16x16x32_bf16 v[80:83], v[168:171], v[208:211], v[80:83]
    v_mfma_f32_16x16x32_bf16 v[148:151], v[172:175], v[208:211], v[148:151]
    ds_read_b128 v[200:203], v15 offset:2048
    s_waitcnt lgkmcnt(9)
    v_mfma_f32_16x16x32_bf16 v[84:87], v[168:171], v[212:215], v[84:87]
    v_mfma_f32_16x16x32_bf16 v[152:155], v[172:175], v[212:215], v[152:155]
    ds_read_b128 v[204:207], v15 offset:4096
    s_waitcnt lgkmcnt(9)
    v_mfma_f32_16x16x32_bf16 v[88:91], v[168:171], v[184:187], v[88:91]
    ds_read_b128 v[208:211], v15 offset:6144
    v_mfma_f32_16x16x32_bf16 v[156:159], v[172:175], v[184:187], v[156:159]
    s_waitcnt lgkmcnt(9)
    v_mfma_f32_16x16x32_bf16 v[92:95], v[168:171], v[188:191], v[92:95]
    ds_read_b128 v[212:215], v15 offset:8192
    v_mfma_f32_16x16x32_bf16 v[160:163], v[172:175], v[188:191], v[160:163]
    s_waitcnt lgkmcnt(9)
    v_mfma_f32_16x16x32_bf16 v[96:99], v[168:171], v[192:195], v[96:99]
    ds_read_b128 v[184:187], v15 offset:10240
    v_mfma_f32_16x16x32_bf16 v[164:167], v[172:175], v[192:195], v[164:167]
    ds_read_b128 v[188:191], v15 offset:12288
    s_waitcnt lgkmcnt(6)
    v_mfma_f32_16x16x32_bf16 v[32:35], v[176:179], v[196:199], v[32:35]
    v_mfma_f32_16x16x32_bf16 v[100:103], v[180:183], v[196:199], v[100:103]
    ds_read_b128 v[192:195], v15 offset:14336
    s_waitcnt lgkmcnt(6)
    v_mfma_f32_16x16x32_bf16 v[36:39], v[176:179], v[200:203], v[36:39]
    v_mfma_f32_16x16x32_bf16 v[104:107], v[180:183], v[200:203], v[104:107]
    ds_read_b128 v[196:199], v15 offset:16384
    s_waitcnt lgkmcnt(6)
    v_mfma_f32_16x16x32_bf16 v[40:43], v[176:179], v[204:207], v[40:43]
    ds_read_b128 v[200:203], v15 offset:18432
    v_mfma_f32_16x16x32_bf16 v[108:111], v[180:183], v[204:207], v[108:111]
    s_waitcnt lgkmcnt(6)
    v_mfma_f32_16x16x32_bf16 v[44:47], v[176:179], v[208:211], v[44:47]
    ds_read_b128 v[204:207], v15 offset:20480
    v_mfma_f32_16x16x32_bf16 v[112:115], v[180:183], v[208:211], v[112:115]
    s_waitcnt lgkmcnt(6)
    v_mfma_f32_16x16x32_bf16 v[48:51], v[176:179], v[212:215], v[48:51]
    ds_read_b128 v[208:211], v15 offset:22528
    v_mfma_f32_16x16x32_bf16 v[116:119], v[180:183], v[212:215], v[116:119]
    ds_read_b128 v[212:215], v15 offset:24576
    s_waitcnt lgkmcnt(7)
    v_mfma_f32_16x16x32_bf16 v[52:55], v[176:179], v[184:187], v[52:55]
    v_mfma_f32_16x16x32_bf16 v[120:123], v[180:183], v[184:187], v[120:123]
    ds_read_b128 v[184:187], v15 offset:26624
    s_waitcnt lgkmcnt(7)
    v_mfma_f32_16x16x32_bf16 v[56:59], v[176:179], v[188:191], v[56:59]
    v_mfma_f32_16x16x32_bf16 v[124:127], v[180:183], v[188:191], v[124:127]
    ds_read_b128 v[188:191], v15 offset:28672
    s_waitcnt lgkmcnt(7)
    v_mfma_f32_16x16x32_bf16 v[60:63], v[176:179], v[192:195], v[60:63]
    v_mfma_f32_16x16x32_bf16 v[128:131], v[180:183], v[192:195], v[128:131]
    ds_read_b128 v[192:195], v15 offset:30720
    s_waitcnt lgkmcnt(7)
    v_mfma_f32_16x16x32_bf16 v[64:67], v[176:179], v[196:199], v[64:67]
    v_mfma_f32_16x16x32_bf16 v[132:135], v[180:183], v[196:199], v[132:135]
    ds_read_b128 v[196:199], v15 offset:32768
    s_waitcnt lgkmcnt(7)
    v_mfma_f32_16x16x32_bf16 v[68:71], v[176:179], v[200:203], v[68:71]
    v_mfma_f32_16x16x32_bf16 v[136:139], v[180:183], v[200:203], v[136:139]
    s_waitcnt lgkmcnt(6)
    v_mfma_f32_16x16x32_bf16 v[72:75], v[176:179], v[204:207], v[72:75]
    v_mfma_f32_16x16x32_bf16 v[140:143], v[180:183], v[204:207], v[140:143]
    s_waitcnt lgkmcnt(5)
    v_mfma_f32_16x16x32_bf16 v[76:79], v[176:179], v[208:211], v[76:79]
    v_mfma_f32_16x16x32_bf16 v[144:147], v[180:183], v[208:211], v[144:147]
    s_waitcnt lgkmcnt(0)
    v_mfma_f32_16x16x32_bf16 v[80:83], v[176:179], v[212:215], v[80:83]
    v_mfma_f32_16x16x32_bf16 v[148:151], v[180:183], v[212:215], v[148:151]
    v_cvt_pk_bf16_f32 v32, v32, v33
    v_cvt_pk_bf16_f32 v33, v34, v35
    ds_write_b64 v252, v[32:33]
    v_add_u32 v252, s70, v252
    v_cvt_pk_bf16_f32 v100, v100, v101
    v_cvt_pk_bf16_f32 v101, v102, v103
    ds_write_b64 v253, v[100:101]
    v_add_u32 v253, s71, v253
    v_mfma_f32_16x16x32_bf16 v[84:87], v[176:179], v[184:187], v[84:87]
    v_mfma_f32_16x16x32_bf16 v[152:155], v[180:183], v[184:187], v[152:155]
    v_cvt_pk_bf16_f32 v36, v36, v37
    v_cvt_pk_bf16_f32 v37, v38, v39
    ds_write_b64 v252, v[36:37]
    v_add_u32 v252, s70, v252
    v_cvt_pk_bf16_f32 v104, v104, v105
    v_cvt_pk_bf16_f32 v105, v106, v107
    ds_write_b64 v253, v[104:105]
    v_add_u32 v253, s71, v253
    v_mfma_f32_16x16x32_bf16 v[88:91], v[176:179], v[188:191], v[88:91]
    v_mfma_f32_16x16x32_bf16 v[156:159], v[180:183], v[188:191], v[156:159]
    v_cvt_pk_bf16_f32 v40, v40, v41
    v_cvt_pk_bf16_f32 v41, v42, v43
    ds_write_b64 v252, v[40:41]
    v_add_u32 v252, s70, v252
    v_cvt_pk_bf16_f32 v108, v108, v109
    v_cvt_pk_bf16_f32 v109, v110, v111
    ds_write_b64 v253, v[108:109]
    v_add_u32 v253, s71, v253
    v_mfma_f32_16x16x32_bf16 v[92:95], v[176:179], v[192:195], v[92:95]
    v_mfma_f32_16x16x32_bf16 v[160:163], v[180:183], v[192:195], v[160:163]
    v_cvt_pk_bf16_f32 v44, v44, v45
    v_cvt_pk_bf16_f32 v45, v46, v47
    ds_write_b64 v252, v[44:45]
    v_add_u32 v252, s70, v252
    v_cvt_pk_bf16_f32 v112, v112, v113
    v_cvt_pk_bf16_f32 v113, v114, v115
    ds_write_b64 v253, v[112:113]
    v_add_u32 v253, s71, v253
    v_mfma_f32_16x16x32_bf16 v[96:99], v[176:179], v[196:199], v[96:99]
    v_mfma_f32_16x16x32_bf16 v[164:167], v[180:183], v[196:199], v[164:167]
    v_cvt_pk_bf16_f32 v48, v48, v49
    v_cvt_pk_bf16_f32 v49, v50, v51
    ds_write_b64 v252, v[48:49]
    v_add_u32 v252, s70, v252
    v_cvt_pk_bf16_f32 v116, v116, v117
    v_cvt_pk_bf16_f32 v117, v118, v119
    ds_write_b64 v253, v[116:117]
    v_add_u32 v253, s71, v253
    v_cvt_pk_bf16_f32 v52, v52, v53
    v_cvt_pk_bf16_f32 v53, v54, v55
    ds_write_b64 v252, v[52:53]
    v_add_u32 v252, s70, v252
    v_cvt_pk_bf16_f32 v120, v120, v121
    v_cvt_pk_bf16_f32 v121, v122, v123
    ds_write_b64 v253, v[120:121]
    v_add_u32 v253, s71, v253
    v_cvt_pk_bf16_f32 v56, v56, v57
    v_cvt_pk_bf16_f32 v57, v58, v59
    ds_write_b64 v252, v[56:57]
    v_add_u32 v252, s70, v252
    v_cvt_pk_bf16_f32 v124, v124, v125
    v_cvt_pk_bf16_f32 v125, v126, v127
    ds_write_b64 v253, v[124:125]
    v_add_u32 v253, s71, v253
    v_cvt_pk_bf16_f32 v60, v60, v61
    v_cvt_pk_bf16_f32 v61, v62, v63
    ds_write_b64 v252, v[60:61]
    v_add_u32 v252, s70, v252
    v_cvt_pk_bf16_f32 v128, v128, v129
    v_cvt_pk_bf16_f32 v129, v130, v131
    ds_write_b64 v253, v[128:129]
    v_add_u32 v253, s71, v253
    v_cvt_pk_bf16_f32 v64, v64, v65
    v_cvt_pk_bf16_f32 v65, v66, v67
    ds_write_b64 v252, v[64:65]
    v_add_u32 v252, s70, v252
    v_cvt_pk_bf16_f32 v132, v132, v133
    v_cvt_pk_bf16_f32 v133, v134, v135
    ds_write_b64 v253, v[132:133]
    v_add_u32 v253, s71, v253
    v_cvt_pk_bf16_f32 v68, v68, v69
    v_cvt_pk_bf16_f32 v69, v70, v71
    ds_write_b64 v252, v[68:69]
    v_add_u32 v252, s70, v252
    v_cvt_pk_bf16_f32 v136, v136, v137
    v_cvt_pk_bf16_f32 v137, v138, v139
    ds_write_b64 v253, v[136:137]
    v_add_u32 v253, s71, v253
    v_cvt_pk_bf16_f32 v72, v72, v73
    v_cvt_pk_bf16_f32 v73, v74, v75
    ds_write_b64 v252, v[72:73]
    v_add_u32 v252, s70, v252
    v_cvt_pk_bf16_f32 v140, v140, v141
    v_cvt_pk_bf16_f32 v141, v142, v143
    ds_write_b64 v253, v[140:141]
    v_add_u32 v253, s71, v253
    v_cvt_pk_bf16_f32 v76, v76, v77
    v_cvt_pk_bf16_f32 v77, v78, v79
    ds_write_b64 v252, v[76:77]
    v_add_u32 v252, s70, v252
    v_cvt_pk_bf16_f32 v144, v144, v145
    v_cvt_pk_bf16_f32 v145, v146, v147
    ds_write_b64 v253, v[144:145]
    v_add_u32 v253, s71, v253
    v_cvt_pk_bf16_f32 v80, v80, v81
    v_cvt_pk_bf16_f32 v81, v82, v83
    ds_write_b64 v252, v[80:81]
    v_add_u32 v252, s70, v252
    v_cvt_pk_bf16_f32 v148, v148, v149
    v_cvt_pk_bf16_f32 v149, v150, v151
    ds_write_b64 v253, v[148:149]
    v_add_u32 v253, s71, v253
    v_cvt_pk_bf16_f32 v84, v84, v85
    v_cvt_pk_bf16_f32 v85, v86, v87
    ds_write_b64 v252, v[84:85]
    v_add_u32 v252, s70, v252
    v_cvt_pk_bf16_f32 v152, v152, v153
    v_cvt_pk_bf16_f32 v153, v154, v155
    ds_write_b64 v253, v[152:153]
    v_add_u32 v253, s71, v253
    v_cvt_pk_bf16_f32 v88, v88, v89
    v_cvt_pk_bf16_f32 v89, v90, v91
    ds_write_b64 v252, v[88:89]
    v_add_u32 v252, s70, v252
    v_cvt_pk_bf16_f32 v156, v156, v157
    v_cvt_pk_bf16_f32 v157, v158, v159
    ds_write_b64 v253, v[156:157]
    v_add_u32 v253, s71, v253
    v_cvt_pk_bf16_f32 v92, v92, v93
    v_cvt_pk_bf16_f32 v93, v94, v95
    ds_write_b64 v252, v[92:93]
    v_add_u32 v252, s70, v252
    v_cvt_pk_bf16_f32 v160, v160, v161
    v_cvt_pk_bf16_f32 v161, v162, v163
    ds_write_b64 v253, v[160:161]
    v_add_u32 v253, s71, v253
    v_cvt_pk_bf16_f32 v96, v96, v97
    v_cvt_pk_bf16_f32 v97, v98, v99
    ds_write_b64 v252, v[96:97]
    v_cvt_pk_bf16_f32 v164, v164, v165
    v_cvt_pk_bf16_f32 v165, v166, v167
    ds_write_b64 v253, v[164:165]
    s_waitcnt lgkmcnt(0)
    s_barrier
    v_lshlrev_b32 v26, 1, v20
    v_lshlrev_b32 v27, 2, v20
    s_mov_b32 s67, 7864320
    buffer_load_ushort v26, v26, s[44:47], 0 offen
    buffer_load_dword v27, v27, s[28:31], s67 offen sc1
L_att:
    ds_read_b64 v[144:145], v240 offset:0
    ds_read_b64 v[146:147], v240 offset:8
    ds_read_b64 v[148:149], v240 offset:104
    ds_read_b64 v[150:151], v240 offset:112
    ds_read_b64 v[152:153], v240 offset:40
    ds_read_b64 v[154:155], v240 offset:48
    ds_read_b64 v[156:157], v240 offset:144
    ds_read_b64 v[158:159], v240 offset:152
    ds_read_b64 v[112:113], v234 offset:0
    ds_read_b64 v[114:115], v234 offset:8
    ds_read_b64 v[116:117], v235 offset:0
    ds_read_b64 v[118:119], v235 offset:8
    ds_read_b64 v[120:121], v234 offset:168
    ds_read_b64 v[122:123], v234 offset:176
    ds_read_b64 v[124:125], v235 offset:168
    ds_read_b64 v[126:127], v235 offset:176
    ds_read_b64 v[128:129], v234 offset:40
    ds_read_b64 v[130:131], v234 offset:48
    ds_read_b64 v[132:133], v235 offset:40
    ds_read_b64 v[134:135], v235 offset:48
    ds_read_b64 v[136:137], v234 offset:208
    ds_read_b64 v[138:139], v234 offset:216
    ds_read_b64 v[140:141], v235 offset:208
    ds_read_b64 v[142:143], v235 offset:216
    s_waitcnt lgkmcnt(15)
    v_and_b32 v144, v144, v232
    v_and_b32 v145, v145, v232
    v_and_b32 v146, v146, v233
    v_and_b32 v147, v147, v233
    v_and_b32 v148, v148, v232
    v_and_b32 v149, v149, v232
    v_and_b32 v150, v150, v233
    v_and_b32 v151, v151, v233
    v_and_b32 v152, v152, v232
    v_and_b32 v153, v153, v232
    v_and_b32 v154, v154, v233
    v_and_b32 v155, v155, v233
    v_and_b32 v156, v156, v232
    v_and_b32 v157, v157, v232
    v_and_b32 v158, v158, v233
    v_and_b32 v159, v159, v233
    s_waitcnt lgkmcnt(12)
    v_mfma_f32_16x16x32_bf16 v[160:163], v[112:115], v[144:147], 0
    v_mfma_f32_16x16x32_bf16 v[164:167], v[116:119], v[144:147], 0
    s_waitcnt lgkmcnt(8)
    v_mfma_f32_16x16x32_bf16 v[168:171], v[120:123], v[148:151], 0
    v_mfma_f32_16x16x32_bf16 v[172:175], v[124:127], v[148:151], 0
    s_waitcnt lgkmcnt(4)
    v_mfma_f32_16x16x32_bf16 v[176:179], v[128:131], v[152:155], 0
    v_mfma_f32_16x16x32_bf16 v[180:183], v[132:135], v[152:155], 0
    s_waitcnt lgkmcnt(0)
    v_mfma_f32_16x16x32_bf16 v[184:187], v[136:139], v[156:159], 0
    v_mfma_f32_16x16x32_bf16 v[188:191], v[140:143], v[156:159], 0
    ds_read_b64_tr_b16 v[112:113], v237 offset:0
    ds_read_b64_tr_b16 v[114:115], v238 offset:0
    ds_read_b64_tr_b16 v[116:117], v237 offset:32
    ds_read_b64_tr_b16 v[118:119], v238 offset:32
    v_mul_f32 v160, v160, v216
    v_mul_f32 v161, v161, v217
    v_mul_f32 v162, v162, v218
    v_mul_f32 v163, v163, v219
    v_fmac_f32 v160, v164, v220
    v_fmac_f32 v161, v165, v221
    v_fmac_f32 v162, v166, v222
    v_fmac_f32 v163, v167, v223
    v_cvt_pk_bf16_f32 v161, v160, v161
    v_lshlrev_b32 v160, 16, v161
    v_and_b32 v161, s3, v161
    v_cvt_pk_bf16_f32 v163, v162, v163
    v_lshlrev_b32 v162, 16, v163
    v_and_b32 v163, s3, v163
    v_fmamk_f32 v160, v160, 0x3e64f92e, v224
    v_fmamk_f32 v161, v161, 0x3e64f92e, v225
    v_fmamk_f32 v162, v162, 0x3e64f92e, v226
    v_fmamk_f32 v163, v163, 0x3e64f92e, v227
    v_cvt_pk_bf16_f32 v161, v160, v161
    v_lshlrev_b32 v160, 16, v161
    v_and_b32 v161, s3, v161
    v_cvt_pk_bf16_f32 v163, v162, v163
    v_lshlrev_b32 v162, 16, v163
    v_and_b32 v163, s3, v163
    v_max3_f32 v246, v160, v161, v162
    v_max_f32 v246, v246, v163
    ds_read_b64_tr_b16 v[120:121], v237 offset:168
    ds_read_b64_tr_b16 v[122:123], v238 offset:168
    ds_read_b64_tr_b16 v[124:125], v237 offset:200
    ds_read_b64_tr_b16 v[126:127], v238 offset:200
    v_mul_f32 v168, v168, v216
    v_mul_f32 v169, v169, v217
    v_mul_f32 v170, v170, v218
    v_mul_f32 v171, v171, v219
    v_fmac_f32 v168, v172, v220
    v_fmac_f32 v169, v173, v221
    v_fmac_f32 v170, v174, v222
    v_fmac_f32 v171, v175, v223
    v_cvt_pk_bf16_f32 v169, v168, v169
    v_lshlrev_b32 v168, 16, v169
    v_and_b32 v169, s3, v169
    v_cvt_pk_bf16_f32 v171, v170, v171
    v_lshlrev_b32 v170, 16, v171
    v_and_b32 v171, s3, v171
    v_fmamk_f32 v168, v168, 0x3e64f92e, v224
    v_fmamk_f32 v169, v169, 0x3e64f92e, v225
    v_fmamk_f32 v170, v170, 0x3e64f92e, v226
    v_fmamk_f32 v171, v171, 0x3e64f92e, v227
    v_cvt_pk_bf16_f32 v169, v168, v169
    v_lshlrev_b32 v168, 16, v169
    v_and_b32 v169, s3, v169
    v_cvt_pk_bf16_f32 v171, v170, v171
    v_lshlrev_b32 v170, 16, v171
    v_and_b32 v171, s3, v171
    v_max3_f32 v247, v168, v169, v170
    v_max_f32 v247, v247, v171
    ds_read_b64_tr_b16 v[128:129], v237 offset:48
    ds_read_b64_tr_b16 v[130:131], v238 offset:48
    ds_read_b64_tr_b16 v[132:133], v237 offset:40
    ds_read_b64_tr_b16 v[134:135], v238 offset:40
    v_mul_f32 v176, v176, v216
    v_mul_f32 v177, v177, v217
    v_mul_f32 v178, v178, v218
    v_mul_f32 v179, v179, v219
    v_fmac_f32 v176, v180, v220
    v_fmac_f32 v177, v181, v221
    v_fmac_f32 v178, v182, v222
    v_fmac_f32 v179, v183, v223
    v_cvt_pk_bf16_f32 v177, v176, v177
    v_lshlrev_b32 v176, 16, v177
    v_and_b32 v177, s3, v177
    v_cvt_pk_bf16_f32 v179, v178, v179
    v_lshlrev_b32 v178, 16, v179
    v_and_b32 v179, s3, v179
    v_fmamk_f32 v176, v176, 0x3e64f92e, v224
    v_fmamk_f32 v177, v177, 0x3e64f92e, v225
    v_fmamk_f32 v178, v178, 0x3e64f92e, v226
    v_fmamk_f32 v179, v179, 0x3e64f92e, v227
    v_cvt_pk_bf16_f32 v177, v176, v177
    v_lshlrev_b32 v176, 16, v177
    v_and_b32 v177, s3, v177
    v_cvt_pk_bf16_f32 v179, v178, v179
    v_lshlrev_b32 v178, 16, v179
    v_and_b32 v179, s3, v179
    v_max3_f32 v248, v176, v177, v178
    v_max_f32 v248, v248, v179
    ds_read_b64_tr_b16 v[136:137], v237 offset:216
    ds_read_b64_tr_b16 v[138:139], v238 offset:216
    ds_read_b64_tr_b16 v[140:141], v237 offset:208
    ds_read_b64_tr_b16 v[142:143], v238 offset:208
    v_mul_f32 v184, v184, v216
    v_mul_f32 v185, v185, v217
    v_mul_f32 v186, v186, v218
    v_mul_f32 v187, v187, v219
    v_fmac_f32 v184, v188, v220
    v_fmac_f32 v185, v189, v221
    v_fmac_f32 v186, v190, v222
    v_fmac_f32 v187, v191, v223
    v_cvt_pk_bf16_f32 v185, v184, v185
    v_lshlrev_b32 v184, 16, v185
    v_and_b32 v185, s3, v185
    v_cvt_pk_bf16_f32 v187, v186, v187
    v_lshlrev_b32 v186, 16, v187
    v_and_b32 v187, s3, v187
    v_fmamk_f32 v184, v184, 0x3e64f92e, v224
    v_fmamk_f32 v185, v185, 0x3e64f92e, v225
    v_fmamk_f32 v186, v186, 0x3e64f92e, v226
    v_fmamk_f32 v187, v187, 0x3e64f92e, v227
    v_cvt_pk_bf16_f32 v185, v184, v185
    v_lshlrev_b32 v184, 16, v185
    v_and_b32 v185, s3, v185
    v_cvt_pk_bf16_f32 v187, v186, v187
    v_lshlrev_b32 v186, 16, v187
    v_and_b32 v187, s3, v187
    v_max3_f32 v249, v184, v185, v186
    v_max_f32 v249, v249, v187
    v_permlane16_swap_b32 v246, v247
    s_nop 0
    v_permlane16_swap_b32 v248, v249
    v_max_f32 v246, v246, v247
    v_max_f32 v248, v248, v249
    s_nop 1
    v_permlane32_swap_b32 v246, v248
    v_max_f32 v246, v246, v248
    v_mul_f32 v246, 0xbfb8aa3b, v246
    v_mov_b32 v248, v246
    s_nop 1
    v_permlane32_swap_b32 v246, v248
    v_mov_b32 v247, v246
    v_mov_b32 v249, v248
    s_nop 0
    v_permlane16_swap_b32 v246, v247
    v_permlane16_swap_b32 v248, v249
    v_fmamk_f32 v160, v160, 0x3fb8aa3b, v246
    v_fmamk_f32 v161, v161, 0x3fb8aa3b, v246
    v_fmamk_f32 v162, v162, 0x3fb8aa3b, v246
    v_fmamk_f32 v163, v163, 0x3fb8aa3b, v246
    v_exp_f32 v160, v160
    v_exp_f32 v161, v161
    v_exp_f32 v162, v162
    v_exp_f32 v163, v163
    v_fmamk_f32 v168, v168, 0x3fb8aa3b, v247
    v_fmamk_f32 v169, v169, 0x3fb8aa3b, v247
    v_fmamk_f32 v170, v170, 0x3fb8aa3b, v247
    v_fmamk_f32 v171, v171, 0x3fb8aa3b, v247
    v_exp_f32 v168, v168
    v_exp_f32 v169, v169
    v_exp_f32 v170, v170
    v_exp_f32 v171, v171
    v_fmamk_f32 v176, v176, 0x3fb8aa3b, v248
    v_fmamk_f32 v177, v177, 0x3fb8aa3b, v248
    v_fmamk_f32 v178, v178, 0x3fb8aa3b, v248
    v_fmamk_f32 v179, v179, 0x3fb8aa3b, v248
    v_exp_f32 v176, v176
    v_exp_f32 v177, v177
    v_exp_f32 v178, v178
    v_exp_f32 v179, v179
    v_fmamk_f32 v184, v184, 0x3fb8aa3b, v249
    v_fmamk_f32 v185, v185, 0x3fb8aa3b, v249
    v_fmamk_f32 v186, v186, 0x3fb8aa3b, v249
    v_fmamk_f32 v187, v187, 0x3fb8aa3b, v249
    v_exp_f32 v184, v184
    v_exp_f32 v185, v185
    v_exp_f32 v186, v186
    v_exp_f32 v187, v187
    v_add_f32 v246, v160, v161
    v_add_f32 v250, v162, v163
    v_add_f32 v246, v246, v250
    v_add_f32 v247, v168, v169
    v_add_f32 v250, v170, v171
    v_add_f32 v247, v247, v250
    v_add_f32 v248, v176, v177
    v_add_f32 v250, v178, v179
    v_add_f32 v248, v248, v250
    v_add_f32 v249, v184, v185
    v_add_f32 v250, v186, v187
    v_add_f32 v249, v249, v250
    v_permlane16_swap_b32 v246, v247
    s_nop 0
    v_permlane16_swap_b32 v248, v249
    v_add_f32 v246, v246, v247
    v_add_f32 v248, v248, v249
    s_nop 1
    v_permlane32_swap_b32 v246, v248
    v_add_f32 v246, v246, v248
    v_rcp_f32 v246, v246
    s_nop 0
    v_mov_b32 v248, v246
    s_nop 1
    v_permlane32_swap_b32 v246, v248
    v_mov_b32 v247, v246
    v_mov_b32 v249, v248
    s_nop 0
    v_permlane16_swap_b32 v246, v247
    v_permlane16_swap_b32 v248, v249
    v_mul_f32 v160, v160, v246
    v_mul_f32 v161, v161, v246
    v_mul_f32 v162, v162, v246
    v_mul_f32 v163, v163, v246
    v_cvt_pk_bf16_f32 v160, v160, v161
    v_cvt_pk_bf16_f32 v161, v162, v163
    v_and_b32 v144, v160, v228
    v_and_b32 v145, v161, v229
    v_and_b32 v146, v160, v230
    v_and_b32 v147, v161, v231
    v_mul_f32 v168, v168, v247
    v_mul_f32 v169, v169, v247
    v_mul_f32 v170, v170, v247
    v_mul_f32 v171, v171, v247
    v_cvt_pk_bf16_f32 v168, v168, v169
    v_cvt_pk_bf16_f32 v169, v170, v171
    v_and_b32 v148, v168, v228
    v_and_b32 v149, v169, v229
    v_and_b32 v150, v168, v230
    v_and_b32 v151, v169, v231
    v_mul_f32 v176, v176, v248
    v_mul_f32 v177, v177, v248
    v_mul_f32 v178, v178, v248
    v_mul_f32 v179, v179, v248
    v_cvt_pk_bf16_f32 v176, v176, v177
    v_cvt_pk_bf16_f32 v177, v178, v179
    v_and_b32 v152, v176, v228
    v_and_b32 v153, v177, v229
    v_and_b32 v154, v176, v230
    v_and_b32 v155, v177, v231
    v_mul_f32 v184, v184, v249
    v_mul_f32 v185, v185, v249
    v_mul_f32 v186, v186, v249
    v_mul_f32 v187, v187, v249
    v_cvt_pk_bf16_f32 v184, v184, v185
    v_cvt_pk_bf16_f32 v185, v186, v187
    v_and_b32 v156, v184, v228
    v_and_b32 v157, v185, v229
    v_and_b32 v158, v184, v230
    v_and_b32 v159, v185, v231
    s_waitcnt lgkmcnt(12)
    v_mfma_f32_16x16x32_bf16 v[160:163], v[112:115], v[144:147], 0
    v_mfma_f32_16x16x32_bf16 v[164:167], v[116:119], v[144:147], 0
    s_waitcnt lgkmcnt(8)
    v_mfma_f32_16x16x32_bf16 v[168:171], v[120:123], v[148:151], 0
    v_mfma_f32_16x16x32_bf16 v[172:175], v[124:127], v[148:151], 0
    s_waitcnt lgkmcnt(4)
    v_mfma_f32_16x16x32_bf16 v[176:179], v[128:131], v[152:155], 0
    v_mfma_f32_16x16x32_bf16 v[180:183], v[132:135], v[152:155], 0
    s_waitcnt lgkmcnt(0)
    v_mfma_f32_16x16x32_bf16 v[184:187], v[136:139], v[156:159], 0
    v_mfma_f32_16x16x32_bf16 v[188:191], v[140:143], v[156:159], 0
    v_cvt_pk_bf16_f32 v112, v160, v161
    v_cvt_pk_bf16_f32 v113, v162, v163
    v_cvt_pk_bf16_f32 v120, v164, v165
    v_cvt_pk_bf16_f32 v121, v166, v167
    v_cvt_pk_bf16_f32 v114, v168, v169
    v_cvt_pk_bf16_f32 v115, v170, v171
    v_cvt_pk_bf16_f32 v124, v172, v173
    v_cvt_pk_bf16_f32 v125, v174, v175
    v_cvt_pk_bf16_f32 v116, v176, v177
    v_cvt_pk_bf16_f32 v117, v178, v179
    v_cvt_pk_bf16_f32 v122, v180, v181
    v_cvt_pk_bf16_f32 v123, v182, v183
    v_cvt_pk_bf16_f32 v118, v184, v185
    v_cvt_pk_bf16_f32 v119, v186, v187
    v_cvt_pk_bf16_f32 v126, v188, v189
    v_cvt_pk_bf16_f32 v127, v190, v191
    v_permlane16_swap_b32 v112, v114
    v_permlane16_swap_b32 v113, v115
    v_permlane16_swap_b32 v116, v118
    v_permlane16_swap_b32 v117, v119
    v_permlane16_swap_b32 v120, v124
    v_permlane16_swap_b32 v121, v125
    v_permlane16_swap_b32 v122, v126
    v_permlane16_swap_b32 v123, v127
    buffer_store_dwordx4 v[112:115], v241, s[28:31], 0 offen sc1
    buffer_store_dwordx4 v[116:119], v242, s[28:31], 0 offen sc1
    buffer_store_dwordx4 v[120:123], v243, s[28:31], 0 offen sc1
    s_waitcnt vmcnt(0)
    s_mov_b64 exec, 1
    v_mov_b32 v9, 1
    v_mov_b32 v14, 163832
    ds_add_rtn_u32 v9, v14, v9
    s_waitcnt lgkmcnt(0)
    v_readfirstlane_b32 s67, v9
    s_nop 1
    s_cmp_eq_u32 s67, 7
    s_cselect_b32 s66, s64, 12582912
    s_mov_b32 exec_lo, -1
    s_mov_b32 exec_hi, 0
    v_lshlrev_b32 v9, 2, v0
    buffer_store_dword v29, v9, s[28:31], s66 offen sc1
    s_mov_b64 exec, -1
    s_cmp_eq_u32 s79, 1
    s_cbranch_scc1 L_att_back
    v_add_u32 v14, 125696, v12
    v_add_u32 v15, 16384, v13
    s_barrier
    ds_read_b128 v[128:131], v15 offset:0
    ds_read_b64_tr_b16 v[132:133], v14 offset:0
    ds_read_b64_tr_b16 v[134:135], v14 offset:1280
    ds_read_b64_tr_b16 v[136:137], v14 offset:32
    ds_read_b64_tr_b16 v[138:139], v14 offset:1312
    ds_read_b64_tr_b16 v[140:141], v14 offset:64
    ds_read_b64_tr_b16 v[142:143], v14 offset:1344
    ds_read_b64_tr_b16 v[144:145], v14 offset:96
    ds_read_b64_tr_b16 v[146:147], v14 offset:1376
    ds_read_b64_tr_b16 v[148:149], v14 offset:128
    ds_read_b64_tr_b16 v[150:151], v14 offset:1408
    ds_read_b128 v[152:155], v15 offset:4096
    ds_read_b64_tr_b16 v[156:157], v14 offset:5120
    ds_read_b64_tr_b16 v[158:159], v14 offset:6400
    ds_read_b64_tr_b16 v[160:161], v14 offset:5152
    ds_read_b64_tr_b16 v[162:163], v14 offset:6432
    ds_read_b64_tr_b16 v[164:165], v14 offset:5184
    ds_read_b64_tr_b16 v[166:167], v14 offset:6464
    ds_read_b64_tr_b16 v[168:169], v14 offset:5216
    ds_read_b64_tr_b16 v[170:171], v14 offset:6496
    ds_read_b64_tr_b16 v[172:173], v14 offset:5248
    ds_read_b64_tr_b16 v[174:175], v14 offset:6528
    s_waitcnt lgkmcnt(15)
    v_mfma_f32_16x16x32_bf16 v[32:35], v[132:135], v[128:131], 0
    ds_read_b64_tr_b16 v[180:181], v14 offset:10240
    ds_read_b64_tr_b16 v[182:183], v14 offset:11520
    ds_read_b64_tr_b16 v[184:185], v14 offset:10272
    ds_read_b64_tr_b16 v[186:187], v14 offset:11552
    ds_read_b64_tr_b16 v[188:189], v14 offset:10304
    ds_read_b64_tr_b16 v[190:191], v14 offset:11584
    ds_read_b64_tr_b16 v[192:193], v14 offset:10336
    v_mfma_f32_16x16x32_bf16 v[36:39], v[136:139], v[128:131], 0
    ds_read_b64_tr_b16 v[194:195], v14 offset:11616
    ds_read_b64_tr_b16 v[196:197], v14 offset:10368
    ds_read_b64_tr_b16 v[198:199], v14 offset:11648
    ds_read_b128 v[176:179], v15 offset:8192
    v_mfma_f32_16x16x32_bf16 v[40:43], v[140:143], v[128:131], 0
    ds_read_b64_tr_b16 v[204:205], v14 offset:15360
    ds_read_b64_tr_b16 v[206:207], v14 offset:16640
    s_waitcnt lgkmcnt(15)
    v_mfma_f32_16x16x32_bf16 v[44:47], v[144:147], v[128:131], 0
    ds_read_b64_tr_b16 v[208:209], v14 offset:15392
    ds_read_b64_tr_b16 v[210:211], v14 offset:16672
    ds_read_b64_tr_b16 v[212:213], v14 offset:15424
    ds_read_b64_tr_b16 v[214:215], v14 offset:16704
    v_mfma_f32_16x16x32_bf16 v[48:51], v[148:151], v[128:131], 0
    ds_read_b64_tr_b16 v[216:217], v14 offset:15456
    ds_read_b64_tr_b16 v[218:219], v14 offset:16736
    ds_read_b64_tr_b16 v[220:221], v14 offset:15488
    v_mfma_f32_16x16x32_bf16 v[32:35], v[156:159], v[152:155], v[32:35]
    ds_read_b64_tr_b16 v[222:223], v14 offset:16768
    ds_read_b128 v[200:203], v15 offset:12288
    v_mfma_f32_16x16x32_bf16 v[36:39], v[160:163], v[152:155], v[36:39]
    v_mfma_f32_16x16x32_bf16 v[40:43], v[164:167], v[152:155], v[40:43]
    v_mfma_f32_16x16x32_bf16 v[44:47], v[168:171], v[152:155], v[44:47]
    s_waitcnt lgkmcnt(15)
    v_mfma_f32_16x16x32_bf16 v[48:51], v[172:175], v[152:155], v[48:51]
    s_waitcnt lgkmcnt(0)
    v_add_u32 v14, 0, v12
    v_add_u32 v15, 32768, v13
    s_barrier
    ds_read_b128 v[128:131], v15 offset:0
    ds_read_b64_tr_b16 v[132:133], v14 offset:0
    v_mfma_f32_16x16x32_bf16 v[32:35], v[180:183], v[176:179], v[32:35]
    ds_read_b64_tr_b16 v[134:135], v14 offset:1280
    ds_read_b64_tr_b16 v[136:137], v14 offset:32
    ds_read_b64_tr_b16 v[138:139], v14 offset:1312
    v_mfma_f32_16x16x32_bf16 v[36:39], v[184:187], v[176:179], v[36:39]
    ds_read_b64_tr_b16 v[140:141], v14 offset:64
    ds_read_b64_tr_b16 v[142:143], v14 offset:1344
    ds_read_b64_tr_b16 v[144:145], v14 offset:96
    v_mfma_f32_16x16x32_bf16 v[40:43], v[188:191], v[176:179], v[40:43]
    ds_read_b64_tr_b16 v[146:147], v14 offset:1376
    ds_read_b64_tr_b16 v[148:149], v14 offset:128
    ds_read_b64_tr_b16 v[150:151], v14 offset:1408
    v_mfma_f32_16x16x32_bf16 v[44:47], v[192:195], v[176:179], v[44:47]
    ds_read_b128 v[152:155], v15 offset:4096
    ds_read_b64_tr_b16 v[156:157], v14 offset:5120
    v_mfma_f32_16x16x32_bf16 v[48:51], v[196:199], v[176:179], v[48:51]
    ds_read_b64_tr_b16 v[158:159], v14 offset:6400
    ds_read_b64_tr_b16 v[160:161], v14 offset:5152
    v_mfma_f32_16x16x32_bf16 v[32:35], v[204:207], v[200:203], v[32:35]
    ds_read_b64_tr_b16 v[162:163], v14 offset:6432
    ds_read_b64_tr_b16 v[164:165], v14 offset:5184
    ds_read_b64_tr_b16 v[166:167], v14 offset:6464
    v_mfma_f32_16x16x32_bf16 v[36:39], v[208:211], v[200:203], v[36:39]
    ds_read_b64_tr_b16 v[168:169], v14 offset:5216
    ds_read_b64_tr_b16 v[170:171], v14 offset:6496
    ds_read_b64_tr_b16 v[172:173], v14 offset:5248
    v_mfma_f32_16x16x32_bf16 v[40:43], v[212:215], v[200:203], v[40:43]
    ds_read_b64_tr_b16 v[174:175], v14 offset:6528
    ds_read_b64_tr_b16 v[180:181], v14 offset:10240
    ds_read_b64_tr_b16 v[182:183], v14 offset:11520
    v_mfma_f32_16x16x32_bf16 v[44:47], v[216:219], v[200:203], v[44:47]
    ds_read_b64_tr_b16 v[184:185], v14 offset:10272
    ds_read_b64_tr_b16 v[186:187], v14 offset:11552
    ds_read_b64_tr_b16 v[188:189], v14 offset:10304
    v_mfma_f32_16x16x32_bf16 v[48:51], v[220:223], v[200:203], v[48:51]
    ds_read_b64_tr_b16 v[190:191], v14 offset:11584
    ds_read_b64_tr_b16 v[192:193], v14 offset:10336
    ds_read_b64_tr_b16 v[194:195], v14 offset:11616
    s_waitcnt lgkmcnt(15)
    v_mfma_f32_16x16x32_bf16 v[32:35], v[132:135], v[128:131], v[32:35]
    ds_read_b64_tr_b16 v[196:197], v14 offset:10368
    ds_read_b64_tr_b16 v[198:199], v14 offset:11648
    v_mfma_f32_16x16x32_bf16 v[36:39], v[136:139], v[128:131], v[36:39]
    ds_read_b128 v[176:179], v15 offset:8192
    ds_read_b64_tr_b16 v[204:205], v14 offset:15360
    v_mfma_f32_16x16x32_bf16 v[40:43], v[140:143], v[128:131], v[40:43]
    ds_read_b64_tr_b16 v[206:207], v14 offset:16640
    ds_read_b64_tr_b16 v[208:209], v14 offset:15392
    ds_read_b64_tr_b16 v[210:211], v14 offset:16672
    v_mfma_f32_16x16x32_bf16 v[44:47], v[144:147], v[128:131], v[44:47]
    ds_read_b64_tr_b16 v[212:213], v14 offset:15424
    ds_read_b64_tr_b16 v[214:215], v14 offset:16704
    ds_read_b64_tr_b16 v[216:217], v14 offset:15456
    v_mfma_f32_16x16x32_bf16 v[48:51], v[148:151], v[128:131], v[48:51]
    ds_read_b64_tr_b16 v[218:219], v14 offset:16736
    ds_read_b64_tr_b16 v[220:221], v14 offset:15488
    ds_read_b64_tr_b16 v[222:223], v14 offset:16768
    v_mfma_f32_16x16x32_bf16 v[32:35], v[156:159], v[152:155], v[32:35]
    ds_read_b128 v[200:203], v15 offset:12288
    s_waitcnt lgkmcnt(15)
    v_mfma_f32_16x16x32_bf16 v[36:39], v[160:163], v[152:155], v[36:39]
    v_mfma_f32_16x16x32_bf16 v[40:43], v[164:167], v[152:155], v[40:43]
    v_mfma_f32_16x16x32_bf16 v[44:47], v[168:171], v[152:155], v[44:47]
    v_mfma_f32_16x16x32_bf16 v[48:51], v[172:175], v[152:155], v[48:51]
    s_waitcnt lgkmcnt(0)
    v_add_u32 v14, 102400, v12
    v_add_u32 v15, 16384, v13
    s_barrier
    ds_read_b128 v[128:131], v15 offset:0
    ds_read_b64_tr_b16 v[132:133], v14 offset:0
    v_mfma_f32_16x16x32_bf16 v[32:35], v[180:183], v[176:179], v[32:35]
    ds_read_b64_tr_b16 v[134:135], v14 offset:1280
    ds_read_b64_tr_b16 v[136:137], v14 offset:32
    ds_read_b64_tr_b16 v[138:139], v14 offset:1312
    v_mfma_f32_16x16x32_bf16 v[36:39], v[184:187], v[176:179], v[36:39]
    ds_read_b64_tr_b16 v[140:141], v14 offset:64
    ds_read_b64_tr_b16 v[142:143], v14 offset:1344
    ds_read_b64_tr_b16 v[144:145], v14 offset:96
    v_mfma_f32_16x16x32_bf16 v[40:43], v[188:191], v[176:179], v[40:43]
    ds_read_b64_tr_b16 v[146:147], v14 offset:1376
    ds_read_b64_tr_b16 v[148:149], v14 offset:128
    ds_read_b64_tr_b16 v[150:151], v14 offset:1408
    v_mfma_f32_16x16x32_bf16 v[44:47], v[192:195], v[176:179], v[44:47]
    ds_read_b128 v[152:155], v15 offset:4096
    ds_read_b64_tr_b16 v[156:157], v14 offset:5120
    v_mfma_f32_16x16x32_bf16 v[48:51], v[196:199], v[176:179], v[48:51]
    ds_read_b64_tr_b16 v[158:159], v14 offset:6400
    ds_read_b64_tr_b16 v[160:161], v14 offset:5152
    v_mfma_f32_16x16x32_bf16 v[32:35], v[204:207], v[200:203], v[32:35]
    ds_read_b64_tr_b16 v[162:163], v14 offset:6432
    ds_read_b64_tr_b16 v[164:165], v14 offset:5184
    ds_read_b64_tr_b16 v[166:167], v14 offset:6464
    v_mfma_f32_16x16x32_bf16 v[36:39], v[208:211], v[200:203], v[36:39]
    ds_read_b64_tr_b16 v[168:169], v14 offset:5216
    ds_read_b64_tr_b16 v[170:171], v14 offset:6496
    ds_read_b64_tr_b16 v[172:173], v14 offset:5248
    v_mfma_f32_16x16x32_bf16 v[40:43], v[212:215], v[200:203], v[40:43]
    ds_read_b64_tr_b16 v[174:175], v14 offset:6528
    ds_read_b64_tr_b16 v[180:181], v14 offset:10240
    ds_read_b64_tr_b16 v[182:183], v14 offset:11520
    v_mfma_f32_16x16x32_bf16 v[44:47], v[216:219], v[200:203], v[44:47]
    ds_read_b64_tr_b16 v[184:185], v14 offset:10272
    ds_read_b64_tr_b16 v[186:187], v14 offset:11552
    ds_read_b64_tr_b16 v[188:189], v14 offset:10304
    v_mfma_f32_16x16x32_bf16 v[48:51], v[220:223], v[200:203], v[48:51]
    ds_read_b64_tr_b16 v[190:191], v14 offset:11584
    ds_read_b64_tr_b16 v[192:193], v14 offset:10336
    ds_read_b64_tr_b16 v[194:195], v14 offset:11616
    s_waitcnt lgkmcnt(15)
    v_mfma_f32_16x16x32_bf16 v[32:35], v[132:135], v[128:131], v[32:35]
    ds_read_b64_tr_b16 v[196:197], v14 offset:10368
    ds_read_b64_tr_b16 v[198:199], v14 offset:11648
    v_mfma_f32_16x16x32_bf16 v[36:39], v[136:139], v[128:131], v[36:39]
    ds_read_b128 v[176:179], v15 offset:8192
    ds_read_b64_tr_b16 v[204:205], v14 offset:15360
    v_mfma_f32_16x16x32_bf16 v[40:43], v[140:143], v[128:131], v[40:43]
    ds_read_b64_tr_b16 v[206:207], v14 offset:16640
    ds_read_b64_tr_b16 v[208:209], v14 offset:15392
    ds_read_b64_tr_b16 v[210:211], v14 offset:16672
    v_mfma_f32_16x16x32_bf16 v[44:47], v[144:147], v[128:131], v[44:47]
    ds_read_b64_tr_b16 v[212:213], v14 offset:15424
    ds_read_b64_tr_b16 v[214:215], v14 offset:16704
    ds_read_b64_tr_b16 v[216:217], v14 offset:15456
    v_mfma_f32_16x16x32_bf16 v[48:51], v[148:151], v[128:131], v[48:51]
    ds_read_b64_tr_b16 v[218:219], v14 offset:16736
    ds_read_b64_tr_b16 v[220:221], v14 offset:15488
    ds_read_b64_tr_b16 v[222:223], v14 offset:16768
    v_mfma_f32_16x16x32_bf16 v[32:35], v[156:159], v[152:155], v[32:35]
    ds_read_b128 v[200:203], v15 offset:12288
    s_waitcnt lgkmcnt(15)
    v_mfma_f32_16x16x32_bf16 v[36:39], v[160:163], v[152:155], v[36:39]
    v_mfma_f32_16x16x32_bf16 v[40:43], v[164:167], v[152:155], v[40:43]
    v_mfma_f32_16x16x32_bf16 v[44:47], v[168:171], v[152:155], v[44:47]
    v_mfma_f32_16x16x32_bf16 v[48:51], v[172:175], v[152:155], v[48:51]
    s_waitcnt lgkmcnt(0)
    v_add_u32 v14, 122880, v12
    v_add_u32 v15, -20480, v13
    s_barrier
    ds_read_b128 v[128:131], v15 offset:0
    ds_read_b64_tr_b16 v[132:133], v14 offset:0
    v_mfma_f32_16x16x32_bf16 v[32:35], v[180:183], v[176:179], v[32:35]
    ds_read_b64_tr_b16 v[134:135], v14 offset:1280
    ds_read_b64_tr_b16 v[136:137], v14 offset:32
    ds_read_b64_tr_b16 v[138:139], v14 offset:1312
    v_mfma_f32_16x16x32_bf16 v[36:39], v[184:187], v[176:179], v[36:39]
    ds_read_b64_tr_b16 v[140:141], v14 offset:64
    ds_read_b64_tr_b16 v[142:143], v14 offset:1344
    ds_read_b64_tr_b16 v[144:145], v14 offset:96
    v_mfma_f32_16x16x32_bf16 v[40:43], v[188:191], v[176:179], v[40:43]
    ds_read_b64_tr_b16 v[146:147], v14 offset:1376
    ds_read_b64_tr_b16 v[148:149], v14 offset:128
    ds_read_b64_tr_b16 v[150:151], v14 offset:1408
    v_mfma_f32_16x16x32_bf16 v[44:47], v[192:195], v[176:179], v[44:47]
    ds_read_b128 v[152:155], v15 offset:4096
    ds_read_b64_tr_b16 v[156:157], v14 offset:5120
    v_mfma_f32_16x16x32_bf16 v[48:51], v[196:199], v[176:179], v[48:51]
    ds_read_b64_tr_b16 v[158:159], v14 offset:6400
    ds_read_b64_tr_b16 v[160:161], v14 offset:5152
    v_mfma_f32_16x16x32_bf16 v[32:35], v[204:207], v[200:203], v[32:35]
    ds_read_b64_tr_b16 v[162:163], v14 offset:6432
    ds_read_b64_tr_b16 v[164:165], v14 offset:5184
    ds_read_b64_tr_b16 v[166:167], v14 offset:6464
    v_mfma_f32_16x16x32_bf16 v[36:39], v[208:211], v[200:203], v[36:39]
    ds_read_b64_tr_b16 v[168:169], v14 offset:5216
    ds_read_b64_tr_b16 v[170:171], v14 offset:6496
    ds_read_b64_tr_b16 v[172:173], v14 offset:5248
    v_mfma_f32_16x16x32_bf16 v[40:43], v[212:215], v[200:203], v[40:43]
    ds_read_b64_tr_b16 v[174:175], v14 offset:6528
    ds_read_b64_tr_b16 v[180:181], v14 offset:10240
    ds_read_b64_tr_b16 v[182:183], v14 offset:11520
    v_mfma_f32_16x16x32_bf16 v[44:47], v[216:219], v[200:203], v[44:47]
    ds_read_b64_tr_b16 v[184:185], v14 offset:10272
    ds_read_b64_tr_b16 v[186:187], v14 offset:11552
    ds_read_b64_tr_b16 v[188:189], v14 offset:10304
    v_mfma_f32_16x16x32_bf16 v[48:51], v[220:223], v[200:203], v[48:51]
    ds_read_b64_tr_b16 v[190:191], v14 offset:11584
    ds_read_b64_tr_b16 v[192:193], v14 offset:10336
    ds_read_b64_tr_b16 v[194:195], v14 offset:11616
    s_waitcnt lgkmcnt(15)
    v_mfma_f32_16x16x32_bf16 v[32:35], v[132:135], v[128:131], v[32:35]
    ds_read_b64_tr_b16 v[196:197], v14 offset:10368
    ds_read_b64_tr_b16 v[198:199], v14 offset:11648
    v_mfma_f32_16x16x32_bf16 v[36:39], v[136:139], v[128:131], v[36:39]
    ds_read_b128 v[176:179], v15 offset:8192
    ds_read_b64_tr_b16 v[204:205], v14 offset:15360
    v_mfma_f32_16x16x32_bf16 v[40:43], v[140:143], v[128:131], v[40:43]
    ds_read_b64_tr_b16 v[206:207], v14 offset:16640
    ds_read_b64_tr_b16 v[208:209], v14 offset:15392
    ds_read_b64_tr_b16 v[210:211], v14 offset:16672
    v_mfma_f32_16x16x32_bf16 v[44:47], v[144:147], v[128:131], v[44:47]
    ds_read_b64_tr_b16 v[212:213], v14 offset:15424
    ds_read_b64_tr_b16 v[214:215], v14 offset:16704
    ds_read_b64_tr_b16 v[216:217], v14 offset:15456
    v_mfma_f32_16x16x32_bf16 v[48:51], v[148:151], v[128:131], v[48:51]
    ds_read_b64_tr_b16 v[218:219], v14 offset:16736
    ds_read_b64_tr_b16 v[220:221], v14 offset:15488
    ds_read_b64_tr_b16 v[222:223], v14 offset:16768
    v_mfma_f32_16x16x32_bf16 v[32:35], v[156:159], v[152:155], v[32:35]
    ds_read_b128 v[200:203], v15 offset:12288
    s_waitcnt lgkmcnt(15)
    v_mfma_f32_16x16x32_bf16 v[36:39], v[160:163], v[152:155], v[36:39]
    v_mfma_f32_16x16x32_bf16 v[40:43], v[164:167], v[152:155], v[40:43]
    v_mfma_f32_16x16x32_bf16 v[44:47], v[168:171], v[152:155], v[44:47]
    v_mfma_f32_16x16x32_bf16 v[48:51], v[172:175], v[152:155], v[48:51]
    s_waitcnt lgkmcnt(0)
    v_add_u32 v14, 102400, v12
    v_add_u32 v15, 32768, v13
    s_barrier
    ds_read_b128 v[128:131], v15 offset:0
    ds_read_b64_tr_b16 v[132:133], v14 offset:0
    v_mfma_f32_16x16x32_bf16 v[32:35], v[180:183], v[176:179], v[32:35]
    ds_read_b64_tr_b16 v[134:135], v14 offset:1280
    ds_read_b64_tr_b16 v[136:137], v14 offset:32
    ds_read_b64_tr_b16 v[138:139], v14 offset:1312
    v_mfma_f32_16x16x32_bf16 v[36:39], v[184:187], v[176:179], v[36:39]
    ds_read_b64_tr_b16 v[140:141], v14 offset:64
    ds_read_b64_tr_b16 v[142:143], v14 offset:1344
    ds_read_b64_tr_b16 v[144:145], v14 offset:96
    v_mfma_f32_16x16x32_bf16 v[40:43], v[188:191], v[176:179], v[40:43]
    ds_read_b64_tr_b16 v[146:147], v14 offset:1376
    ds_read_b64_tr_b16 v[148:149], v14 offset:128
    ds_read_b64_tr_b16 v[150:151], v14 offset:1408
    v_mfma_f32_16x16x32_bf16 v[44:47], v[192:195], v[176:179], v[44:47]
    ds_read_b128 v[152:155], v15 offset:4096
    ds_read_b64_tr_b16 v[156:157], v14 offset:5120
    v_mfma_f32_16x16x32_bf16 v[48:51], v[196:199], v[176:179], v[48:51]
    ds_read_b64_tr_b16 v[158:159], v14 offset:6400
    ds_read_b64_tr_b16 v[160:161], v14 offset:5152
    v_mfma_f32_16x16x32_bf16 v[32:35], v[204:207], v[200:203], v[32:35]
    ds_read_b64_tr_b16 v[162:163], v14 offset:6432
    ds_read_b64_tr_b16 v[164:165], v14 offset:5184
    ds_read_b64_tr_b16 v[166:167], v14 offset:6464
    v_mfma_f32_16x16x32_bf16 v[36:39], v[208:211], v[200:203], v[36:39]
    ds_read_b64_tr_b16 v[168:169], v14 offset:5216
    ds_read_b64_tr_b16 v[170:171], v14 offset:6496
    ds_read_b64_tr_b16 v[172:173], v14 offset:5248
    v_mfma_f32_16x16x32_bf16 v[40:43], v[212:215], v[200:203], v[40:43]
    ds_read_b64_tr_b16 v[174:175], v14 offset:6528
    ds_read_b64_tr_b16 v[180:181], v14 offset:10240
    ds_read_b64_tr_b16 v[182:183], v14 offset:11520
    v_mfma_f32_16x16x32_bf16 v[44:47], v[216:219], v[200:203], v[44:47]
    ds_read_b64_tr_b16 v[184:185], v14 offset:10272
    ds_read_b64_tr_b16 v[186:187], v14 offset:11552
    ds_read_b64_tr_b16 v[188:189], v14 offset:10304
    v_mfma_f32_16x16x32_bf16 v[48:51], v[220:223], v[200:203], v[48:51]
    ds_read_b64_tr_b16 v[190:191], v14 offset:11584
    ds_read_b64_tr_b16 v[192:193], v14 offset:10336
    ds_read_b64_tr_b16 v[194:195], v14 offset:11616
    s_waitcnt lgkmcnt(15)
    v_mfma_f32_16x16x32_bf16 v[32:35], v[132:135], v[128:131], v[32:35]
    ds_read_b64_tr_b16 v[196:197], v14 offset:10368
    ds_read_b64_tr_b16 v[198:199], v14 offset:11648
    v_mfma_f32_16x16x32_bf16 v[36:39], v[136:139], v[128:131], v[36:39]
    ds_read_b128 v[176:179], v15 offset:8192
    ds_read_b64_tr_b16 v[204:205], v14 offset:15360
    v_mfma_f32_16x16x32_bf16 v[40:43], v[140:143], v[128:131], v[40:43]
    ds_read_b64_tr_b16 v[206:207], v14 offset:16640
    ds_read_b64_tr_b16 v[208:209], v14 offset:15392
    ds_read_b64_tr_b16 v[210:211], v14 offset:16672
    v_mfma_f32_16x16x32_bf16 v[44:47], v[144:147], v[128:131], v[44:47]
    ds_read_b64_tr_b16 v[212:213], v14 offset:15424
    ds_read_b64_tr_b16 v[214:215], v14 offset:16704
    ds_read_b64_tr_b16 v[216:217], v14 offset:15456
    v_mfma_f32_16x16x32_bf16 v[48:51], v[148:151], v[128:131], v[48:51]
    ds_read_b64_tr_b16 v[218:219], v14 offset:16736
    ds_read_b64_tr_b16 v[220:221], v14 offset:15488
    ds_read_b64_tr_b16 v[222:223], v14 offset:16768
    v_mfma_f32_16x16x32_bf16 v[32:35], v[156:159], v[152:155], v[32:35]
    ds_read_b128 v[200:203], v15 offset:12288
    s_waitcnt lgkmcnt(15)
    v_mfma_f32_16x16x32_bf16 v[36:39], v[160:163], v[152:155], v[36:39]
    v_mfma_f32_16x16x32_bf16 v[40:43], v[164:167], v[152:155], v[40:43]
    v_mfma_f32_16x16x32_bf16 v[44:47], v[168:171], v[152:155], v[44:47]
    v_mfma_f32_16x16x32_bf16 v[48:51], v[172:175], v[152:155], v[48:51]
    s_waitcnt lgkmcnt(0)
    v_add_u32 v14, 0, v11
    v_add_u32 v15, 146176, v10
    s_barrier
    ds_read_b64_tr_b16 v[128:129], v15 offset:0
    ds_read_b64_tr_b16 v[130:131], v15 offset:2048
    ds_read_b128 v[132:135], v14 offset:0
    v_mfma_f32_16x16x32_bf16 v[32:35], v[180:183], v[176:179], v[32:35]
    ds_read_b128 v[136:139], v14 offset:1024
    v_mfma_f32_16x16x32_bf16 v[36:39], v[184:187], v[176:179], v[36:39]
    ds_read_b128 v[140:143], v14 offset:2048
    ds_read_b128 v[144:147], v14 offset:3072
    v_mfma_f32_16x16x32_bf16 v[40:43], v[188:191], v[176:179], v[40:43]
    ds_read_b128 v[148:151], v14 offset:4096
    v_mfma_f32_16x16x32_bf16 v[44:47], v[192:195], v[176:179], v[44:47]
    ds_read_b64_tr_b16 v[152:153], v15 offset:4096
    ds_read_b64_tr_b16 v[154:155], v15 offset:6144
    ds_read_b128 v[156:159], v14 offset:5120
    v_mfma_f32_16x16x32_bf16 v[48:51], v[196:199], v[176:179], v[48:51]
    ds_read_b128 v[160:163], v14 offset:6144
    v_mfma_f32_16x16x32_bf16 v[32:35], v[204:207], v[200:203], v[32:35]
    ds_read_b128 v[164:167], v14 offset:7168
    v_mfma_f32_16x16x32_bf16 v[36:39], v[208:211], v[200:203], v[36:39]
    ds_read_b128 v[168:171], v14 offset:8192
    ds_read_b128 v[172:175], v14 offset:9216
    v_mfma_f32_16x16x32_bf16 v[40:43], v[212:215], v[200:203], v[40:43]
    ds_read_b128 v[180:183], v14 offset:10240
    v_mfma_f32_16x16x32_bf16 v[44:47], v[216:219], v[200:203], v[44:47]
    ds_read_b128 v[184:187], v14 offset:11264
    ds_read_b128 v[188:191], v14 offset:12288
    v_mfma_f32_16x16x32_bf16 v[48:51], v[220:223], v[200:203], v[48:51]
    ds_read_b128 v[192:195], v14 offset:13312
    s_waitcnt lgkmcnt(15)
    v_mfma_f32_16x16x32_bf16 v[52:55], v[132:135], v[128:131], 0
    ds_read_b128 v[196:199], v14 offset:14336
    s_waitcnt lgkmcnt(15)
    v_mfma_f32_16x16x32_bf16 v[56:59], v[136:139], v[128:131], 0
    ds_read_b64_tr_b16 v[176:177], v15 offset:8192
    ds_read_b64_tr_b16 v[178:179], v15 offset:10240
    ds_read_b128 v[204:207], v14 offset:15360
    s_waitcnt lgkmcnt(15)
    v_mfma_f32_16x16x32_bf16 v[60:63], v[140:143], v[128:131], 0
    ds_read_b128 v[208:211], v14 offset:16384
    v_mfma_f32_16x16x32_bf16 v[64:67], v[144:147], v[128:131], 0
    ds_read_b128 v[212:215], v14 offset:17408
    ds_read_b128 v[216:219], v14 offset:18432
    v_mfma_f32_16x16x32_bf16 v[68:71], v[148:151], v[128:131], 0
    ds_read_b128 v[220:223], v14 offset:19456
    s_waitcnt lgkmcnt(15)
    v_mfma_f32_16x16x32_bf16 v[52:55], v[156:159], v[152:155], v[52:55]
    ds_read_b64_tr_b16 v[200:201], v15 offset:12288
    ds_read_b64_tr_b16 v[202:203], v15 offset:14336
    v_mfma_f32_16x16x32_bf16 v[56:59], v[160:163], v[152:155], v[56:59]
    s_waitcnt lgkmcnt(15)
    v_mfma_f32_16x16x32_bf16 v[60:63], v[164:167], v[152:155], v[60:63]
    v_mfma_f32_16x16x32_bf16 v[64:67], v[168:171], v[152:155], v[64:67]
    s_waitcnt lgkmcnt(14)
    v_mfma_f32_16x16x32_bf16 v[68:71], v[172:175], v[152:155], v[68:71]
    s_waitcnt lgkmcnt(0)
    v_add_u32 v14, 122880, v11
    v_add_u32 v15, 20480, v10
    s_barrier
    ds_read_b64_tr_b16 v[128:129], v15 offset:0
    ds_read_b64_tr_b16 v[130:131], v15 offset:2048
    ds_read_b128 v[132:135], v14 offset:0
    v_mfma_f32_16x16x32_bf16 v[52:55], v[180:183], v[176:179], v[52:55]
    ds_read_b128 v[136:139], v14 offset:1024
    v_lshlrev_b32 v26, 16, v26
    v_sub_f32 v72, 1.0, v27
    v_mfma_f32_16x16x32_bf16 v[56:59], v[184:187], v[176:179], v[56:59]
    ds_read_b128 v[140:143], v14 offset:2048
    ds_read_b128 v[144:147], v14 offset:3072
    v_cvt_pk_bf16_f32 v72, v72, v72
    v_and_b32 v72, s3, v72
    v_mfma_f32_16x16x32_bf16 v[60:63], v[188:191], v[176:179], v[60:63]
    ds_read_b128 v[148:151], v14 offset:4096
    v_mul_u32_u24 v74, 1280, v20
    v_lshl_add_u32 v74, v2, 3, v74
    v_mfma_f32_16x16x32_bf16 v[64:67], v[192:195], v[176:179], v[64:67]
    ds_read_b64_tr_b16 v[152:153], v15 offset:4096
    ds_read_b64_tr_b16 v[154:155], v15 offset:6144
    ds_read_b128 v[156:159], v14 offset:5120
    s_mul_i32 s70, s61, 160
    v_and_b32 v75, 1, v2
    v_mfma_f32_16x16x32_bf16 v[68:71], v[196:199], v[176:179], v[68:71]
    ds_read_b128 v[160:163], v14 offset:6144
    v_mul_u32_u24 v75, 24, v75
    v_add_u32 v75, v75, v74
    v_mfma_f32_16x16x32_bf16 v[52:55], v[204:207], v[200:203], v[52:55]
    ds_read_b128 v[164:167], v14 offset:7168
    v_cvt_pk_bf16_f32 v33, v32, v33
    v_lshlrev_b32 v32, 16, v33
    v_mfma_f32_16x16x32_bf16 v[56:59], v[208:211], v[200:203], v[56:59]
    ds_read_b128 v[168:171], v14 offset:8192
    ds_read_b128 v[172:175], v14 offset:9216
    v_and_b32 v33, s3, v33
    v_mul_f32 v32, v32, v27
    v_mfma_f32_16x16x32_bf16 v[60:63], v[212:215], v[200:203], v[60:63]
    ds_read_b128 v[180:183], v14 offset:10240
    v_mul_f32 v33, v33, v27
    v_cvt_pk_bf16_f32 v33, v32, v33
    v_mfma_f32_16x16x32_bf16 v[64:67], v[216:219], v[200:203], v[64:67]
    ds_read_b128 v[184:187], v14 offset:11264
    ds_read_b128 v[188:191], v14 offset:12288
    v_lshlrev_b32 v32, 16, v33
    v_and_b32 v33, s3, v33
    v_mfma_f32_16x16x32_bf16 v[68:71], v[220:223], v[200:203], v[68:71]
    ds_read_b128 v[192:195], v14 offset:13312
    v_cvt_pk_bf16_f32 v35, v34, v35
    v_lshlrev_b32 v34, 16, v35
    s_waitcnt lgkmcnt(15)
    v_mfma_f32_16x16x32_bf16 v[52:55], v[132:135], v[128:131], v[52:55]
    ds_read_b128 v[196:199], v14 offset:14336
    v_and_b32 v35, s3, v35
    s_waitcnt lgkmcnt(15)
    v_mfma_f32_16x16x32_bf16 v[56:59], v[136:139], v[128:131], v[56:59]
    ds_read_b64_tr_b16 v[176:177], v15 offset:8192
    ds_read_b64_tr_b16 v[178:179], v15 offset:10240
    ds_read_b128 v[204:207], v14 offset:15360
    v_mul_f32 v34, v34, v27
    s_waitcnt lgkmcnt(15)
    v_mfma_f32_16x16x32_bf16 v[60:63], v[140:143], v[128:131], v[60:63]
    ds_read_b128 v[208:211], v14 offset:16384
    v_mul_f32 v35, v35, v27
    v_mfma_f32_16x16x32_bf16 v[64:67], v[144:147], v[128:131], v[64:67]
    ds_read_b128 v[212:215], v14 offset:17408
    ds_read_b128 v[216:219], v14 offset:18432
    v_cvt_pk_bf16_f32 v35, v34, v35
    v_mfma_f32_16x16x32_bf16 v[68:71], v[148:151], v[128:131], v[68:71]
    ds_read_b128 v[220:223], v14 offset:19456
    v_lshlrev_b32 v34, 16, v35
    s_waitcnt lgkmcnt(15)
    v_mfma_f32_16x16x32_bf16 v[52:55], v[156:159], v[152:155], v[52:55]
    ds_read_b64_tr_b16 v[200:201], v15 offset:12288
    ds_read_b64_tr_b16 v[202:203], v15 offset:14336
    v_and_b32 v35, s3, v35
    v_mfma_f32_16x16x32_bf16 v[56:59], v[160:163], v[152:155], v[56:59]
    v_cvt_pk_bf16_f32 v37, v36, v37
    s_waitcnt lgkmcnt(15)
    v_mfma_f32_16x16x32_bf16 v[60:63], v[164:167], v[152:155], v[60:63]
    v_lshlrev_b32 v36, 16, v37
    v_mfma_f32_16x16x32_bf16 v[64:67], v[168:171], v[152:155], v[64:67]
    v_and_b32 v37, s3, v37
    s_waitcnt lgkmcnt(14)
    v_mfma_f32_16x16x32_bf16 v[68:71], v[172:175], v[152:155], v[68:71]
    v_mul_f32 v36, v36, v27
    s_waitcnt lgkmcnt(0)
    v_add_u32 v14, 102400, v11
    v_add_u32 v15, 69632, v10
    s_barrier
    ds_read_b64_tr_b16 v[128:129], v15 offset:0
    ds_read_b64_tr_b16 v[130:131], v15 offset:2048
    ds_read_b128 v[132:135], v14 offset:0
    v_mfma_f32_16x16x32_bf16 v[52:55], v[180:183], v[176:179], v[52:55]
    ds_read_b128 v[136:139], v14 offset:1024
    v_mul_f32 v37, v37, v27
    v_cvt_pk_bf16_f32 v37, v36, v37
    v_mfma_f32_16x16x32_bf16 v[56:59], v[184:187], v[176:179], v[56:59]
    ds_read_b128 v[140:143], v14 offset:2048
    ds_read_b128 v[144:147], v14 offset:3072
    v_lshlrev_b32 v36, 16, v37
    v_and_b32 v37, s3, v37
    v_mfma_f32_16x16x32_bf16 v[60:63], v[188:191], v[176:179], v[60:63]
    ds_read_b128 v[148:151], v14 offset:4096
    v_cvt_pk_bf16_f32 v39, v38, v39
    v_lshlrev_b32 v38, 16, v39
    v_mfma_f32_16x16x32_bf16 v[64:67], v[192:195], v[176:179], v[64:67]
    ds_read_b64_tr_b16 v[152:153], v15 offset:4096
    ds_read_b64_tr_b16 v[154:155], v15 offset:6144
    ds_read_b128 v[156:159], v14 offset:5120
    v_and_b32 v39, s3, v39
    v_mul_f32 v38, v38, v27
    v_mfma_f32_16x16x32_bf16 v[68:71], v[196:199], v[176:179], v[68:71]
    ds_read_b128 v[160:163], v14 offset:6144
    v_mul_f32 v39, v39, v27
    v_cvt_pk_bf16_f32 v39, v38, v39
    v_mfma_f32_16x16x32_bf16 v[52:55], v[204:207], v[200:203], v[52:55]
    ds_read_b128 v[164:167], v14 offset:7168
    v_lshlrev_b32 v38, 16, v39
    v_and_b32 v39, s3, v39
    v_mfma_f32_16x16x32_bf16 v[56:59], v[208:211], v[200:203], v[56:59]
    ds_read_b128 v[168:171], v14 offset:8192
    ds_read_b128 v[172:175], v14 offset:9216
    v_cvt_pk_bf16_f32 v41, v40, v41
    v_lshlrev_b32 v40, 16, v41
    v_mfma_f32_16x16x32_bf16 v[60:63], v[212:215], v[200:203], v[60:63]
    ds_read_b128 v[180:183], v14 offset:10240
    v_and_b32 v41, s3, v41
    v_mul_f32 v40, v40, v27
    v_mfma_f32_16x16x32_bf16 v[64:67], v[216:219], v[200:203], v[64:67]
    ds_read_b128 v[184:187], v14 offset:11264
    ds_read_b128 v[188:191], v14 offset:12288
    v_mul_f32 v41, v41, v27
    v_cvt_pk_bf16_f32 v41, v40, v41
    v_mfma_f32_16x16x32_bf16 v[68:71], v[220:223], v[200:203], v[68:71]
    ds_read_b128 v[192:195], v14 offset:13312
    v_lshlrev_b32 v40, 16, v41
    v_and_b32 v41, s3, v41
    s_waitcnt lgkmcnt(15)
    v_mfma_f32_16x16x32_bf16 v[52:55], v[132:135], v[128:131], v[52:55]
    ds_read_b128 v[196:199], v14 offset:14336
    v_cvt_pk_bf16_f32 v43, v42, v43
    s_waitcnt lgkmcnt(15)
    v_mfma_f32_16x16x32_bf16 v[56:59], v[136:139], v[128:131], v[56:59]
    ds_read_b64_tr_b16 v[176:177], v15 offset:8192
    ds_read_b64_tr_b16 v[178:179], v15 offset:10240
    ds_read_b128 v[204:207], v14 offset:15360
    v_lshlrev_b32 v42, 16, v43
    s_waitcnt lgkmcnt(15)
    v_mfma_f32_16x16x32_bf16 v[60:63], v[140:143], v[128:131], v[60:63]
    ds_read_b128 v[208:211], v14 offset:16384
    v_and_b32 v43, s3, v43
    v_mfma_f32_16x16x32_bf16 v[64:67], v[144:147], v[128:131], v[64:67]
    ds_read_b128 v[212:215], v14 offset:17408
    ds_read_b128 v[216:219], v14 offset:18432
    v_mul_f32 v42, v42, v27
    v_mfma_f32_16x16x32_bf16 v[68:71], v[148:151], v[128:131], v[68:71]
    ds_read_b128 v[220:223], v14 offset:19456
    v_mul_f32 v43, v43, v27
    s_waitcnt lgkmcnt(15)
    v_mfma_f32_16x16x32_bf16 v[52:55], v[156:159], v[152:155], v[52:55]
    ds_read_b64_tr_b16 v[200:201], v15 offset:12288
    ds_read_b64_tr_b16 v[202:203], v15 offset:14336
    v_cvt_pk_bf16_f32 v43, v42, v43
    v_mfma_f32_16x16x32_bf16 v[56:59], v[160:163], v[152:155], v[56:59]
    v_lshlrev_b32 v42, 16, v43
    s_waitcnt lgkmcnt(15)
    v_mfma_f32_16x16x32_bf16 v[60:63], v[164:167], v[152:155], v[60:63]
    v_and_b32 v43, s3, v43
    v_mfma_f32_16x16x32_bf16 v[64:67], v[168:171], v[152:155], v[64:67]
    v_cvt_pk_bf16_f32 v45, v44, v45
    s_waitcnt lgkmcnt(14)
    v_mfma_f32_16x16x32_bf16 v[68:71], v[172:175], v[152:155], v[68:71]
    v_lshlrev_b32 v44, 16, v45
    s_waitcnt lgkmcnt(0)
    v_add_u32 v14, 0, v11
    v_add_u32 v15, 86016, v10
    s_barrier
    ds_read_b64_tr_b16 v[128:129], v15 offset:0
    ds_read_b64_tr_b16 v[130:131], v15 offset:2048
    ds_read_b128 v[132:135], v14 offset:0
    v_mfma_f32_16x16x32_bf16 v[52:55], v[180:183], v[176:179], v[52:55]
    ds_read_b128 v[136:139], v14 offset:1024
    v_and_b32 v45, s3, v45
    v_mul_f32 v44, v44, v27
    v_mfma_f32_16x16x32_bf16 v[56:59], v[184:187], v[176:179], v[56:59]
    ds_read_b128 v[140:143], v14 offset:2048
    ds_read_b128 v[144:147], v14 offset:3072
    v_mul_f32 v45, v45, v27
    v_cvt_pk_bf16_f32 v45, v44, v45
    v_mfma_f32_16x16x32_bf16 v[60:63], v[188:191], v[176:179], v[60:63]
    ds_read_b128 v[148:151], v14 offset:4096
    v_lshlrev_b32 v44, 16, v45
    v_and_b32 v45, s3, v45
    v_mfma_f32_16x16x32_bf16 v[64:67], v[192:195], v[176:179], v[64:67]
    ds_read_b64_tr_b16 v[152:153], v15 offset:4096
    ds_read_b64_tr_b16 v[154:155], v15 offset:6144
    ds_read_b128 v[156:159], v14 offset:5120
    v_cvt_pk_bf16_f32 v47, v46, v47
    v_lshlrev_b32 v46, 16, v47
    v_mfma_f32_16x16x32_bf16 v[68:71], v[196:199], v[176:179], v[68:71]
    ds_read_b128 v[160:163], v14 offset:6144
    v_and_b32 v47, s3, v47
    v_mul_f32 v46, v46, v27
    v_mfma_f32_16x16x32_bf16 v[52:55], v[204:207], v[200:203], v[52:55]
    ds_read_b128 v[164:167], v14 offset:7168
    v_mul_f32 v47, v47, v27
    v_cvt_pk_bf16_f32 v47, v46, v47
    v_mfma_f32_16x16x32_bf16 v[56:59], v[208:211], v[200:203], v[56:59]
    ds_read_b128 v[168:171], v14 offset:8192
    ds_read_b128 v[172:175], v14 offset:9216
    v_lshlrev_b32 v46, 16, v47
    v_and_b32 v47, s3, v47
    v_mfma_f32_16x16x32_bf16 v[60:63], v[212:215], v[200:203], v[60:63]
    ds_read_b128 v[180:183], v14 offset:10240
    v_cvt_pk_bf16_f32 v49, v48, v49
    v_lshlrev_b32 v48, 16, v49
    v_mfma_f32_16x16x32_bf16 v[64:67], v[216:219], v[200:203], v[64:67]
    ds_read_b128 v[184:187], v14 offset:11264
    ds_read_b128 v[188:191], v14 offset:12288
    v_and_b32 v49, s3, v49
    v_mul_f32 v48, v48, v27
    v_mfma_f32_16x16x32_bf16 v[68:71], v[220:223], v[200:203], v[68:71]
    ds_read_b128 v[192:195], v14 offset:13312
    v_mul_f32 v49, v49, v27
    v_cvt_pk_bf16_f32 v49, v48, v49
    s_waitcnt lgkmcnt(15)
    v_mfma_f32_16x16x32_bf16 v[52:55], v[132:135], v[128:131], v[52:55]
    ds_read_b128 v[196:199], v14 offset:14336
    v_lshlrev_b32 v48, 16, v49
    s_waitcnt lgkmcnt(15)
    v_mfma_f32_16x16x32_bf16 v[56:59], v[136:139], v[128:131], v[56:59]
    ds_read_b64_tr_b16 v[176:177], v15 offset:8192
    ds_read_b64_tr_b16 v[178:179], v15 offset:10240
    ds_read_b128 v[204:207], v14 offset:15360
    v_and_b32 v49, s3, v49
    s_waitcnt lgkmcnt(15)
    v_mfma_f32_16x16x32_bf16 v[60:63], v[140:143], v[128:131], v[60:63]
    ds_read_b128 v[208:211], v14 offset:16384
    v_cvt_pk_bf16_f32 v51, v50, v51
    v_mfma_f32_16x16x32_bf16 v[64:67], v[144:147], v[128:131], v[64:67]
    ds_read_b128 v[212:215], v14 offset:17408
    ds_read_b128 v[216:219], v14 offset:18432
    v_lshlrev_b32 v50, 16, v51
    v_mfma_f32_16x16x32_bf16 v[68:71], v[148:151], v[128:131], v[68:71]
    ds_read_b128 v[220:223], v14 offset:19456
    v_and_b32 v51, s3, v51
    s_waitcnt lgkmcnt(15)
    v_mfma_f32_16x16x32_bf16 v[52:55], v[156:159], v[152:155], v[52:55]
    ds_read_b64_tr_b16 v[200:201], v15 offset:12288
    ds_read_b64_tr_b16 v[202:203], v15 offset:14336
    v_mul_f32 v50, v50, v27
    v_mfma_f32_16x16x32_bf16 v[56:59], v[160:163], v[152:155], v[56:59]
    v_mul_f32 v51, v51, v27
    s_waitcnt lgkmcnt(15)
    v_mfma_f32_16x16x32_bf16 v[60:63], v[164:167], v[152:155], v[60:63]
    v_cvt_pk_bf16_f32 v51, v50, v51
    v_mfma_f32_16x16x32_bf16 v[64:67], v[168:171], v[152:155], v[64:67]
    v_lshlrev_b32 v50, 16, v51
    s_waitcnt lgkmcnt(14)
    v_mfma_f32_16x16x32_bf16 v[68:71], v[172:175], v[152:155], v[68:71]
    v_and_b32 v51, s3, v51
    s_waitcnt lgkmcnt(0)
    v_add_u32 v14, 122880, v11
    v_add_u32 v15, 36864, v10
    s_barrier
    ds_read_b64_tr_b16 v[128:129], v15 offset:0
    ds_read_b64_tr_b16 v[130:131], v15 offset:2048
    ds_read_b128 v[132:135], v14 offset:0
    v_mfma_f32_16x16x32_bf16 v[52:55], v[180:183], v[176:179], v[52:55]
    ds_read_b128 v[136:139], v14 offset:1024
    v_mfma_f32_16x16x32_bf16 v[56:59], v[184:187], v[176:179], v[56:59]
    ds_read_b128 v[140:143], v14 offset:2048
    ds_read_b128 v[144:147], v14 offset:3072
    v_mfma_f32_16x16x32_bf16 v[60:63], v[188:191], v[176:179], v[60:63]
    ds_read_b128 v[148:151], v14 offset:4096
    v_mfma_f32_16x16x32_bf16 v[64:67], v[192:195], v[176:179], v[64:67]
    ds_read_b64_tr_b16 v[152:153], v15 offset:4096
    ds_read_b64_tr_b16 v[154:155], v15 offset:6144
    ds_read_b128 v[156:159], v14 offset:5120
    v_mfma_f32_16x16x32_bf16 v[68:71], v[196:199], v[176:179], v[68:71]
    ds_read_b128 v[160:163], v14 offset:6144
    v_mfma_f32_16x16x32_bf16 v[52:55], v[204:207], v[200:203], v[52:55]
    ds_read_b128 v[164:167], v14 offset:7168
    v_mfma_f32_16x16x32_bf16 v[56:59], v[208:211], v[200:203], v[56:59]
    ds_read_b128 v[168:171], v14 offset:8192
    ds_read_b128 v[172:175], v14 offset:9216
    v_mfma_f32_16x16x32_bf16 v[60:63], v[212:215], v[200:203], v[60:63]
    ds_read_b128 v[180:183], v14 offset:10240
    v_mfma_f32_16x16x32_bf16 v[64:67], v[216:219], v[200:203], v[64:67]
    ds_read_b128 v[184:187], v14 offset:11264
    ds_read_b128 v[188:191], v14 offset:12288
    v_mfma_f32_16x16x32_bf16 v[68:71], v[220:223], v[200:203], v[68:71]
    ds_read_b128 v[192:195], v14 offset:13312
    s_waitcnt lgkmcnt(15)
    v_mfma_f32_16x16x32_bf16 v[52:55], v[132:135], v[128:131], v[52:55]
    ds_read_b128 v[196:199], v14 offset:14336
    s_waitcnt lgkmcnt(15)
    v_mfma_f32_16x16x32_bf16 v[56:59], v[136:139], v[128:131], v[56:59]
    ds_read_b64_tr_b16 v[176:177], v15 offset:8192
    ds_read_b64_tr_b16 v[178:179], v15 offset:10240
    ds_read_b128 v[204:207], v14 offset:15360
    s_waitcnt lgkmcnt(15)
    v_mfma_f32_16x16x32_bf16 v[60:63], v[140:143], v[128:131], v[60:63]
    ds_read_b128 v[208:211], v14 offset:16384
    v_mfma_f32_16x16x32_bf16 v[64:67], v[144:147], v[128:131], v[64:67]
    ds_read_b128 v[212:215], v14 offset:17408
    ds_read_b128 v[216:219], v14 offset:18432
    v_mfma_f32_16x16x32_bf16 v[68:71], v[148:151], v[128:131], v[68:71]
    ds_read_b128 v[220:223], v14 offset:19456
    s_waitcnt lgkmcnt(15)
    v_mfma_f32_16x16x32_bf16 v[52:55], v[156:159], v[152:155], v[52:55]
    ds_read_b64_tr_b16 v[200:201], v15 offset:12288
    ds_read_b64_tr_b16 v[202:203], v15 offset:14336
    v_mfma_f32_16x16x32_bf16 v[56:59], v[160:163], v[152:155], v[56:59]
    s_waitcnt lgkmcnt(15)
    v_mfma_f32_16x16x32_bf16 v[60:63], v[164:167], v[152:155], v[60:63]
    v_mfma_f32_16x16x32_bf16 v[64:67], v[168:171], v[152:155], v[64:67]
    s_waitcnt lgkmcnt(14)
    v_mfma_f32_16x16x32_bf16 v[68:71], v[172:175], v[152:155], v[68:71]
    s_waitcnt lgkmcnt(0)
    v_add_u32 v14, 102400, v11
    v_add_u32 v15, 53248, v10
    s_barrier
    ds_read_b64_tr_b16 v[128:129], v15 offset:0
    ds_read_b64_tr_b16 v[130:131], v15 offset:2048
    ds_read_b128 v[132:135], v14 offset:0
    v_mfma_f32_16x16x32_bf16 v[52:55], v[180:183], v[176:179], v[52:55]
    ds_read_b128 v[136:139], v14 offset:1024
    v_mfma_f32_16x16x32_bf16 v[56:59], v[184:187], v[176:179], v[56:59]
    ds_read_b128 v[140:143], v14 offset:2048
    ds_read_b128 v[144:147], v14 offset:3072
    v_mfma_f32_16x16x32_bf16 v[60:63], v[188:191], v[176:179], v[60:63]
    ds_read_b128 v[148:151], v14 offset:4096
    v_mfma_f32_16x16x32_bf16 v[64:67], v[192:195], v[176:179], v[64:67]
    ds_read_b64_tr_b16 v[152:153], v15 offset:4096
    ds_read_b64_tr_b16 v[154:155], v15 offset:6144
    ds_read_b128 v[156:159], v14 offset:5120
    v_mfma_f32_16x16x32_bf16 v[68:71], v[196:199], v[176:179], v[68:71]
    ds_read_b128 v[160:163], v14 offset:6144
    v_mfma_f32_16x16x32_bf16 v[52:55], v[204:207], v[200:203], v[52:55]
    ds_read_b128 v[164:167], v14 offset:7168
    v_mfma_f32_16x16x32_bf16 v[56:59], v[208:211], v[200:203], v[56:59]
    ds_read_b128 v[168:171], v14 offset:8192
    ds_read_b128 v[172:175], v14 offset:9216
    v_mfma_f32_16x16x32_bf16 v[60:63], v[212:215], v[200:203], v[60:63]
    ds_read_b128 v[180:183], v14 offset:10240
    v_mfma_f32_16x16x32_bf16 v[64:67], v[216:219], v[200:203], v[64:67]
    ds_read_b128 v[184:187], v14 offset:11264
    ds_read_b128 v[188:191], v14 offset:12288
    v_mfma_f32_16x16x32_bf16 v[68:71], v[220:223], v[200:203], v[68:71]
    ds_read_b128 v[192:195], v14 offset:13312
    s_waitcnt lgkmcnt(15)
    v_mfma_f32_16x16x32_bf16 v[52:55], v[132:135], v[128:131], v[52:55]
    ds_read_b128 v[196:199], v14 offset:14336
    s_waitcnt lgkmcnt(15)
    v_mfma_f32_16x16x32_bf16 v[56:59], v[136:139], v[128:131], v[56:59]
    ds_read_b64_tr_b16 v[176:177], v15 offset:8192
    ds_read_b64_tr_b16 v[178:179], v15 offset:10240
    ds_read_b128 v[204:207], v14 offset:15360
    s_waitcnt lgkmcnt(15)
    v_mfma_f32_16x16x32_bf16 v[60:63], v[140:143], v[128:131], v[60:63]
    ds_read_b128 v[208:211], v14 offset:16384
    v_mfma_f32_16x16x32_bf16 v[64:67], v[144:147], v[128:131], v[64:67]
    ds_read_b128 v[212:215], v14 offset:17408
    ds_read_b128 v[216:219], v14 offset:18432
    v_mfma_f32_16x16x32_bf16 v[68:71], v[148:151], v[128:131], v[68:71]
    ds_read_b128 v[220:223], v14 offset:19456
    s_waitcnt lgkmcnt(15)
    v_mfma_f32_16x16x32_bf16 v[52:55], v[156:159], v[152:155], v[52:55]
    ds_read_b64_tr_b16 v[200:201], v15 offset:12288
    ds_read_b64_tr_b16 v[202:203], v15 offset:14336
    v_mfma_f32_16x16x32_bf16 v[56:59], v[160:163], v[152:155], v[56:59]
    s_waitcnt lgkmcnt(15)
    v_mfma_f32_16x16x32_bf16 v[60:63], v[164:167], v[152:155], v[60:63]
    v_mfma_f32_16x16x32_bf16 v[64:67], v[168:171], v[152:155], v[64:67]
    s_waitcnt lgkmcnt(14)
    v_mfma_f32_16x16x32_bf16 v[68:71], v[172:175], v[152:155], v[68:71]
    s_waitcnt lgkmcnt(0)
    v_add_u32 v14, 0, v11
    v_add_u32 v15, 143360, v10
    s_barrier
    ds_read_b64_tr_b16 v[128:129], v15 offset:0
    ds_read_b64_tr_b16 v[130:131], v15 offset:2048
    ds_read_b128 v[132:135], v14 offset:0
    v_mfma_f32_16x16x32_bf16 v[52:55], v[180:183], v[176:179], v[52:55]
    ds_read_b128 v[136:139], v14 offset:1024
    v_mfma_f32_16x16x32_bf16 v[56:59], v[184:187], v[176:179], v[56:59]
    ds_read_b128 v[140:143], v14 offset:2048
    ds_read_b128 v[144:147], v14 offset:3072
    v_mfma_f32_16x16x32_bf16 v[60:63], v[188:191], v[176:179], v[60:63]
    ds_read_b128 v[148:151], v14 offset:4096
    v_mfma_f32_16x16x32_bf16 v[64:67], v[192:195], v[176:179], v[64:67]
    ds_read_b64_tr_b16 v[152:153], v15 offset:4096
    ds_read_b64_tr_b16 v[154:155], v15 offset:6144
    ds_read_b128 v[156:159], v14 offset:5120
    v_mfma_f32_16x16x32_bf16 v[68:71], v[196:199], v[176:179], v[68:71]
    ds_read_b128 v[160:163], v14 offset:6144
    v_mfma_f32_16x16x32_bf16 v[52:55], v[204:207], v[200:203], v[52:55]
    ds_read_b128 v[164:167], v14 offset:7168
    v_mfma_f32_16x16x32_bf16 v[56:59], v[208:211], v[200:203], v[56:59]
    ds_read_b128 v[168:171], v14 offset:8192
    ds_read_b128 v[172:175], v14 offset:9216
    v_mfma_f32_16x16x32_bf16 v[60:63], v[212:215], v[200:203], v[60:63]
    ds_read_b128 v[180:183], v14 offset:10240
    v_mfma_f32_16x16x32_bf16 v[64:67], v[216:219], v[200:203], v[64:67]
    ds_read_b128 v[184:187], v14 offset:11264
    ds_read_b128 v[188:191], v14 offset:12288
    v_mfma_f32_16x16x32_bf16 v[68:71], v[220:223], v[200:203], v[68:71]
    ds_read_b128 v[192:195], v14 offset:13312
    s_waitcnt lgkmcnt(15)
    v_mfma_f32_16x16x32_bf16 v[52:55], v[132:135], v[128:131], v[52:55]
    ds_read_b128 v[196:199], v14 offset:14336
    s_waitcnt lgkmcnt(15)
    v_mfma_f32_16x16x32_bf16 v[56:59], v[136:139], v[128:131], v[56:59]
    ds_read_b64_tr_b16 v[176:177], v15 offset:8192
    ds_read_b64_tr_b16 v[178:179], v15 offset:10240
    ds_read_b128 v[204:207], v14 offset:15360
    s_waitcnt lgkmcnt(15)
    v_mfma_f32_16x16x32_bf16 v[60:63], v[140:143], v[128:131], v[60:63]
    ds_read_b128 v[208:211], v14 offset:16384
    v_mfma_f32_16x16x32_bf16 v[64:67], v[144:147], v[128:131], v[64:67]
    ds_read_b128 v[212:215], v14 offset:17408
    ds_read_b128 v[216:219], v14 offset:18432
    v_mfma_f32_16x16x32_bf16 v[68:71], v[148:151], v[128:131], v[68:71]
    ds_read_b128 v[220:223], v14 offset:19456
    s_waitcnt lgkmcnt(15)
    v_mfma_f32_16x16x32_bf16 v[52:55], v[156:159], v[152:155], v[52:55]
    ds_read_b64_tr_b16 v[200:201], v15 offset:12288
    ds_read_b64_tr_b16 v[202:203], v15 offset:14336
    v_mfma_f32_16x16x32_bf16 v[56:59], v[160:163], v[152:155], v[56:59]
    s_waitcnt lgkmcnt(15)
    v_mfma_f32_16x16x32_bf16 v[60:63], v[164:167], v[152:155], v[60:63]
    v_mfma_f32_16x16x32_bf16 v[64:67], v[168:171], v[152:155], v[64:67]
    s_waitcnt lgkmcnt(14)
    v_mfma_f32_16x16x32_bf16 v[68:71], v[172:175], v[152:155], v[68:71]
    s_waitcnt lgkmcnt(0)
    v_add_u32 v14, 122880, v11
    v_add_u32 v15, 20480, v10
    s_barrier
    ds_read_b64_tr_b16 v[128:129], v15 offset:0
    ds_read_b64_tr_b16 v[130:131], v15 offset:2048
    ds_read_b128 v[132:135], v14 offset:0
    v_mfma_f32_16x16x32_bf16 v[52:55], v[180:183], v[176:179], v[52:55]
    ds_read_b128 v[136:139], v14 offset:1024
    v_mfma_f32_16x16x32_bf16 v[56:59], v[184:187], v[176:179], v[56:59]
    ds_read_b128 v[140:143], v14 offset:2048
    ds_read_b128 v[144:147], v14 offset:3072
    v_mfma_f32_16x16x32_bf16 v[60:63], v[188:191], v[176:179], v[60:63]
    ds_read_b128 v[148:151], v14 offset:4096
    v_mfma_f32_16x16x32_bf16 v[64:67], v[192:195], v[176:179], v[64:67]
    ds_read_b64_tr_b16 v[152:153], v15 offset:4096
    ds_read_b64_tr_b16 v[154:155], v15 offset:6144
    ds_read_b128 v[156:159], v14 offset:5120
    v_mfma_f32_16x16x32_bf16 v[68:71], v[196:199], v[176:179], v[68:71]
    ds_read_b128 v[160:163], v14 offset:6144
    v_mfma_f32_16x16x32_bf16 v[52:55], v[204:207], v[200:203], v[52:55]
    ds_read_b128 v[164:167], v14 offset:7168
    v_mfma_f32_16x16x32_bf16 v[56:59], v[208:211], v[200:203], v[56:59]
    ds_read_b128 v[168:171], v14 offset:8192
    ds_read_b128 v[172:175], v14 offset:9216
    v_mfma_f32_16x16x32_bf16 v[60:63], v[212:215], v[200:203], v[60:63]
    ds_read_b128 v[180:183], v14 offset:10240
    v_mfma_f32_16x16x32_bf16 v[64:67], v[216:219], v[200:203], v[64:67]
    ds_read_b128 v[184:187], v14 offset:11264
    ds_read_b128 v[188:191], v14 offset:12288
    v_mfma_f32_16x16x32_bf16 v[68:71], v[220:223], v[200:203], v[68:71]
    ds_read_b128 v[192:195], v14 offset:13312
    s_waitcnt lgkmcnt(15)
    v_mfma_f32_16x16x32_bf16 v[52:55], v[132:135], v[128:131], v[52:55]
    ds_read_b128 v[196:199], v14 offset:14336
    s_waitcnt lgkmcnt(15)
    v_mfma_f32_16x16x32_bf16 v[56:59], v[136:139], v[128:131], v[56:59]
    ds_read_b64_tr_b16 v[176:177], v15 offset:8192
    ds_read_b64_tr_b16 v[178:179], v15 offset:10240
    ds_read_b128 v[204:207], v14 offset:15360
    s_waitcnt lgkmcnt(15)
    v_mfma_f32_16x16x32_bf16 v[60:63], v[140:143], v[128:131], v[60:63]
    ds_read_b128 v[208:211], v14 offset:16384
    v_mfma_f32_16x16x32_bf16 v[64:67], v[144:147], v[128:131], v[64:67]
    ds_read_b128 v[212:215], v14 offset:17408
    ds_read_b128 v[216:219], v14 offset:18432
    v_mfma_f32_16x16x32_bf16 v[68:71], v[148:151], v[128:131], v[68:71]
    ds_read_b128 v[220:223], v14 offset:19456
    s_waitcnt lgkmcnt(15)
    v_mfma_f32_16x16x32_bf16 v[52:55], v[156:159], v[152:155], v[52:55]
    ds_read_b64_tr_b16 v[200:201], v15 offset:12288
    ds_read_b64_tr_b16 v[202:203], v15 offset:14336
    v_mfma_f32_16x16x32_bf16 v[56:59], v[160:163], v[152:155], v[56:59]
    s_waitcnt lgkmcnt(15)
    v_mfma_f32_16x16x32_bf16 v[60:63], v[164:167], v[152:155], v[60:63]
    v_mfma_f32_16x16x32_bf16 v[64:67], v[168:171], v[152:155], v[64:67]
    s_waitcnt lgkmcnt(14)
    v_mfma_f32_16x16x32_bf16 v[68:71], v[172:175], v[152:155], v[68:71]
    s_waitcnt lgkmcnt(0)
    v_add_u32 v14, 102400, v11
    v_add_u32 v15, 69632, v10
    s_barrier
    ds_read_b64_tr_b16 v[128:129], v15 offset:0
    ds_read_b64_tr_b16 v[130:131], v15 offset:2048
    ds_read_b128 v[132:135], v14 offset:0
    v_mfma_f32_16x16x32_bf16 v[52:55], v[180:183], v[176:179], v[52:55]
    ds_read_b128 v[136:139], v14 offset:1024
    v_mfma_f32_16x16x32_bf16 v[56:59], v[184:187], v[176:179], v[56:59]
    ds_read_b128 v[140:143], v14 offset:2048
    ds_read_b128 v[144:147], v14 offset:3072
    v_mfma_f32_16x16x32_bf16 v[60:63], v[188:191], v[176:179], v[60:63]
    ds_read_b128 v[148:151], v14 offset:4096
    v_mfma_f32_16x16x32_bf16 v[64:67], v[192:195], v[176:179], v[64:67]
    ds_read_b64_tr_b16 v[152:153], v15 offset:4096
    ds_read_b64_tr_b16 v[154:155], v15 offset:6144
    ds_read_b128 v[156:159], v14 offset:5120
    v_mfma_f32_16x16x32_bf16 v[68:71], v[196:199], v[176:179], v[68:71]
    ds_read_b128 v[160:163], v14 offset:6144
    v_mfma_f32_16x16x32_bf16 v[52:55], v[204:207], v[200:203], v[52:55]
    ds_read_b128 v[164:167], v14 offset:7168
    v_mfma_f32_16x16x32_bf16 v[56:59], v[208:211], v[200:203], v[56:59]
    ds_read_b128 v[168:171], v14 offset:8192
    ds_read_b128 v[172:175], v14 offset:9216
    v_mfma_f32_16x16x32_bf16 v[60:63], v[212:215], v[200:203], v[60:63]
    ds_read_b128 v[180:183], v14 offset:10240
    v_mfma_f32_16x16x32_bf16 v[64:67], v[216:219], v[200:203], v[64:67]
    ds_read_b128 v[184:187], v14 offset:11264
    ds_read_b128 v[188:191], v14 offset:12288
    v_mfma_f32_16x16x32_bf16 v[68:71], v[220:223], v[200:203], v[68:71]
    ds_read_b128 v[192:195], v14 offset:13312
    s_waitcnt lgkmcnt(15)
    v_mfma_f32_16x16x32_bf16 v[52:55], v[132:135], v[128:131], v[52:55]
    ds_read_b128 v[196:199], v14 offset:14336
    s_waitcnt lgkmcnt(15)
    v_mfma_f32_16x16x32_bf16 v[56:59], v[136:139], v[128:131], v[56:59]
    ds_read_b64_tr_b16 v[176:177], v15 offset:8192
    ds_read_b64_tr_b16 v[178:179], v15 offset:10240
    ds_read_b128 v[204:207], v14 offset:15360
    s_waitcnt lgkmcnt(15)
    v_mfma_f32_16x16x32_bf16 v[60:63], v[140:143], v[128:131], v[60:63]
    ds_read_b128 v[208:211], v14 offset:16384
    v_mfma_f32_16x16x32_bf16 v[64:67], v[144:147], v[128:131], v[64:67]
    ds_read_b128 v[212:215], v14 offset:17408
    ds_read_b128 v[216:219], v14 offset:18432
    v_mfma_f32_16x16x32_bf16 v[68:71], v[148:151], v[128:131], v[68:71]
    ds_read_b128 v[220:223], v14 offset:19456
    s_waitcnt lgkmcnt(15)
    v_mfma_f32_16x16x32_bf16 v[52:55], v[156:159], v[152:155], v[52:55]
    ds_read_b64_tr_b16 v[200:201], v15 offset:12288
    ds_read_b64_tr_b16 v[202:203], v15 offset:14336
    v_mfma_f32_16x16x32_bf16 v[56:59], v[160:163], v[152:155], v[56:59]
    s_waitcnt lgkmcnt(15)
    v_mfma_f32_16x16x32_bf16 v[60:63], v[164:167], v[152:155], v[60:63]
    v_mfma_f32_16x16x32_bf16 v[64:67], v[168:171], v[152:155], v[64:67]
    s_waitcnt lgkmcnt(14)
    v_mfma_f32_16x16x32_bf16 v[68:71], v[172:175], v[152:155], v[68:71]
    s_waitcnt lgkmcnt(0)
    v_add_u32 v14, 0, v11
    v_add_u32 v15, 86016, v10
    s_barrier
    ds_read_b64_tr_b16 v[128:129], v15 offset:0
    ds_read_b64_tr_b16 v[130:131], v15 offset:2048
    ds_read_b128 v[132:135], v14 offset:0
    v_mfma_f32_16x16x32_bf16 v[52:55], v[180:183], v[176:179], v[52:55]
    ds_read_b128 v[136:139], v14 offset:1024
    v_mfma_f32_16x16x32_bf16 v[56:59], v[184:187], v[176:179], v[56:59]
    ds_read_b128 v[140:143], v14 offset:2048
    ds_read_b128 v[144:147], v14 offset:3072
    v_mfma_f32_16x16x32_bf16 v[60:63], v[188:191], v[176:179], v[60:63]
    ds_read_b128 v[148:151], v14 offset:4096
    v_mfma_f32_16x16x32_bf16 v[64:67], v[192:195], v[176:179], v[64:67]
    ds_read_b64_tr_b16 v[152:153], v15 offset:4096
    ds_read_b64_tr_b16 v[154:155], v15 offset:6144
    ds_read_b128 v[156:159], v14 offset:5120
    v_mfma_f32_16x16x32_bf16 v[68:71], v[196:199], v[176:179], v[68:71]
    ds_read_b128 v[160:163], v14 offset:6144
    v_mfma_f32_16x16x32_bf16 v[52:55], v[204:207], v[200:203], v[52:55]
    ds_read_b128 v[164:167], v14 offset:7168
    v_mfma_f32_16x16x32_bf16 v[56:59], v[208:211], v[200:203], v[56:59]
    ds_read_b128 v[168:171], v14 offset:8192
    ds_read_b128 v[172:175], v14 offset:9216
    v_mfma_f32_16x16x32_bf16 v[60:63], v[212:215], v[200:203], v[60:63]
    ds_read_b128 v[180:183], v14 offset:10240
    v_mfma_f32_16x16x32_bf16 v[64:67], v[216:219], v[200:203], v[64:67]
    ds_read_b128 v[184:187], v14 offset:11264
    ds_read_b128 v[188:191], v14 offset:12288
    v_mfma_f32_16x16x32_bf16 v[68:71], v[220:223], v[200:203], v[68:71]
    ds_read_b128 v[192:195], v14 offset:13312
    s_waitcnt lgkmcnt(15)
    v_mfma_f32_16x16x32_bf16 v[52:55], v[132:135], v[128:131], v[52:55]
    ds_read_b128 v[196:199], v14 offset:14336
    s_waitcnt lgkmcnt(15)
    v_mfma_f32_16x16x32_bf16 v[56:59], v[136:139], v[128:131], v[56:59]
    ds_read_b64_tr_b16 v[176:177], v15 offset:8192
    ds_read_b64_tr_b16 v[178:179], v15 offset:10240
    ds_read_b128 v[204:207], v14 offset:15360
    s_waitcnt lgkmcnt(15)
    v_mfma_f32_16x16x32_bf16 v[60:63], v[140:143], v[128:131], v[60:63]
    ds_read_b128 v[208:211], v14 offset:16384
    v_mfma_f32_16x16x32_bf16 v[64:67], v[144:147], v[128:131], v[64:67]
    ds_read_b128 v[212:215], v14 offset:17408
    ds_read_b128 v[216:219], v14 offset:18432
    v_mfma_f32_16x16x32_bf16 v[68:71], v[148:151], v[128:131], v[68:71]
    ds_read_b128 v[220:223], v14 offset:19456
    s_waitcnt lgkmcnt(15)
    v_mfma_f32_16x16x32_bf16 v[52:55], v[156:159], v[152:155], v[52:55]
    ds_read_b64_tr_b16 v[200:201], v15 offset:12288
    ds_read_b64_tr_b16 v[202:203], v15 offset:14336
    v_mfma_f32_16x16x32_bf16 v[56:59], v[160:163], v[152:155], v[56:59]
    s_waitcnt lgkmcnt(15)
    v_mfma_f32_16x16x32_bf16 v[60:63], v[164:167], v[152:155], v[60:63]
    v_mfma_f32_16x16x32_bf16 v[64:67], v[168:171], v[152:155], v[64:67]
    s_waitcnt lgkmcnt(14)
    v_mfma_f32_16x16x32_bf16 v[68:71], v[172:175], v[152:155], v[68:71]
    s_waitcnt lgkmcnt(0)
    v_add_u32 v14, 122880, v11
    v_add_u32 v15, 36864, v10
    s_barrier
    ds_read_b64_tr_b16 v[128:129], v15 offset:0
    ds_read_b64_tr_b16 v[130:131], v15 offset:2048
    ds_read_b128 v[132:135], v14 offset:0
    v_mfma_f32_16x16x32_bf16 v[52:55], v[180:183], v[176:179], v[52:55]
    ds_read_b128 v[136:139], v14 offset:1024
    v_mfma_f32_16x16x32_bf16 v[56:59], v[184:187], v[176:179], v[56:59]
    ds_read_b128 v[140:143], v14 offset:2048
    ds_read_b128 v[144:147], v14 offset:3072
    v_mfma_f32_16x16x32_bf16 v[60:63], v[188:191], v[176:179], v[60:63]
    ds_read_b128 v[148:151], v14 offset:4096
    v_mfma_f32_16x16x32_bf16 v[64:67], v[192:195], v[176:179], v[64:67]
    ds_read_b64_tr_b16 v[152:153], v15 offset:4096
    ds_read_b64_tr_b16 v[154:155], v15 offset:6144
    ds_read_b128 v[156:159], v14 offset:5120
    v_mfma_f32_16x16x32_bf16 v[68:71], v[196:199], v[176:179], v[68:71]
    ds_read_b128 v[160:163], v14 offset:6144
    v_mfma_f32_16x16x32_bf16 v[52:55], v[204:207], v[200:203], v[52:55]
    ds_read_b128 v[164:167], v14 offset:7168
    v_mfma_f32_16x16x32_bf16 v[56:59], v[208:211], v[200:203], v[56:59]
    ds_read_b128 v[168:171], v14 offset:8192
    ds_read_b128 v[172:175], v14 offset:9216
    v_mfma_f32_16x16x32_bf16 v[60:63], v[212:215], v[200:203], v[60:63]
    ds_read_b128 v[180:183], v14 offset:10240
    v_mfma_f32_16x16x32_bf16 v[64:67], v[216:219], v[200:203], v[64:67]
    ds_read_b128 v[184:187], v14 offset:11264
    ds_read_b128 v[188:191], v14 offset:12288
    v_mfma_f32_16x16x32_bf16 v[68:71], v[220:223], v[200:203], v[68:71]
    ds_read_b128 v[192:195], v14 offset:13312
    s_waitcnt lgkmcnt(15)
    v_mfma_f32_16x16x32_bf16 v[52:55], v[132:135], v[128:131], v[52:55]
    ds_read_b128 v[196:199], v14 offset:14336
    s_waitcnt lgkmcnt(15)
    v_mfma_f32_16x16x32_bf16 v[56:59], v[136:139], v[128:131], v[56:59]
    ds_read_b64_tr_b16 v[176:177], v15 offset:8192
    ds_read_b64_tr_b16 v[178:179], v15 offset:10240
    ds_read_b128 v[204:207], v14 offset:15360
    s_waitcnt lgkmcnt(15)
    v_mfma_f32_16x16x32_bf16 v[60:63], v[140:143], v[128:131], v[60:63]
    ds_read_b128 v[208:211], v14 offset:16384
    v_mfma_f32_16x16x32_bf16 v[64:67], v[144:147], v[128:131], v[64:67]
    ds_read_b128 v[212:215], v14 offset:17408
    ds_read_b128 v[216:219], v14 offset:18432
    v_mfma_f32_16x16x32_bf16 v[68:71], v[148:151], v[128:131], v[68:71]
    ds_read_b128 v[220:223], v14 offset:19456
    s_waitcnt lgkmcnt(15)
    v_mfma_f32_16x16x32_bf16 v[52:55], v[156:159], v[152:155], v[52:55]
    ds_read_b64_tr_b16 v[200:201], v15 offset:12288
    ds_read_b64_tr_b16 v[202:203], v15 offset:14336
    v_mfma_f32_16x16x32_bf16 v[56:59], v[160:163], v[152:155], v[56:59]
    s_waitcnt lgkmcnt(15)
    v_mfma_f32_16x16x32_bf16 v[60:63], v[164:167], v[152:155], v[60:63]
    v_mfma_f32_16x16x32_bf16 v[64:67], v[168:171], v[152:155], v[64:67]
    s_waitcnt lgkmcnt(14)
    v_mfma_f32_16x16x32_bf16 v[68:71], v[172:175], v[152:155], v[68:71]
    s_waitcnt lgkmcnt(0)
    v_add_u32 v14, 102400, v11
    v_add_u32 v15, 53248, v10
    s_barrier
    ds_read_b64_tr_b16 v[128:129], v15 offset:0
    ds_read_b64_tr_b16 v[130:131], v15 offset:2048
    ds_read_b128 v[132:135], v14 offset:0
    v_mfma_f32_16x16x32_bf16 v[52:55], v[180:183], v[176:179], v[52:55]
    ds_read_b128 v[136:139], v14 offset:1024
    v_mfma_f32_16x16x32_bf16 v[56:59], v[184:187], v[176:179], v[56:59]
    ds_read_b128 v[140:143], v14 offset:2048
    ds_read_b128 v[144:147], v14 offset:3072
    v_mfma_f32_16x16x32_bf16 v[60:63], v[188:191], v[176:179], v[60:63]
    ds_read_b128 v[148:151], v14 offset:4096
    v_mfma_f32_16x16x32_bf16 v[64:67], v[192:195], v[176:179], v[64:67]
    ds_read_b64_tr_b16 v[152:153], v15 offset:4096
    ds_read_b64_tr_b16 v[154:155], v15 offset:6144
    ds_read_b128 v[156:159], v14 offset:5120
    v_mfma_f32_16x16x32_bf16 v[68:71], v[196:199], v[176:179], v[68:71]
    ds_read_b128 v[160:163], v14 offset:6144
    v_mfma_f32_16x16x32_bf16 v[52:55], v[204:207], v[200:203], v[52:55]
    ds_read_b128 v[164:167], v14 offset:7168
    v_mfma_f32_16x16x32_bf16 v[56:59], v[208:211], v[200:203], v[56:59]
    ds_read_b128 v[168:171], v14 offset:8192
    ds_read_b128 v[172:175], v14 offset:9216
    v_mfma_f32_16x16x32_bf16 v[60:63], v[212:215], v[200:203], v[60:63]
    ds_read_b128 v[180:183], v14 offset:10240
    v_mfma_f32_16x16x32_bf16 v[64:67], v[216:219], v[200:203], v[64:67]
    ds_read_b128 v[184:187], v14 offset:11264
    ds_read_b128 v[188:191], v14 offset:12288
    v_mfma_f32_16x16x32_bf16 v[68:71], v[220:223], v[200:203], v[68:71]
    ds_read_b128 v[192:195], v14 offset:13312
    s_waitcnt lgkmcnt(15)
    v_mfma_f32_16x16x32_bf16 v[52:55], v[132:135], v[128:131], v[52:55]
    ds_read_b128 v[196:199], v14 offset:14336
    s_waitcnt lgkmcnt(15)
    v_mfma_f32_16x16x32_bf16 v[56:59], v[136:139], v[128:131], v[56:59]
    ds_read_b64_tr_b16 v[176:177], v15 offset:8192
    ds_read_b64_tr_b16 v[178:179], v15 offset:10240
    ds_read_b128 v[204:207], v14 offset:15360
    s_waitcnt lgkmcnt(15)
    v_mfma_f32_16x16x32_bf16 v[60:63], v[140:143], v[128:131], v[60:63]
    ds_read_b128 v[208:211], v14 offset:16384
    v_mfma_f32_16x16x32_bf16 v[64:67], v[144:147], v[128:131], v[64:67]
    ds_read_b128 v[212:215], v14 offset:17408
    ds_read_b128 v[216:219], v14 offset:18432
    v_mfma_f32_16x16x32_bf16 v[68:71], v[148:151], v[128:131], v[68:71]
    ds_read_b128 v[220:223], v14 offset:19456
    s_waitcnt lgkmcnt(15)
    v_mfma_f32_16x16x32_bf16 v[52:55], v[156:159], v[152:155], v[52:55]
    ds_read_b64_tr_b16 v[200:201], v15 offset:12288
    ds_read_b64_tr_b16 v[202:203], v15 offset:14336
    v_mfma_f32_16x16x32_bf16 v[56:59], v[160:163], v[152:155], v[56:59]
    s_waitcnt lgkmcnt(15)
    v_mfma_f32_16x16x32_bf16 v[60:63], v[164:167], v[152:155], v[60:63]
    v_mfma_f32_16x16x32_bf16 v[64:67], v[168:171], v[152:155], v[64:67]
    s_waitcnt lgkmcnt(14)
    v_mfma_f32_16x16x32_bf16 v[68:71], v[172:175], v[152:155], v[68:71]
    s_waitcnt lgkmcnt(0)
    v_mfma_f32_16x16x32_bf16 v[52:55], v[180:183], v[176:179], v[52:55]
    v_mfma_f32_16x16x32_bf16 v[56:59], v[184:187], v[176:179], v[56:59]
    v_mfma_f32_16x16x32_bf16 v[60:63], v[188:191], v[176:179], v[60:63]
    v_mfma_f32_16x16x32_bf16 v[64:67], v[192:195], v[176:179], v[64:67]
    v_mfma_f32_16x16x32_bf16 v[68:71], v[196:199], v[176:179], v[68:71]
    v_mfma_f32_16x16x32_bf16 v[52:55], v[204:207], v[200:203], v[52:55]
    v_mfma_f32_16x16x32_bf16 v[56:59], v[208:211], v[200:203], v[56:59]
    v_mfma_f32_16x16x32_bf16 v[60:63], v[212:215], v[200:203], v[60:63]
    v_mfma_f32_16x16x32_bf16 v[64:67], v[216:219], v[200:203], v[64:67]
    v_mfma_f32_16x16x32_bf16 v[68:71], v[220:223], v[200:203], v[68:71]
    s_nop 3
    v_cvt_pk_bf16_f32 v53, v52, v53
    v_lshlrev_b32 v52, 16, v53
    v_and_b32 v53, s3, v53
    v_cvt_pk_bf16_f32 v55, v54, v55
    v_lshlrev_b32 v54, 16, v55
    v_and_b32 v55, s3, v55
    v_pk_add_f32 v[52:53], v[52:53], v[26:27] op_sel_hi:[1,0]
    v_pk_add_f32 v[54:55], v[54:55], v[26:27] op_sel_hi:[1,0]
    v_cvt_pk_bf16_f32 v53, v52, v53
    v_lshlrev_b32 v52, 16, v53
    v_and_b32 v53, s3, v53
    v_cvt_pk_bf16_f32 v55, v54, v55
    v_lshlrev_b32 v54, 16, v55
    v_and_b32 v55, s3, v55
    v_pk_mul_f32 v[52:53], v[52:53], v[72:73] op_sel_hi:[1,0]
    v_pk_mul_f32 v[54:55], v[54:55], v[72:73] op_sel_hi:[1,0]
    v_cvt_pk_bf16_f32 v53, v52, v53
    v_lshlrev_b32 v52, 16, v53
    v_and_b32 v53, s3, v53
    v_cvt_pk_bf16_f32 v55, v54, v55
    v_lshlrev_b32 v54, 16, v55
    v_and_b32 v55, s3, v55
    v_pk_add_f32 v[32:33], v[32:33], v[52:53]
    v_pk_add_f32 v[34:35], v[34:35], v[54:55]
    v_cvt_pk_bf16_f32 v76, v32, v33
    v_cvt_pk_bf16_f32 v77, v34, v35
    v_cvt_pk_bf16_f32 v57, v56, v57
    v_lshlrev_b32 v56, 16, v57
    v_and_b32 v57, s3, v57
    v_cvt_pk_bf16_f32 v59, v58, v59
    v_lshlrev_b32 v58, 16, v59
    v_and_b32 v59, s3, v59
    v_pk_add_f32 v[56:57], v[56:57], v[26:27] op_sel_hi:[1,0]
    v_pk_add_f32 v[58:59], v[58:59], v[26:27] op_sel_hi:[1,0]
    v_cvt_pk_bf16_f32 v57, v56, v57
    v_lshlrev_b32 v56, 16, v57
    v_and_b32 v57, s3, v57
    v_cvt_pk_bf16_f32 v59, v58, v59
    v_lshlrev_b32 v58, 16, v59
    v_and_b32 v59, s3, v59
    v_pk_mul_f32 v[56:57], v[56:57], v[72:73] op_sel_hi:[1,0]
    v_pk_mul_f32 v[58:59], v[58:59], v[72:73] op_sel_hi:[1,0]
    v_cvt_pk_bf16_f32 v57, v56, v57
    v_lshlrev_b32 v56, 16, v57
    v_and_b32 v57, s3, v57
    v_cvt_pk_bf16_f32 v59, v58, v59
    v_lshlrev_b32 v58, 16, v59
    v_and_b32 v59, s3, v59
    v_pk_add_f32 v[36:37], v[36:37], v[56:57]
    v_pk_add_f32 v[38:39], v[38:39], v[58:59]
    v_cvt_pk_bf16_f32 v78, v36, v37
    v_cvt_pk_bf16_f32 v79, v38, v39
    s_nop 0
    v_permlane16_swap_b32 v76, v78
    v_permlane16_swap_b32 v77, v79
    buffer_store_dwordx4 v[76:79], v75, s[36:39], s70 offen offset:0
    v_cvt_pk_bf16_f32 v61, v60, v61
    v_lshlrev_b32 v60, 16, v61
    v_and_b32 v61, s3, v61
    v_cvt_pk_bf16_f32 v63, v62, v63
    v_lshlrev_b32 v62, 16, v63
    v_and_b32 v63, s3, v63
    v_pk_add_f32 v[60:61], v[60:61], v[26:27] op_sel_hi:[1,0]
    v_pk_add_f32 v[62:63], v[62:63], v[26:27] op_sel_hi:[1,0]
    v_cvt_pk_bf16_f32 v61, v60, v61
    v_lshlrev_b32 v60, 16, v61
    v_and_b32 v61, s3, v61
    v_cvt_pk_bf16_f32 v63, v62, v63
    v_lshlrev_b32 v62, 16, v63
    v_and_b32 v63, s3, v63
    v_pk_mul_f32 v[60:61], v[60:61], v[72:73] op_sel_hi:[1,0]
    v_pk_mul_f32 v[62:63], v[62:63], v[72:73] op_sel_hi:[1,0]
    v_cvt_pk_bf16_f32 v61, v60, v61
    v_lshlrev_b32 v60, 16, v61
    v_and_b32 v61, s3, v61
    v_cvt_pk_bf16_f32 v63, v62, v63
    v_lshlrev_b32 v62, 16, v63
    v_and_b32 v63, s3, v63
    v_pk_add_f32 v[40:41], v[40:41], v[60:61]
    v_pk_add_f32 v[42:43], v[42:43], v[62:63]
    v_cvt_pk_bf16_f32 v80, v40, v41
    v_cvt_pk_bf16_f32 v81, v42, v43
    v_cvt_pk_bf16_f32 v65, v64, v65
    v_lshlrev_b32 v64, 16, v65
    v_and_b32 v65, s3, v65
    v_cvt_pk_bf16_f32 v67, v66, v67
    v_lshlrev_b32 v66, 16, v67
    v_and_b32 v67, s3, v67
    v_pk_add_f32 v[64:65], v[64:65], v[26:27] op_sel_hi:[1,0]
    v_pk_add_f32 v[66:67], v[66:67], v[26:27] op_sel_hi:[1,0]
    v_cvt_pk_bf16_f32 v65, v64, v65
    v_lshlrev_b32 v64, 16, v65
    v_and_b32 v65, s3, v65
    v_cvt_pk_bf16_f32 v67, v66, v67
    v_lshlrev_b32 v66, 16, v67
    v_and_b32 v67, s3, v67
    v_pk_mul_f32 v[64:65], v[64:65], v[72:73] op_sel_hi:[1,0]
    v_pk_mul_f32 v[66:67], v[66:67], v[72:73] op_sel_hi:[1,0]
    v_cvt_pk_bf16_f32 v65, v64, v65
    v_lshlrev_b32 v64, 16, v65
    v_and_b32 v65, s3, v65
    v_cvt_pk_bf16_f32 v67, v66, v67
    v_lshlrev_b32 v66, 16, v67
    v_and_b32 v67, s3, v67
    v_pk_add_f32 v[44:45], v[44:45], v[64:65]
    v_pk_add_f32 v[46:47], v[46:47], v[66:67]
    v_cvt_pk_bf16_f32 v82, v44, v45
    v_cvt_pk_bf16_f32 v83, v46, v47
    s_nop 0
    v_permlane16_swap_b32 v80, v82
    v_permlane16_swap_b32 v81, v83
    buffer_store_dwordx4 v[80:83], v75, s[36:39], s70 offen offset:64
    v_cvt_pk_bf16_f32 v69, v68, v69
    v_lshlrev_b32 v68, 16, v69
    v_and_b32 v69, s3, v69
    v_cvt_pk_bf16_f32 v71, v70, v71
    v_lshlrev_b32 v70, 16, v71
    v_and_b32 v71, s3, v71
    v_pk_add_f32 v[68:69], v[68:69], v[26:27] op_sel_hi:[1,0]
    v_pk_add_f32 v[70:71], v[70:71], v[26:27] op_sel_hi:[1,0]
    v_cvt_pk_bf16_f32 v69, v68, v69
    v_lshlrev_b32 v68, 16, v69
    v_and_b32 v69, s3, v69
    v_cvt_pk_bf16_f32 v71, v70, v71
    v_lshlrev_b32 v70, 16, v71
    v_and_b32 v71, s3, v71
    v_pk_mul_f32 v[68:69], v[68:69], v[72:73] op_sel_hi:[1,0]
    v_pk_mul_f32 v[70:71], v[70:71], v[72:73] op_sel_hi:[1,0]
    v_cvt_pk_bf16_f32 v69, v68, v69
    v_lshlrev_b32 v68, 16, v69
    v_and_b32 v69, s3, v69
    v_cvt_pk_bf16_f32 v71, v70, v71
    v_lshlrev_b32 v70, 16, v71
    v_and_b32 v71, s3, v71
    v_pk_add_f32 v[48:49], v[48:49], v[68:69]
    v_pk_add_f32 v[50:51], v[50:51], v[70:71]
    v_cvt_pk_bf16_f32 v84, v48, v49
    v_cvt_pk_bf16_f32 v85, v50, v51
    buffer_store_dwordx2 v[84:85], v74, s[36:39], s70 offen offset:128
    s_endpgm
L_end:
    s_endpgm
.section .rodata,"a"
.p2align 6
.amdhsa_kernel gated_mix__sliding_local_dilated__mixer_token_mlp__prompt_kernel
  .amdhsa_next_free_vgpr 256
  .amdhsa_next_free_sgpr 96
  .amdhsa_accum_offset 256
  .amdhsa_group_segment_fixed_size 0
  .amdhsa_kernarg_size 96
  .amdhsa_user_sgpr_count 2
  .amdhsa_user_sgpr_kernarg_segment_ptr 1
  .amdhsa_system_sgpr_workgroup_id_x 1
.end_amdhsa_kernel
```
